```python
import torch

def _softmax(x, axis=-1):
    return torch.softmax(x, dim=axis)
def _gelu(x):
    return torch.nn.functional.gelu(x, approximate="tanh")
def _silu(x):
    return torch.nn.functional.silu(x)
def _sigmoid(x):
    return torch.sigmoid(x)
def _layernorm(x, axis=-1, eps=1e-5):
    m = x.mean(dim=axis, keepdim=True)
    v = x.var(dim=axis, keepdim=True, unbiased=False)
    return (x - m) / torch.sqrt(v + eps)
def _scatter_add(tgt, idx, src, axis=0):
    return tgt.clone().index_add_(axis, idx, src)
def _segment_sum(src, seg, n):
    out = torch.zeros((n,) + src.shape[1:], dtype=src.dtype)
    return out.index_add_(0, seg, src)
def _pad(x, pw):
    flat = tuple(v for pair in reversed(pw) for v in pair)
    return torch.nn.functional.pad(x, flat)

kernel_name = 'concat_heads__linear_kernel_hedgehog__compressed_kv_cla__prompt'

def setup_inputs():

    _w = (lambda a: (lambda t: t.to(torch.bfloat16) if t.is_floating_point() else t)(torch.as_tensor(a)))
    def _A_setup():
        B, S, D, H = 1, 2048, 512, 32
        Dh = D // H
        return {
            "x": _w((lambda *s: torch.randn(*s, dtype=torch.bfloat16) * 0.4)(B, S, D)),
            "wqkv": _w((lambda *s: torch.randn(*s, dtype=torch.bfloat16) * 0.4)(D, 3 * D)),
            "w_phi": _w((lambda *s: torch.randn(*s, dtype=torch.bfloat16) * 0.4)(H, Dh, Dh) * (Dh ** -0.5)),
            "wo": _w((lambda *s: torch.randn(*s, dtype=torch.bfloat16) * 0.05)(D, D)),
        }
    _A_in = _A_setup()

    def _B_setup():
        B, H, Sq, Sk, D, M = 1, 32, 2048, 2048, 128, 512
        Dc = 4 * D
        return {
            "x": _w((lambda *s: torch.randn(*s, dtype=torch.bfloat16) * 0.8)(B, Sq, M)),
            "c_kv": _w((lambda *s: torch.randn(*s, dtype=torch.bfloat16) * 0.4)(B, Sk, Dc)),
            "w_q": _w((lambda *s: torch.randn(*s, dtype=torch.bfloat16) * 6.4)(M, H, D) * (M ** -0.5)),
            "w_uk": _w((lambda *s: torch.randn(*s, dtype=torch.bfloat16) * 6.4)(Dc, H, D) * (Dc ** -0.5)),
            "w_uv": _w((lambda *s: torch.randn(*s, dtype=torch.bfloat16) * 0.4)(Dc, H, D) * (Dc ** -0.5)),
            "w_o": _w((lambda *s: torch.randn(*s, dtype=torch.bfloat16) * 0.4)(H, D, M) * ((H * D) ** -0.5)),
        }
    _B_in = _B_setup()

    return {
        "A_x": _A_in["x"],
        "A_wqkv": _A_in["wqkv"],
        "A_w_phi": _A_in["w_phi"],
        "A_wo": _A_in["wo"],
        "B_x": _B_in["x"],
        "B_c_kv": _B_in["c_kv"],
        "B_w_q": _B_in["w_q"],
        "B_w_uk": _B_in["w_uk"],
        "B_w_uv": _B_in["w_uv"],
        "B_w_o": _B_in["w_o"],
    }

def reference(A_x, A_wqkv, A_w_phi, A_wo, B_x, B_c_kv, B_w_q, B_w_uk, B_w_uv, B_w_o):
    def _A_ref(x, wqkv, w_phi, wo):
        B, S, D = x.shape
        H = 32; Dh = D // H
        qkv = (lambda x, *d: x.permute(*d))((x @ wqkv).reshape(B, S, 3, H, Dh), 2, 0, 3, 1, 4)
        q, k, v = qkv[0], qkv[1], qkv[2]
        pq = torch.einsum("bhsd,hdf->bhsf", q, w_phi)
        pk = torch.einsum("bhsd,hdf->bhsf", k, w_phi)
        phi_q = torch.concatenate([_softmax(pq, axis=-1), _softmax(-pq, axis=-1)], axis=-1)
        phi_k = torch.concatenate([_softmax(pk, axis=-1), _softmax(-pk, axis=-1)], axis=-1)
        kv = torch.einsum("bhsf,bhsd->bhfd", phi_k, v)
        z  = torch.einsum("bhsf->bhf", phi_k)
        num = torch.einsum("bhqf,bhfd->bhqd", phi_q, kv)
        den = torch.einsum("bhqf,bhf->bhq", phi_q, z)[..., None] + 1e-6
        o = num / den
        return (lambda x, *d: x.permute(*d))(o, 0, 2, 1, 3).reshape(B, S, D) @ wo

    def _B_ref(x, c_kv, w_q, w_uk, w_uv, w_o):
        B, Sq, M = x.shape[0], x.shape[1], x.shape[2]
        Sk = c_kv.shape[1]
        H, D = w_q.shape[1], w_q.shape[2]
        q = torch.einsum("bqm,mhd->bhqd", x, w_q)
        k = torch.einsum("bkc,chd->bhkd", c_kv, w_uk)
        v = torch.einsum("bkc,chd->bhkd", c_kv, w_uv)
        scores = torch.einsum("bhqd,bhkd->bhqk", q, k) * (D ** -0.5)
        off = Sk - Sq
        qi = torch.arange(Sq)[:, None]
        kj = torch.arange(Sk)[None, :]
        cmask = kj <= (qi + off)
        scores = torch.where(cmask[None, None], scores, -1e9)
        p = _softmax(scores, axis=-1)
        ctx = torch.einsum("bhqk,bhkd->bhqd", p, v)
        return torch.einsum("bhqd,hdm->bqm", ctx, w_o)

    a = _A_ref(A_x, A_wqkv, A_w_phi, A_wo)
    b = _B_ref(B_x, B_c_kv, B_w_q, B_w_uk, B_w_uv, B_w_o)
    return torch.concatenate([a, b], axis=-1)
```

```asm
; @launch kernel=concat_heads__linear_kernel_hedgehog__compressed_kv_cla__prompt_kernel grid=(256,1,1) block=(512,1,1) lds=163840
.amdgcn_target "amdgcn-amd-amdhsa--gfx950"
.text
.globl concat_heads__linear_kernel_hedgehog__compressed_kv_cla__prompt_kernel
.p2align 8
.type concat_heads__linear_kernel_hedgehog__compressed_kv_cla__prompt_kernel,@function
concat_heads__linear_kernel_hedgehog__compressed_kv_cla__prompt_kernel:
    s_cmp_ge_u32 s2, 256
    s_cbranch_scc1 ka_end
    s_load_dwordx2 s[16:17], s[0:1], 40
    s_load_dwordx2 s[20:21], s[0:1], 56
    s_load_dwordx2 s[24:25], s[0:1], 64
    s_load_dwordx2 s[8:9], s[0:1], 96
    s_getpc_b64 s[86:87]
ka_here:
    s_sub_u32 s86, s86, ka_here-concat_heads__linear_kernel_hedgehog__compressed_kv_cla__prompt_kernel
    s_subb_u32 s87, s87, 0
    s_lshr_b32 s56, s2, 3
    s_mul_i32 s56, s56, 24
    s_sub_u32 s56, s56, 488
    v_add_u32 v2, s56, v0
    v_lshlrev_b32 v2, 7, v2
    v_min_u32 v2, code_end-concat_heads__linear_kernel_hedgehog__compressed_kv_cla__prompt_kernel-4, v2
    v_mov_b32 v3, s87
    v_add_co_u32 v2, vcc, s86, v2
    s_nop 1
    v_addc_co_u32 v3, vcc, 0, v3, vcc
    v_cmp_lt_u32 vcc, 487, v0
    s_and_saveexec_b64 s[88:89], vcc
    s_cbranch_execz ka_nocpf
    global_load_dword v25, v[2:3], off
ka_nocpf:
    s_mov_b64 exec, s[88:89]
    v_lshrrev_b32 v1, 6, v0
    v_and_b32 v0, 63, v0
    v_readfirstlane_b32 s3, v1
    s_mov_b32 s18, 2097152
    s_mov_b32 s19, 0x20000
    s_mov_b32 s22, 4194304
    s_mov_b32 s23, 0x20000
    s_mov_b32 s26, 4194304
    s_mov_b32 s27, 0x20000
    s_mov_b32 s10, 268435456
    s_mov_b32 s11, 0x20000
    s_and_b32 s56, s2, 7
    s_lshr_b32 s57, s2, 3
    s_add_u32 s57, s57, 0
    s_and_b32 s58, s57, 3
    s_lshl_b32 s4, s56, 2
    s_add_u32 s4, s4, s58
    s_and_b32 s98, s2, 31
    s_lshr_b32 s5, s2, 5
    s_lshr_b32 s6, s56, 1
    s_lshl_b32 s6, s6, 2
    s_add_u32 s6, s6, s58
    s_and_b32 s7, s56, 1
    s_lshl_b32 s7, s7, 3
    s_add_u32 s7, s7, s5
    s_and_b32 s65, s3, 3
    s_lshl_b32 s60, s3, 11
    s_lshl_b32 s61, s3, 10
    v_lshrrev_b32 v15, 4, v0
    v_and_b32 v10, 7, v0
    v_xor_b32 v10, v10, v15
    v_lshlrev_b32 v10, 4, v10
    v_lshrrev_b32 v23, 3, v0
    v_lshl_or_b32 v10, v23, 10, v10
    v_xor_b32 v23, 64, v10
    s_and_b32 s56, s3, 2
    s_lshl_b32 s56, s56, 1
    s_lshl_b32 s57, s65, 2
    v_and_b32 v17, 15, v0
    v_or_b32 v16, s56, v15
    v_lshlrev_b32 v16, 1, v16
    v_xor_b32 v16, v16, v17
    v_add_u32 v19, s57, v15
    v_lshlrev_b32 v11, 13, v19
    v_lshl_or_b32 v11, v16, 4, v11
    s_lshl_b32 s62, s5, 8
    s_lshl_b32 s56, s3, 4
    s_add_u32 s62, s62, s56
    s_lshl_b32 s62, s62, 10
    s_lshr_b32 s56, s3, 2
    s_lshl_b32 s56, s56, 17
    s_lshl_b32 s63, s98, 8
    s_add_u32 s63, s63, s56
    s_waitcnt lgkmcnt(0)
    s_mov_b32 s94, 0
    s_add_u32 m0, s60, 32768
    s_add_u32 s64, s62, 0
    buffer_load_dwordx4 v10, s[16:19], s64 offen lds
    s_add_u32 m0, s60, 33792
    s_add_u32 s64, s62, 8192
    buffer_load_dwordx4 v23, s[16:19], s64 offen lds
    s_add_u32 m0, s61, 65536
    s_add_u32 s64, s63, 0
    buffer_load_dwordx4 v11, s[20:23], s64 offen nt lds
    s_add_u32 m0, s61, 73728
    s_add_u32 s64, s63, 0
    buffer_load_dwordx4 v11, s[24:27], s64 offen nt lds
    s_add_u32 m0, s60, 49152
    s_add_u32 s64, s62, 131072
    buffer_load_dwordx4 v10, s[16:19], s64 offen lds
    s_add_u32 m0, s60, 50176
    s_add_u32 s64, s62, 139264
    buffer_load_dwordx4 v23, s[16:19], s64 offen lds
    s_add_u32 m0, s61, 81920
    s_add_u32 s64, s63, 262144
    buffer_load_dwordx4 v11, s[20:23], s64 offen nt lds
    s_add_u32 m0, s61, 90112
    s_add_u32 s64, s63, 262144
    buffer_load_dwordx4 v11, s[24:27], s64 offen nt lds
    s_add_u32 m0, s60, 131072
    s_add_u32 s64, s62, 128
    buffer_load_dwordx4 v10, s[16:19], s64 offen lds
    s_add_u32 m0, s60, 132096
    s_add_u32 s64, s62, 8320
    buffer_load_dwordx4 v23, s[16:19], s64 offen lds
    s_add_u32 m0, s61, 98304
    s_add_u32 s64, s63, 524288
    buffer_load_dwordx4 v11, s[20:23], s64 offen nt lds
    s_add_u32 m0, s61, 106496
    s_add_u32 s64, s63, 524288
    buffer_load_dwordx4 v11, s[24:27], s64 offen nt lds
    s_lshl_b32 s60, s65, 11
    s_lshl_b32 s61, s65, 10
    s_lshl_b32 s56, s3, 14
    s_add_u32 s62, s62, s56
    s_load_dwordx2 s[28:29], s[0:1], 0
    s_mov_b32 s30, 2097152
    s_mov_b32 s31, 0x20000
    s_load_dwordx2 s[32:33], s[0:1], 8
    s_mov_b32 s34, 1572864
    s_mov_b32 s35, 0x20000
    s_load_dwordx2 s[52:53], s[0:1], 16
    s_mov_b32 s54, 16384
    s_mov_b32 s55, 0x20000
    s_load_dwordx2 s[48:49], s[0:1], 24
    s_mov_b32 s50, 524288
    s_mov_b32 s51, 0x20000
    s_load_dwordx2 s[36:37], s[0:1], 32
    s_mov_b32 s38, 2097152
    s_mov_b32 s39, 0x20000
    s_load_dwordx2 s[40:41], s[0:1], 48
    s_mov_b32 s42, 4194304
    s_mov_b32 s43, 0x20000
    s_load_dwordx2 s[12:13], s[0:1], 88
    s_mov_b32 s14, 256
    s_mov_b32 s15, 0x20000
    v_lshlrev_b32 v24, 7, v0
    v_mul_u32_u24 v12, 3072, v19
    v_lshrrev_b32 v18, 2, v16
    v_lshl_add_u32 v12, v18, 10, v12
    v_and_b32 v19, 3, v16
    v_lshl_add_u32 v12, v19, 4, v12
    v_cmp_eq_u32 vcc, 3, v18
    v_mov_b32 v19, 1073741824
    s_nop 0
    v_cndmask_b32 v12, v12, v19, vcc
    v_bfe_u32 v18, v0, 2, 2
    v_bfe_u32 v21, v0, 1, 3
    v_xor_b32 v21, v21, v15
    v_lshlrev_b32 v21, 4, v21
    v_and_b32 v17, 15, v0
    v_lshl_or_b32 v21, v17, 7, v21
    s_lshl_b32 s78, s6, 7
    s_lshl_b32 s56, s65, 4
    s_add_u32 s78, s78, s56
    s_lshl_b32 s78, s78, 10
    s_lshl_b32 s79, s7, 6
    s_add_u32 s96, s5, 5
    s_and_b32 s96, s96, 7
    s_lshl_b32 s56, s96, 2
    s_add_u32 s81, s56, s65
    s_sub_u32 s80, 63, s81
    s_cmp_lt_u32 s3, 4
    s_cselect_b32 s68, s80, s81
    s_lshl_b32 s80, s80, 15
    s_lshl_b32 s81, s81, 15
    s_lshl_b32 s82, s98, 8
    v_lshl_add_u32 v17, v15, 3, v18
    v_lshlrev_b32 v22, 8, v17
    v_and_b32 v17, 1, v15
    v_lshl_or_b32 v17, v17, 2, v18
    v_lshl_or_b32 v22, v17, 5, v22
    v_and_b32 v17, 3, v0
    v_lshl_or_b32 v22, v17, 3, v22
    v_or_b32 v22, 65536, v22
    s_lshr_b32 s56, s3, 2
    s_lshl_b32 s56, s56, 13
    s_and_b32 s57, s3, 2
    s_lshl_b32 s57, s57, 6
    s_or_b32 s56, s56, s57
    v_xor_b32 v2, s56, v22
    v_xor_b32 v3, 32, v2
    v_xor_b32 v4, 64, v2
    v_xor_b32 v5, 96, v2
    s_and_b32 s56, s3, 1
    s_lshl_b32 s56, s56, 14
    v_add_u32 v1, s56, v21
    v_xor_b32 v6, 64, v1
    v_add_u32 v7, 131072, v1
    v_xor_b32 v9, 64, v7
    s_lshl_b32 s56, s4, 6
    s_lshl_b32 s57, s5, 3
    s_add_u32 s56, s56, s57
    s_and_b32 s57, s3, 1
    s_lshl_b32 s57, s57, 2
    s_add_u32 s56, s56, s57
    s_lshl_b32 s66, s56, 13
    s_and_b32 s57, s3, 2
    s_lshl_b32 s57, s57, 11
    s_add_u32 s66, s66, s57
    s_lshl_b32 s73, s4, 19
    s_lshl_b32 s77, s65, 12
    s_add_u32 s73, s73, s77
    s_add_u32 s74, s73, 18857984
    s_add_u32 s73, s73, 1048576
    s_mov_b32 s75, 0
    s_lshl_b32 s57, s96, 1
    s_sub_u32 s76, 32, s57
    s_add_u32 s91, s77, 131072
    s_mov_b32 s72, 1317011456
    v_and_b32 v19, 3, v0
    v_lshrrev_b32 v8, 2, v0
    v_lshlrev_b32 v8, 6, v8
    v_lshl_or_b32 v8, v19, 4, v8
    s_and_b32 s56, s3, 1
    s_lshl_b32 s56, s56, 3
    s_add_u32 s56, s56, 147456
    v_add_u32 v8, s56, v8
    v_lshlrev_b32 v15, 4, v0
    s_cmp_ge_u32 s3, 4
    s_cbranch_scc1 stream_s
    s_add_u32 s66, s66, 1048576
    s_and_b32 s58, s4, 3
    s_lshl_b32 s58, s58, 3
    s_add_u32 s58, s58, s5
    s_sub_u32 s58, s58, 1024
    v_lshlrev_b32 v18, 5, v0
    v_add_u32 v18, s58, v18
    s_lshr_b32 s58, s4, 2
    s_lshl_b32 s58, s58, 5
    s_mov_b32 exec_hi, 0
    v_add_u32 v18, s58, v0
    s_mov_b32 exec_hi, 0xff
    v_lshlrev_b32 v18, 7, v18
    s_mov_b32 s58, 68157440
    s_cmp_eq_u32 s3, 0
    s_cselect_b32 s58, s58, 1073741824
    buffer_load_dword v20, v18, s[8:11], s58 offen sc1
    s_mov_b64 exec, -1
    s_waitcnt vmcnt(5) lgkmcnt(0)
    s_barrier
    ds_read_b64_tr_b16 v[32:33], v2 offset:0
    ds_read_b64_tr_b16 v[34:35], v2 offset:1024
    ds_read_b64_tr_b16 v[36:37], v3 offset:0
    ds_read_b64_tr_b16 v[38:39], v3 offset:1024
    ds_read_b64_tr_b16 v[40:41], v4 offset:0
    ds_read_b64_tr_b16 v[42:43], v4 offset:1024
    ds_read_b64_tr_b16 v[44:45], v5 offset:0
    ds_read_b64_tr_b16 v[46:47], v5 offset:1024
    ds_read_b128 v[48:51], v1 offset:32768
    ds_read_b128 v[52:55], v1 offset:34816
    ds_read_b128 v[56:59], v1 offset:36864
    ds_read_b128 v[60:63], v1 offset:38912
    ds_read_b128 v[64:67], v1 offset:40960
    ds_read_b128 v[68:71], v1 offset:43008
    ds_read_b128 v[72:75], v1 offset:45056
    ds_read_b128 v[76:79], v1 offset:47104
    s_add_u32 m0, s77, 147456
    s_add_u32 s64, s62, 131200
    buffer_load_dwordx4 v10, s[16:19], s64 offen lds
    s_add_u32 m0, s77, 148480
    s_add_u32 s64, s62, 139392
    buffer_load_dwordx4 v23, s[16:19], s64 offen lds
    s_add_u32 m0, s77, 149504
    s_add_u32 s64, s62, 147584
    buffer_load_dwordx4 v10, s[16:19], s64 offen lds
    s_add_u32 m0, s77, 150528
    s_add_u32 s64, s62, 155776
    buffer_load_dwordx4 v23, s[16:19], s64 offen lds
    s_add_u32 m0, s61, 114688
    s_add_u32 s64, s63, 786432
    buffer_load_dwordx4 v11, s[20:23], s64 offen nt lds
    s_add_u32 m0, s61, 122880
    s_add_u32 s64, s63, 786432
    buffer_load_dwordx4 v11, s[24:27], s64 offen nt lds
    s_add_u32 m0, s61, 118784
    s_add_u32 s64, s63, 917504
    buffer_load_dwordx4 v11, s[20:23], s64 offen nt lds
    s_add_u32 m0, s61, 126976
    s_add_u32 s64, s63, 917504
    buffer_load_dwordx4 v11, s[24:27], s64 offen nt lds
    s_waitcnt vmcnt(13) lgkmcnt(0)
    s_barrier
    v_mfma_f32_16x16x32_bf16 v[128:131], v[32:35], v[48:51], 0
    ds_read_b64_tr_b16 v[80:81], v2 offset:16384
    v_mfma_f32_16x16x32_bf16 v[132:135], v[36:39], v[48:51], 0
    ds_read_b64_tr_b16 v[82:83], v2 offset:17408
    v_mfma_f32_16x16x32_bf16 v[144:147], v[40:43], v[48:51], 0
    s_add_u32 m0, s77, 0
    s_add_u32 s64, s62, 256
    buffer_load_dwordx4 v10, s[16:19], s64 offen lds
    v_mfma_f32_16x16x32_bf16 v[148:151], v[44:47], v[48:51], 0
    ds_read_b64_tr_b16 v[84:85], v3 offset:16384
    v_mfma_f32_16x16x32_bf16 v[156:159], v[44:47], v[52:55], 0
    v_mfma_f32_16x16x32_bf16 v[152:155], v[40:43], v[52:55], 0
    ds_read_b64_tr_b16 v[86:87], v3 offset:17408
    v_mfma_f32_16x16x32_bf16 v[140:143], v[36:39], v[52:55], 0
    ds_read_b64_tr_b16 v[88:89], v4 offset:16384
    s_add_u32 m0, s77, 1024
    s_add_u32 s64, s62, 8448
    buffer_load_dwordx4 v23, s[16:19], s64 offen lds
    v_mfma_f32_16x16x32_bf16 v[136:139], v[32:35], v[52:55], 0
    v_mfma_f32_16x16x32_bf16 v[160:163], v[32:35], v[56:59], 0
    ds_read_b64_tr_b16 v[90:91], v4 offset:17408
    v_mfma_f32_16x16x32_bf16 v[164:167], v[36:39], v[56:59], 0
    v_mfma_f32_16x16x32_bf16 v[176:179], v[40:43], v[56:59], 0
    ds_read_b64_tr_b16 v[92:93], v5 offset:16384
    s_add_u32 m0, s77, 2048
    s_add_u32 s64, s62, 16640
    buffer_load_dwordx4 v10, s[16:19], s64 offen lds
    v_mfma_f32_16x16x32_bf16 v[180:183], v[44:47], v[56:59], 0
    ds_read_b64_tr_b16 v[94:95], v5 offset:17408
    v_mfma_f32_16x16x32_bf16 v[188:191], v[44:47], v[60:63], 0
    v_mfma_f32_16x16x32_bf16 v[184:187], v[40:43], v[60:63], 0
    ds_read_b128 v[96:99], v6 offset:32768
    v_mfma_f32_16x16x32_bf16 v[172:175], v[36:39], v[60:63], 0
    s_add_u32 m0, s77, 3072
    s_add_u32 s64, s62, 24832
    buffer_load_dwordx4 v23, s[16:19], s64 offen lds
    v_mfma_f32_16x16x32_bf16 v[168:171], v[32:35], v[60:63], 0
    ds_read_b128 v[100:103], v6 offset:34816
    v_mfma_f32_16x16x32_bf16 v[192:195], v[32:35], v[64:67], 0
    ds_read_b128 v[104:107], v6 offset:36864
    v_mfma_f32_16x16x32_bf16 v[196:199], v[36:39], v[64:67], 0
    v_mfma_f32_16x16x32_bf16 v[208:211], v[40:43], v[64:67], 0
    ds_read_b128 v[108:111], v6 offset:38912
    s_add_u32 m0, s61, 65536
    s_add_u32 s64, s63, 1048576
    buffer_load_dwordx4 v11, s[20:23], s64 offen nt lds
    v_mfma_f32_16x16x32_bf16 v[212:215], v[44:47], v[64:67], 0
    v_mfma_f32_16x16x32_bf16 v[220:223], v[44:47], v[68:71], 0
    ds_read_b128 v[112:115], v6 offset:40960
    v_mfma_f32_16x16x32_bf16 v[216:219], v[40:43], v[68:71], 0
    ds_read_b128 v[116:119], v6 offset:43008
    v_mfma_f32_16x16x32_bf16 v[204:207], v[36:39], v[68:71], 0
    s_add_u32 m0, s61, 73728
    s_add_u32 s64, s63, 1048576
    buffer_load_dwordx4 v11, s[24:27], s64 offen nt lds
    v_mfma_f32_16x16x32_bf16 v[200:203], v[32:35], v[68:71], 0
    ds_read_b128 v[120:123], v6 offset:45056
    v_mfma_f32_16x16x32_bf16 v[224:227], v[32:35], v[72:75], 0
    v_mfma_f32_16x16x32_bf16 v[228:231], v[36:39], v[72:75], 0
    ds_read_b128 v[124:127], v6 offset:47104
    v_mfma_f32_16x16x32_bf16 v[240:243], v[40:43], v[72:75], 0
    s_add_u32 m0, s61, 69632
    s_add_u32 s64, s63, 1179648
    buffer_load_dwordx4 v11, s[20:23], s64 offen nt lds
    v_mfma_f32_16x16x32_bf16 v[244:247], v[44:47], v[72:75], 0
    v_mfma_f32_16x16x32_bf16 v[252:255], v[44:47], v[76:79], 0
    v_mfma_f32_16x16x32_bf16 v[248:251], v[40:43], v[76:79], 0
    v_mfma_f32_16x16x32_bf16 v[236:239], v[36:39], v[76:79], 0
    s_add_u32 m0, s61, 77824
    s_add_u32 s64, s63, 1179648
    buffer_load_dwordx4 v11, s[24:27], s64 offen nt lds
    v_mfma_f32_16x16x32_bf16 v[232:235], v[32:35], v[76:79], 0
    s_waitcnt vmcnt(8) lgkmcnt(0)
    s_barrier
    v_mfma_f32_16x16x32_bf16 v[128:131], v[80:83], v[96:99], v[128:131]
    ds_read_b64_tr_b16 v[32:33], v2 offset:32768
    v_mfma_f32_16x16x32_bf16 v[132:135], v[84:87], v[96:99], v[132:135]
    ds_read_b64_tr_b16 v[34:35], v2 offset:33792
    v_mfma_f32_16x16x32_bf16 v[144:147], v[88:91], v[96:99], v[144:147]
    s_add_u32 m0, s77, 16384
    s_add_u32 s64, s62, 131328
    buffer_load_dwordx4 v10, s[16:19], s64 offen lds
    v_mfma_f32_16x16x32_bf16 v[148:151], v[92:95], v[96:99], v[148:151]
    ds_read_b64_tr_b16 v[36:37], v3 offset:32768
    v_mfma_f32_16x16x32_bf16 v[156:159], v[92:95], v[100:103], v[156:159]
    v_mfma_f32_16x16x32_bf16 v[152:155], v[88:91], v[100:103], v[152:155]
    ds_read_b64_tr_b16 v[38:39], v3 offset:33792
    v_mfma_f32_16x16x32_bf16 v[140:143], v[84:87], v[100:103], v[140:143]
    ds_read_b64_tr_b16 v[40:41], v4 offset:32768
    s_add_u32 m0, s77, 17408
    s_add_u32 s64, s62, 139520
    buffer_load_dwordx4 v23, s[16:19], s64 offen lds
    v_mfma_f32_16x16x32_bf16 v[136:139], v[80:83], v[100:103], v[136:139]
    v_mfma_f32_16x16x32_bf16 v[160:163], v[80:83], v[104:107], v[160:163]
    ds_read_b64_tr_b16 v[42:43], v4 offset:33792
    v_mfma_f32_16x16x32_bf16 v[164:167], v[84:87], v[104:107], v[164:167]
    v_mfma_f32_16x16x32_bf16 v[176:179], v[88:91], v[104:107], v[176:179]
    ds_read_b64_tr_b16 v[44:45], v5 offset:32768
    s_add_u32 m0, s77, 18432
    s_add_u32 s64, s62, 147712
    buffer_load_dwordx4 v10, s[16:19], s64 offen lds
    v_mfma_f32_16x16x32_bf16 v[180:183], v[92:95], v[104:107], v[180:183]
    ds_read_b64_tr_b16 v[46:47], v5 offset:33792
    v_mfma_f32_16x16x32_bf16 v[188:191], v[92:95], v[108:111], v[188:191]
    v_mfma_f32_16x16x32_bf16 v[184:187], v[88:91], v[108:111], v[184:187]
    ds_read_b128 v[48:51], v7 offset:0
    v_mfma_f32_16x16x32_bf16 v[172:175], v[84:87], v[108:111], v[172:175]
    s_add_u32 m0, s77, 19456
    s_add_u32 s64, s62, 155904
    buffer_load_dwordx4 v23, s[16:19], s64 offen lds
    v_mfma_f32_16x16x32_bf16 v[168:171], v[80:83], v[108:111], v[168:171]
    ds_read_b128 v[52:55], v7 offset:2048
    v_mfma_f32_16x16x32_bf16 v[192:195], v[80:83], v[112:115], v[192:195]
    ds_read_b128 v[56:59], v7 offset:4096
    v_mfma_f32_16x16x32_bf16 v[196:199], v[84:87], v[112:115], v[196:199]
    v_mfma_f32_16x16x32_bf16 v[208:211], v[88:91], v[112:115], v[208:211]
    ds_read_b128 v[60:63], v7 offset:6144
    s_add_u32 m0, s61, 81920
    s_add_u32 s64, s63, 1310720
    buffer_load_dwordx4 v11, s[20:23], s64 offen nt lds
    v_mfma_f32_16x16x32_bf16 v[212:215], v[92:95], v[112:115], v[212:215]
    v_mfma_f32_16x16x32_bf16 v[220:223], v[92:95], v[116:119], v[220:223]
    ds_read_b128 v[64:67], v7 offset:8192
    v_mfma_f32_16x16x32_bf16 v[216:219], v[88:91], v[116:119], v[216:219]
    ds_read_b128 v[68:71], v7 offset:10240
    v_mfma_f32_16x16x32_bf16 v[204:207], v[84:87], v[116:119], v[204:207]
    s_add_u32 m0, s61, 90112
    s_add_u32 s64, s63, 1310720
    buffer_load_dwordx4 v11, s[24:27], s64 offen nt lds
    v_mfma_f32_16x16x32_bf16 v[200:203], v[80:83], v[116:119], v[200:203]
    ds_read_b128 v[72:75], v7 offset:12288
    v_mfma_f32_16x16x32_bf16 v[224:227], v[80:83], v[120:123], v[224:227]
    v_mfma_f32_16x16x32_bf16 v[228:231], v[84:87], v[120:123], v[228:231]
    ds_read_b128 v[76:79], v7 offset:14336
    v_mfma_f32_16x16x32_bf16 v[240:243], v[88:91], v[120:123], v[240:243]
    s_add_u32 m0, s61, 86016
    s_add_u32 s64, s63, 1441792
    buffer_load_dwordx4 v11, s[20:23], s64 offen nt lds
    v_mfma_f32_16x16x32_bf16 v[244:247], v[92:95], v[120:123], v[244:247]
    v_mfma_f32_16x16x32_bf16 v[252:255], v[92:95], v[124:127], v[252:255]
    v_mfma_f32_16x16x32_bf16 v[248:251], v[88:91], v[124:127], v[248:251]
    v_mfma_f32_16x16x32_bf16 v[236:239], v[84:87], v[124:127], v[236:239]
    s_add_u32 m0, s61, 94208
    s_add_u32 s64, s63, 1441792
    buffer_load_dwordx4 v11, s[24:27], s64 offen nt lds
    v_mfma_f32_16x16x32_bf16 v[232:235], v[80:83], v[124:127], v[232:235]
    s_waitcnt vmcnt(16) lgkmcnt(0)
    s_barrier
    v_mfma_f32_16x16x32_bf16 v[128:131], v[32:35], v[48:51], v[128:131]
    ds_read_b64_tr_b16 v[80:81], v2 offset:49152
    v_mfma_f32_16x16x32_bf16 v[132:135], v[36:39], v[48:51], v[132:135]
    ds_read_b64_tr_b16 v[82:83], v2 offset:50176
    v_mfma_f32_16x16x32_bf16 v[144:147], v[40:43], v[48:51], v[144:147]
    s_add_u32 m0, s77, 32768
    s_add_u32 s64, s62, 384
    buffer_load_dwordx4 v10, s[16:19], s64 offen lds
    v_mfma_f32_16x16x32_bf16 v[148:151], v[44:47], v[48:51], v[148:151]
    ds_read_b64_tr_b16 v[84:85], v3 offset:49152
    v_mfma_f32_16x16x32_bf16 v[156:159], v[44:47], v[52:55], v[156:159]
    v_mfma_f32_16x16x32_bf16 v[152:155], v[40:43], v[52:55], v[152:155]
    ds_read_b64_tr_b16 v[86:87], v3 offset:50176
    v_mfma_f32_16x16x32_bf16 v[140:143], v[36:39], v[52:55], v[140:143]
    ds_read_b64_tr_b16 v[88:89], v4 offset:49152
    s_add_u32 m0, s77, 33792
    s_add_u32 s64, s62, 8576
    buffer_load_dwordx4 v23, s[16:19], s64 offen lds
    v_mfma_f32_16x16x32_bf16 v[136:139], v[32:35], v[52:55], v[136:139]
    v_mfma_f32_16x16x32_bf16 v[160:163], v[32:35], v[56:59], v[160:163]
    ds_read_b64_tr_b16 v[90:91], v4 offset:50176
    v_mfma_f32_16x16x32_bf16 v[164:167], v[36:39], v[56:59], v[164:167]
    v_mfma_f32_16x16x32_bf16 v[176:179], v[40:43], v[56:59], v[176:179]
    ds_read_b64_tr_b16 v[92:93], v5 offset:49152
    s_add_u32 m0, s77, 34816
    s_add_u32 s64, s62, 16768
    buffer_load_dwordx4 v10, s[16:19], s64 offen lds
    v_mfma_f32_16x16x32_bf16 v[180:183], v[44:47], v[56:59], v[180:183]
    ds_read_b64_tr_b16 v[94:95], v5 offset:50176
    v_mfma_f32_16x16x32_bf16 v[188:191], v[44:47], v[60:63], v[188:191]
    v_mfma_f32_16x16x32_bf16 v[184:187], v[40:43], v[60:63], v[184:187]
    ds_read_b128 v[96:99], v9 offset:0
    v_mfma_f32_16x16x32_bf16 v[172:175], v[36:39], v[60:63], v[172:175]
    s_add_u32 m0, s77, 35840
    s_add_u32 s64, s62, 24960
    buffer_load_dwordx4 v23, s[16:19], s64 offen lds
    v_mfma_f32_16x16x32_bf16 v[168:171], v[32:35], v[60:63], v[168:171]
    ds_read_b128 v[100:103], v9 offset:2048
    v_mfma_f32_16x16x32_bf16 v[192:195], v[32:35], v[64:67], v[192:195]
    ds_read_b128 v[104:107], v9 offset:4096
    v_mfma_f32_16x16x32_bf16 v[196:199], v[36:39], v[64:67], v[196:199]
    v_mfma_f32_16x16x32_bf16 v[208:211], v[40:43], v[64:67], v[208:211]
    ds_read_b128 v[108:111], v9 offset:6144
    s_add_u32 m0, s61, 98304
    s_add_u32 s64, s63, 1572864
    buffer_load_dwordx4 v11, s[20:23], s64 offen nt lds
    v_mfma_f32_16x16x32_bf16 v[212:215], v[44:47], v[64:67], v[212:215]
    v_mfma_f32_16x16x32_bf16 v[220:223], v[44:47], v[68:71], v[220:223]
    ds_read_b128 v[112:115], v9 offset:8192
    v_mfma_f32_16x16x32_bf16 v[216:219], v[40:43], v[68:71], v[216:219]
    ds_read_b128 v[116:119], v9 offset:10240
    v_mfma_f32_16x16x32_bf16 v[204:207], v[36:39], v[68:71], v[204:207]
    s_add_u32 m0, s61, 106496
    s_add_u32 s64, s63, 1572864
    buffer_load_dwordx4 v11, s[24:27], s64 offen nt lds
    v_mfma_f32_16x16x32_bf16 v[200:203], v[32:35], v[68:71], v[200:203]
    ds_read_b128 v[120:123], v9 offset:12288
    v_mfma_f32_16x16x32_bf16 v[224:227], v[32:35], v[72:75], v[224:227]
    v_mfma_f32_16x16x32_bf16 v[228:231], v[36:39], v[72:75], v[228:231]
    ds_read_b128 v[124:127], v9 offset:14336
    v_mfma_f32_16x16x32_bf16 v[240:243], v[40:43], v[72:75], v[240:243]
    s_add_u32 m0, s61, 102400
    s_add_u32 s64, s63, 1703936
    buffer_load_dwordx4 v11, s[20:23], s64 offen nt lds
    v_mfma_f32_16x16x32_bf16 v[244:247], v[44:47], v[72:75], v[244:247]
    v_mfma_f32_16x16x32_bf16 v[252:255], v[44:47], v[76:79], v[252:255]
    v_mfma_f32_16x16x32_bf16 v[248:251], v[40:43], v[76:79], v[248:251]
    v_mfma_f32_16x16x32_bf16 v[236:239], v[36:39], v[76:79], v[236:239]
    s_add_u32 m0, s61, 110592
    s_add_u32 s64, s63, 1703936
    buffer_load_dwordx4 v11, s[24:27], s64 offen nt lds
    v_mfma_f32_16x16x32_bf16 v[232:235], v[32:35], v[76:79], v[232:235]
    s_waitcnt vmcnt(8) lgkmcnt(0)
    s_barrier
    v_mfma_f32_16x16x32_bf16 v[128:131], v[80:83], v[96:99], v[128:131]
    ds_read_b64_tr_b16 v[32:33], v2 offset:0
    v_mfma_f32_16x16x32_bf16 v[132:135], v[84:87], v[96:99], v[132:135]
    ds_read_b64_tr_b16 v[34:35], v2 offset:1024
    v_mfma_f32_16x16x32_bf16 v[144:147], v[88:91], v[96:99], v[144:147]
    s_add_u32 m0, s77, 49152
    s_add_u32 s64, s62, 131456
    buffer_load_dwordx4 v10, s[16:19], s64 offen lds
    v_mfma_f32_16x16x32_bf16 v[148:151], v[92:95], v[96:99], v[148:151]
    ds_read_b64_tr_b16 v[36:37], v3 offset:0
    v_mfma_f32_16x16x32_bf16 v[156:159], v[92:95], v[100:103], v[156:159]
    v_mfma_f32_16x16x32_bf16 v[152:155], v[88:91], v[100:103], v[152:155]
    ds_read_b64_tr_b16 v[38:39], v3 offset:1024
    v_mfma_f32_16x16x32_bf16 v[140:143], v[84:87], v[100:103], v[140:143]
    ds_read_b64_tr_b16 v[40:41], v4 offset:0
    s_add_u32 m0, s77, 50176
    s_add_u32 s64, s62, 139648
    buffer_load_dwordx4 v23, s[16:19], s64 offen lds
    v_mfma_f32_16x16x32_bf16 v[136:139], v[80:83], v[100:103], v[136:139]
    v_mfma_f32_16x16x32_bf16 v[160:163], v[80:83], v[104:107], v[160:163]
    ds_read_b64_tr_b16 v[42:43], v4 offset:1024
    v_mfma_f32_16x16x32_bf16 v[164:167], v[84:87], v[104:107], v[164:167]
    v_mfma_f32_16x16x32_bf16 v[176:179], v[88:91], v[104:107], v[176:179]
    ds_read_b64_tr_b16 v[44:45], v5 offset:0
    s_add_u32 m0, s77, 51200
    s_add_u32 s64, s62, 147840
    buffer_load_dwordx4 v10, s[16:19], s64 offen lds
    v_mfma_f32_16x16x32_bf16 v[180:183], v[92:95], v[104:107], v[180:183]
    ds_read_b64_tr_b16 v[46:47], v5 offset:1024
    v_mfma_f32_16x16x32_bf16 v[188:191], v[92:95], v[108:111], v[188:191]
    v_mfma_f32_16x16x32_bf16 v[184:187], v[88:91], v[108:111], v[184:187]
    ds_read_b128 v[48:51], v1 offset:0
    v_mfma_f32_16x16x32_bf16 v[172:175], v[84:87], v[108:111], v[172:175]
    s_add_u32 m0, s77, 52224
    s_add_u32 s64, s62, 156032
    buffer_load_dwordx4 v23, s[16:19], s64 offen lds
    v_mfma_f32_16x16x32_bf16 v[168:171], v[80:83], v[108:111], v[168:171]
    ds_read_b128 v[52:55], v1 offset:2048
    v_mfma_f32_16x16x32_bf16 v[192:195], v[80:83], v[112:115], v[192:195]
    ds_read_b128 v[56:59], v1 offset:4096
    v_mfma_f32_16x16x32_bf16 v[196:199], v[84:87], v[112:115], v[196:199]
    v_mfma_f32_16x16x32_bf16 v[208:211], v[88:91], v[112:115], v[208:211]
    ds_read_b128 v[60:63], v1 offset:6144
    s_add_u32 m0, s61, 114688
    s_add_u32 s64, s63, 1835008
    buffer_load_dwordx4 v11, s[20:23], s64 offen nt lds
    v_mfma_f32_16x16x32_bf16 v[212:215], v[92:95], v[112:115], v[212:215]
    v_mfma_f32_16x16x32_bf16 v[220:223], v[92:95], v[116:119], v[220:223]
    ds_read_b128 v[64:67], v1 offset:8192
    v_mfma_f32_16x16x32_bf16 v[216:219], v[88:91], v[116:119], v[216:219]
    ds_read_b128 v[68:71], v1 offset:10240
    v_mfma_f32_16x16x32_bf16 v[204:207], v[84:87], v[116:119], v[204:207]
    s_add_u32 m0, s61, 122880
    s_add_u32 s64, s63, 1835008
    buffer_load_dwordx4 v11, s[24:27], s64 offen nt lds
    v_mfma_f32_16x16x32_bf16 v[200:203], v[80:83], v[116:119], v[200:203]
    ds_read_b128 v[72:75], v1 offset:12288
    v_mfma_f32_16x16x32_bf16 v[224:227], v[80:83], v[120:123], v[224:227]
    v_mfma_f32_16x16x32_bf16 v[228:231], v[84:87], v[120:123], v[228:231]
    ds_read_b128 v[76:79], v1 offset:14336
    v_mfma_f32_16x16x32_bf16 v[240:243], v[88:91], v[120:123], v[240:243]
    s_add_u32 m0, s61, 118784
    s_add_u32 s64, s63, 1966080
    buffer_load_dwordx4 v11, s[20:23], s64 offen nt lds
    v_mfma_f32_16x16x32_bf16 v[244:247], v[92:95], v[120:123], v[244:247]
    v_mfma_f32_16x16x32_bf16 v[252:255], v[92:95], v[124:127], v[252:255]
    v_mfma_f32_16x16x32_bf16 v[248:251], v[88:91], v[124:127], v[248:251]
    v_mfma_f32_16x16x32_bf16 v[236:239], v[84:87], v[124:127], v[236:239]
    s_add_u32 m0, s61, 126976
    s_add_u32 s64, s63, 1966080
    buffer_load_dwordx4 v11, s[24:27], s64 offen nt lds
    v_mfma_f32_16x16x32_bf16 v[232:235], v[80:83], v[124:127], v[232:235]
    s_waitcnt vmcnt(16) lgkmcnt(0)
    s_barrier
    v_mfma_f32_16x16x32_bf16 v[128:131], v[32:35], v[48:51], v[128:131]
    ds_read_b64_tr_b16 v[80:81], v2 offset:16384
    v_mfma_f32_16x16x32_bf16 v[132:135], v[36:39], v[48:51], v[132:135]
    ds_read_b64_tr_b16 v[82:83], v2 offset:17408
    v_mfma_f32_16x16x32_bf16 v[144:147], v[40:43], v[48:51], v[144:147]
    s_add_u32 m0, s77, 131072
    s_add_u32 s64, s62, 512
    buffer_load_dwordx4 v10, s[16:19], s64 offen lds
    v_mfma_f32_16x16x32_bf16 v[148:151], v[44:47], v[48:51], v[148:151]
    ds_read_b64_tr_b16 v[84:85], v3 offset:16384
    v_mfma_f32_16x16x32_bf16 v[156:159], v[44:47], v[52:55], v[156:159]
    v_mfma_f32_16x16x32_bf16 v[152:155], v[40:43], v[52:55], v[152:155]
    ds_read_b64_tr_b16 v[86:87], v3 offset:17408
    v_mfma_f32_16x16x32_bf16 v[140:143], v[36:39], v[52:55], v[140:143]
    ds_read_b64_tr_b16 v[88:89], v4 offset:16384
    s_add_u32 m0, s77, 132096
    s_add_u32 s64, s62, 8704
    buffer_load_dwordx4 v23, s[16:19], s64 offen lds
    v_mfma_f32_16x16x32_bf16 v[136:139], v[32:35], v[52:55], v[136:139]
    v_mfma_f32_16x16x32_bf16 v[160:163], v[32:35], v[56:59], v[160:163]
    ds_read_b64_tr_b16 v[90:91], v4 offset:17408
    v_mfma_f32_16x16x32_bf16 v[164:167], v[36:39], v[56:59], v[164:167]
    v_mfma_f32_16x16x32_bf16 v[176:179], v[40:43], v[56:59], v[176:179]
    ds_read_b64_tr_b16 v[92:93], v5 offset:16384
    s_add_u32 m0, s77, 133120
    s_add_u32 s64, s62, 16896
    buffer_load_dwordx4 v10, s[16:19], s64 offen lds
    v_mfma_f32_16x16x32_bf16 v[180:183], v[44:47], v[56:59], v[180:183]
    ds_read_b64_tr_b16 v[94:95], v5 offset:17408
    v_mfma_f32_16x16x32_bf16 v[188:191], v[44:47], v[60:63], v[188:191]
    v_mfma_f32_16x16x32_bf16 v[184:187], v[40:43], v[60:63], v[184:187]
    ds_read_b128 v[96:99], v6 offset:0
    v_mfma_f32_16x16x32_bf16 v[172:175], v[36:39], v[60:63], v[172:175]
    s_add_u32 m0, s77, 134144
    s_add_u32 s64, s62, 25088
    buffer_load_dwordx4 v23, s[16:19], s64 offen lds
    v_mfma_f32_16x16x32_bf16 v[168:171], v[32:35], v[60:63], v[168:171]
    ds_read_b128 v[100:103], v6 offset:2048
    v_mfma_f32_16x16x32_bf16 v[192:195], v[32:35], v[64:67], v[192:195]
    ds_read_b128 v[104:107], v6 offset:4096
    v_mfma_f32_16x16x32_bf16 v[196:199], v[36:39], v[64:67], v[196:199]
    v_mfma_f32_16x16x32_bf16 v[208:211], v[40:43], v[64:67], v[208:211]
    ds_read_b128 v[108:111], v6 offset:6144
    s_add_u32 m0, s61, 65536
    s_add_u32 s64, s63, 2097152
    buffer_load_dwordx4 v11, s[20:23], s64 offen nt lds
    v_mfma_f32_16x16x32_bf16 v[212:215], v[44:47], v[64:67], v[212:215]
    v_mfma_f32_16x16x32_bf16 v[220:223], v[44:47], v[68:71], v[220:223]
    ds_read_b128 v[112:115], v6 offset:8192
    v_mfma_f32_16x16x32_bf16 v[216:219], v[40:43], v[68:71], v[216:219]
    ds_read_b128 v[116:119], v6 offset:10240
    v_mfma_f32_16x16x32_bf16 v[204:207], v[36:39], v[68:71], v[204:207]
    s_add_u32 m0, s61, 73728
    s_add_u32 s64, s63, 2097152
    buffer_load_dwordx4 v11, s[24:27], s64 offen nt lds
    v_mfma_f32_16x16x32_bf16 v[200:203], v[32:35], v[68:71], v[200:203]
    ds_read_b128 v[120:123], v6 offset:12288
    v_mfma_f32_16x16x32_bf16 v[224:227], v[32:35], v[72:75], v[224:227]
    v_mfma_f32_16x16x32_bf16 v[228:231], v[36:39], v[72:75], v[228:231]
    ds_read_b128 v[124:127], v6 offset:14336
    v_mfma_f32_16x16x32_bf16 v[240:243], v[40:43], v[72:75], v[240:243]
    s_add_u32 m0, s61, 69632
    s_add_u32 s64, s63, 2228224
    buffer_load_dwordx4 v11, s[20:23], s64 offen nt lds
    v_mfma_f32_16x16x32_bf16 v[244:247], v[44:47], v[72:75], v[244:247]
    v_mfma_f32_16x16x32_bf16 v[252:255], v[44:47], v[76:79], v[252:255]
    v_mfma_f32_16x16x32_bf16 v[248:251], v[40:43], v[76:79], v[248:251]
    v_mfma_f32_16x16x32_bf16 v[236:239], v[36:39], v[76:79], v[236:239]
    s_add_u32 m0, s61, 77824
    s_add_u32 s64, s63, 2228224
    buffer_load_dwordx4 v11, s[24:27], s64 offen nt lds
    v_mfma_f32_16x16x32_bf16 v[232:235], v[32:35], v[76:79], v[232:235]
    s_waitcnt vmcnt(8) lgkmcnt(0)
    s_barrier
    v_mfma_f32_16x16x32_bf16 v[128:131], v[80:83], v[96:99], v[128:131]
    ds_read_b64_tr_b16 v[32:33], v2 offset:32768
    v_mfma_f32_16x16x32_bf16 v[132:135], v[84:87], v[96:99], v[132:135]
    ds_read_b64_tr_b16 v[34:35], v2 offset:33792
    v_mfma_f32_16x16x32_bf16 v[144:147], v[88:91], v[96:99], v[144:147]
    s_add_u32 m0, s77, 147456
    s_add_u32 s64, s62, 131584
    buffer_load_dwordx4 v10, s[16:19], s64 offen lds
    v_mfma_f32_16x16x32_bf16 v[148:151], v[92:95], v[96:99], v[148:151]
    ds_read_b64_tr_b16 v[36:37], v3 offset:32768
    v_mfma_f32_16x16x32_bf16 v[156:159], v[92:95], v[100:103], v[156:159]
    v_mfma_f32_16x16x32_bf16 v[152:155], v[88:91], v[100:103], v[152:155]
    ds_read_b64_tr_b16 v[38:39], v3 offset:33792
    v_mfma_f32_16x16x32_bf16 v[140:143], v[84:87], v[100:103], v[140:143]
    ds_read_b64_tr_b16 v[40:41], v4 offset:32768
    s_add_u32 m0, s77, 148480
    s_add_u32 s64, s62, 139776
    buffer_load_dwordx4 v23, s[16:19], s64 offen lds
    v_mfma_f32_16x16x32_bf16 v[136:139], v[80:83], v[100:103], v[136:139]
    v_mfma_f32_16x16x32_bf16 v[160:163], v[80:83], v[104:107], v[160:163]
    ds_read_b64_tr_b16 v[42:43], v4 offset:33792
    v_mfma_f32_16x16x32_bf16 v[164:167], v[84:87], v[104:107], v[164:167]
    v_mfma_f32_16x16x32_bf16 v[176:179], v[88:91], v[104:107], v[176:179]
    ds_read_b64_tr_b16 v[44:45], v5 offset:32768
    s_add_u32 m0, s77, 149504
    s_add_u32 s64, s62, 147968
    buffer_load_dwordx4 v10, s[16:19], s64 offen lds
    v_mfma_f32_16x16x32_bf16 v[180:183], v[92:95], v[104:107], v[180:183]
    ds_read_b64_tr_b16 v[46:47], v5 offset:33792
    v_mfma_f32_16x16x32_bf16 v[188:191], v[92:95], v[108:111], v[188:191]
    v_mfma_f32_16x16x32_bf16 v[184:187], v[88:91], v[108:111], v[184:187]
    ds_read_b128 v[48:51], v1 offset:32768
    v_mfma_f32_16x16x32_bf16 v[172:175], v[84:87], v[108:111], v[172:175]
    s_add_u32 m0, s77, 150528
    s_add_u32 s64, s62, 156160
    buffer_load_dwordx4 v23, s[16:19], s64 offen lds
    v_mfma_f32_16x16x32_bf16 v[168:171], v[80:83], v[108:111], v[168:171]
    ds_read_b128 v[52:55], v1 offset:34816
    v_mfma_f32_16x16x32_bf16 v[192:195], v[80:83], v[112:115], v[192:195]
    ds_read_b128 v[56:59], v1 offset:36864
    v_mfma_f32_16x16x32_bf16 v[196:199], v[84:87], v[112:115], v[196:199]
    v_mfma_f32_16x16x32_bf16 v[208:211], v[88:91], v[112:115], v[208:211]
    ds_read_b128 v[60:63], v1 offset:38912
    s_add_u32 m0, s61, 81920
    s_add_u32 s64, s63, 2359296
    buffer_load_dwordx4 v11, s[20:23], s64 offen nt lds
    v_mfma_f32_16x16x32_bf16 v[212:215], v[92:95], v[112:115], v[212:215]
    v_mfma_f32_16x16x32_bf16 v[220:223], v[92:95], v[116:119], v[220:223]
    ds_read_b128 v[64:67], v1 offset:40960
    v_mfma_f32_16x16x32_bf16 v[216:219], v[88:91], v[116:119], v[216:219]
    ds_read_b128 v[68:71], v1 offset:43008
    v_mfma_f32_16x16x32_bf16 v[204:207], v[84:87], v[116:119], v[204:207]
    s_add_u32 m0, s61, 90112
    s_add_u32 s64, s63, 2359296
    buffer_load_dwordx4 v11, s[24:27], s64 offen nt lds
    v_mfma_f32_16x16x32_bf16 v[200:203], v[80:83], v[116:119], v[200:203]
    ds_read_b128 v[72:75], v1 offset:45056
    v_mfma_f32_16x16x32_bf16 v[224:227], v[80:83], v[120:123], v[224:227]
    v_mfma_f32_16x16x32_bf16 v[228:231], v[84:87], v[120:123], v[228:231]
    ds_read_b128 v[76:79], v1 offset:47104
    v_mfma_f32_16x16x32_bf16 v[240:243], v[88:91], v[120:123], v[240:243]
    s_add_u32 m0, s61, 86016
    s_add_u32 s64, s63, 2490368
    buffer_load_dwordx4 v11, s[20:23], s64 offen nt lds
    v_mfma_f32_16x16x32_bf16 v[244:247], v[92:95], v[120:123], v[244:247]
    v_mfma_f32_16x16x32_bf16 v[252:255], v[92:95], v[124:127], v[252:255]
    v_mfma_f32_16x16x32_bf16 v[248:251], v[88:91], v[124:127], v[248:251]
    v_mfma_f32_16x16x32_bf16 v[236:239], v[84:87], v[124:127], v[236:239]
    s_add_u32 m0, s61, 94208
    s_add_u32 s64, s63, 2490368
    buffer_load_dwordx4 v11, s[24:27], s64 offen nt lds
    v_mfma_f32_16x16x32_bf16 v[232:235], v[80:83], v[124:127], v[232:235]
    s_waitcnt vmcnt(16) lgkmcnt(0)
    s_barrier
    v_mfma_f32_16x16x32_bf16 v[128:131], v[32:35], v[48:51], v[128:131]
    ds_read_b64_tr_b16 v[80:81], v2 offset:49152
    v_mfma_f32_16x16x32_bf16 v[132:135], v[36:39], v[48:51], v[132:135]
    ds_read_b64_tr_b16 v[82:83], v2 offset:50176
    v_mfma_f32_16x16x32_bf16 v[144:147], v[40:43], v[48:51], v[144:147]
    s_add_u32 m0, s77, 0
    s_add_u32 s64, s62, 640
    buffer_load_dwordx4 v10, s[16:19], s64 offen lds
    v_mfma_f32_16x16x32_bf16 v[148:151], v[44:47], v[48:51], v[148:151]
    ds_read_b64_tr_b16 v[84:85], v3 offset:49152
    v_mfma_f32_16x16x32_bf16 v[156:159], v[44:47], v[52:55], v[156:159]
    v_mfma_f32_16x16x32_bf16 v[152:155], v[40:43], v[52:55], v[152:155]
    ds_read_b64_tr_b16 v[86:87], v3 offset:50176
    v_mfma_f32_16x16x32_bf16 v[140:143], v[36:39], v[52:55], v[140:143]
    ds_read_b64_tr_b16 v[88:89], v4 offset:49152
    s_add_u32 m0, s77, 1024
    s_add_u32 s64, s62, 8832
    buffer_load_dwordx4 v23, s[16:19], s64 offen lds
    v_mfma_f32_16x16x32_bf16 v[136:139], v[32:35], v[52:55], v[136:139]
    v_mfma_f32_16x16x32_bf16 v[160:163], v[32:35], v[56:59], v[160:163]
    ds_read_b64_tr_b16 v[90:91], v4 offset:50176
    v_mfma_f32_16x16x32_bf16 v[164:167], v[36:39], v[56:59], v[164:167]
    v_mfma_f32_16x16x32_bf16 v[176:179], v[40:43], v[56:59], v[176:179]
    ds_read_b64_tr_b16 v[92:93], v5 offset:49152
    s_add_u32 m0, s77, 2048
    s_add_u32 s64, s62, 17024
    buffer_load_dwordx4 v10, s[16:19], s64 offen lds
    v_mfma_f32_16x16x32_bf16 v[180:183], v[44:47], v[56:59], v[180:183]
    ds_read_b64_tr_b16 v[94:95], v5 offset:50176
    v_mfma_f32_16x16x32_bf16 v[188:191], v[44:47], v[60:63], v[188:191]
    v_mfma_f32_16x16x32_bf16 v[184:187], v[40:43], v[60:63], v[184:187]
    ds_read_b128 v[96:99], v6 offset:32768
    v_mfma_f32_16x16x32_bf16 v[172:175], v[36:39], v[60:63], v[172:175]
    s_add_u32 m0, s77, 3072
    s_add_u32 s64, s62, 25216
    buffer_load_dwordx4 v23, s[16:19], s64 offen lds
    v_mfma_f32_16x16x32_bf16 v[168:171], v[32:35], v[60:63], v[168:171]
    ds_read_b128 v[100:103], v6 offset:34816
    v_mfma_f32_16x16x32_bf16 v[192:195], v[32:35], v[64:67], v[192:195]
    ds_read_b128 v[104:107], v6 offset:36864
    v_mfma_f32_16x16x32_bf16 v[196:199], v[36:39], v[64:67], v[196:199]
    v_mfma_f32_16x16x32_bf16 v[208:211], v[40:43], v[64:67], v[208:211]
    ds_read_b128 v[108:111], v6 offset:38912
    s_add_u32 m0, s61, 98304
    s_add_u32 s64, s63, 2621440
    buffer_load_dwordx4 v11, s[20:23], s64 offen nt lds
    v_mfma_f32_16x16x32_bf16 v[212:215], v[44:47], v[64:67], v[212:215]
    v_mfma_f32_16x16x32_bf16 v[220:223], v[44:47], v[68:71], v[220:223]
    ds_read_b128 v[112:115], v6 offset:40960
    v_mfma_f32_16x16x32_bf16 v[216:219], v[40:43], v[68:71], v[216:219]
    ds_read_b128 v[116:119], v6 offset:43008
    v_mfma_f32_16x16x32_bf16 v[204:207], v[36:39], v[68:71], v[204:207]
    s_add_u32 m0, s61, 106496
    s_add_u32 s64, s63, 2621440
    buffer_load_dwordx4 v11, s[24:27], s64 offen nt lds
    v_mfma_f32_16x16x32_bf16 v[200:203], v[32:35], v[68:71], v[200:203]
    ds_read_b128 v[120:123], v6 offset:45056
    v_mfma_f32_16x16x32_bf16 v[224:227], v[32:35], v[72:75], v[224:227]
    v_mfma_f32_16x16x32_bf16 v[228:231], v[36:39], v[72:75], v[228:231]
    ds_read_b128 v[124:127], v6 offset:47104
    v_mfma_f32_16x16x32_bf16 v[240:243], v[40:43], v[72:75], v[240:243]
    s_add_u32 m0, s61, 102400
    s_add_u32 s64, s63, 2752512
    buffer_load_dwordx4 v11, s[20:23], s64 offen nt lds
    v_mfma_f32_16x16x32_bf16 v[244:247], v[44:47], v[72:75], v[244:247]
    v_mfma_f32_16x16x32_bf16 v[252:255], v[44:47], v[76:79], v[252:255]
    v_mfma_f32_16x16x32_bf16 v[248:251], v[40:43], v[76:79], v[248:251]
    v_mfma_f32_16x16x32_bf16 v[236:239], v[36:39], v[76:79], v[236:239]
    s_add_u32 m0, s61, 110592
    s_add_u32 s64, s63, 2752512
    buffer_load_dwordx4 v11, s[24:27], s64 offen nt lds
    v_mfma_f32_16x16x32_bf16 v[232:235], v[32:35], v[76:79], v[232:235]
    s_waitcnt vmcnt(8) lgkmcnt(0)
    s_barrier
    v_mfma_f32_16x16x32_bf16 v[128:131], v[80:83], v[96:99], v[128:131]
    ds_read_b64_tr_b16 v[32:33], v2 offset:0
    v_mfma_f32_16x16x32_bf16 v[132:135], v[84:87], v[96:99], v[132:135]
    ds_read_b64_tr_b16 v[34:35], v2 offset:1024
    v_mfma_f32_16x16x32_bf16 v[144:147], v[88:91], v[96:99], v[144:147]
    s_add_u32 m0, s77, 16384
    s_add_u32 s64, s62, 131712
    buffer_load_dwordx4 v10, s[16:19], s64 offen lds
    v_mfma_f32_16x16x32_bf16 v[148:151], v[92:95], v[96:99], v[148:151]
    ds_read_b64_tr_b16 v[36:37], v3 offset:0
    v_mfma_f32_16x16x32_bf16 v[156:159], v[92:95], v[100:103], v[156:159]
    v_mfma_f32_16x16x32_bf16 v[152:155], v[88:91], v[100:103], v[152:155]
    ds_read_b64_tr_b16 v[38:39], v3 offset:1024
    v_mfma_f32_16x16x32_bf16 v[140:143], v[84:87], v[100:103], v[140:143]
    ds_read_b64_tr_b16 v[40:41], v4 offset:0
    s_add_u32 m0, s77, 17408
    s_add_u32 s64, s62, 139904
    buffer_load_dwordx4 v23, s[16:19], s64 offen lds
    v_mfma_f32_16x16x32_bf16 v[136:139], v[80:83], v[100:103], v[136:139]
    v_mfma_f32_16x16x32_bf16 v[160:163], v[80:83], v[104:107], v[160:163]
    ds_read_b64_tr_b16 v[42:43], v4 offset:1024
    v_mfma_f32_16x16x32_bf16 v[164:167], v[84:87], v[104:107], v[164:167]
    v_mfma_f32_16x16x32_bf16 v[176:179], v[88:91], v[104:107], v[176:179]
    ds_read_b64_tr_b16 v[44:45], v5 offset:0
    s_add_u32 m0, s77, 18432
    s_add_u32 s64, s62, 148096
    buffer_load_dwordx4 v10, s[16:19], s64 offen lds
    v_mfma_f32_16x16x32_bf16 v[180:183], v[92:95], v[104:107], v[180:183]
    ds_read_b64_tr_b16 v[46:47], v5 offset:1024
    v_mfma_f32_16x16x32_bf16 v[188:191], v[92:95], v[108:111], v[188:191]
    v_mfma_f32_16x16x32_bf16 v[184:187], v[88:91], v[108:111], v[184:187]
    ds_read_b128 v[48:51], v7 offset:0
    v_mfma_f32_16x16x32_bf16 v[172:175], v[84:87], v[108:111], v[172:175]
    s_add_u32 m0, s77, 19456
    s_add_u32 s64, s62, 156288
    buffer_load_dwordx4 v23, s[16:19], s64 offen lds
    v_mfma_f32_16x16x32_bf16 v[168:171], v[80:83], v[108:111], v[168:171]
    ds_read_b128 v[52:55], v7 offset:2048
    v_mfma_f32_16x16x32_bf16 v[192:195], v[80:83], v[112:115], v[192:195]
    ds_read_b128 v[56:59], v7 offset:4096
    v_mfma_f32_16x16x32_bf16 v[196:199], v[84:87], v[112:115], v[196:199]
    v_mfma_f32_16x16x32_bf16 v[208:211], v[88:91], v[112:115], v[208:211]
    ds_read_b128 v[60:63], v7 offset:6144
    s_add_u32 m0, s61, 114688
    s_add_u32 s64, s63, 2883584
    buffer_load_dwordx4 v11, s[20:23], s64 offen nt lds
    v_mfma_f32_16x16x32_bf16 v[212:215], v[92:95], v[112:115], v[212:215]
    v_mfma_f32_16x16x32_bf16 v[220:223], v[92:95], v[116:119], v[220:223]
    ds_read_b128 v[64:67], v7 offset:8192
    v_mfma_f32_16x16x32_bf16 v[216:219], v[88:91], v[116:119], v[216:219]
    ds_read_b128 v[68:71], v7 offset:10240
    v_mfma_f32_16x16x32_bf16 v[204:207], v[84:87], v[116:119], v[204:207]
    s_add_u32 m0, s61, 122880
    s_add_u32 s64, s63, 2883584
    buffer_load_dwordx4 v11, s[24:27], s64 offen nt lds
    v_mfma_f32_16x16x32_bf16 v[200:203], v[80:83], v[116:119], v[200:203]
    ds_read_b128 v[72:75], v7 offset:12288
    v_mfma_f32_16x16x32_bf16 v[224:227], v[80:83], v[120:123], v[224:227]
    v_mfma_f32_16x16x32_bf16 v[228:231], v[84:87], v[120:123], v[228:231]
    ds_read_b128 v[76:79], v7 offset:14336
    v_mfma_f32_16x16x32_bf16 v[240:243], v[88:91], v[120:123], v[240:243]
    s_add_u32 m0, s61, 118784
    s_add_u32 s64, s63, 3014656
    buffer_load_dwordx4 v11, s[20:23], s64 offen nt lds
    v_mfma_f32_16x16x32_bf16 v[244:247], v[92:95], v[120:123], v[244:247]
    v_mfma_f32_16x16x32_bf16 v[252:255], v[92:95], v[124:127], v[252:255]
    v_mfma_f32_16x16x32_bf16 v[248:251], v[88:91], v[124:127], v[248:251]
    v_mfma_f32_16x16x32_bf16 v[236:239], v[84:87], v[124:127], v[236:239]
    s_add_u32 m0, s61, 126976
    s_add_u32 s64, s63, 3014656
    buffer_load_dwordx4 v11, s[24:27], s64 offen nt lds
    v_mfma_f32_16x16x32_bf16 v[232:235], v[80:83], v[124:127], v[232:235]
    s_waitcnt vmcnt(16) lgkmcnt(0)
    s_barrier
    v_mfma_f32_16x16x32_bf16 v[128:131], v[32:35], v[48:51], v[128:131]
    ds_read_b64_tr_b16 v[80:81], v2 offset:16384
    v_mfma_f32_16x16x32_bf16 v[132:135], v[36:39], v[48:51], v[132:135]
    ds_read_b64_tr_b16 v[82:83], v2 offset:17408
    v_mfma_f32_16x16x32_bf16 v[144:147], v[40:43], v[48:51], v[144:147]
    s_add_u32 m0, s77, 32768
    s_add_u32 s64, s62, 768
    buffer_load_dwordx4 v10, s[16:19], s64 offen lds
    v_mfma_f32_16x16x32_bf16 v[148:151], v[44:47], v[48:51], v[148:151]
    ds_read_b64_tr_b16 v[84:85], v3 offset:16384
    v_mfma_f32_16x16x32_bf16 v[156:159], v[44:47], v[52:55], v[156:159]
    v_mfma_f32_16x16x32_bf16 v[152:155], v[40:43], v[52:55], v[152:155]
    ds_read_b64_tr_b16 v[86:87], v3 offset:17408
    v_mfma_f32_16x16x32_bf16 v[140:143], v[36:39], v[52:55], v[140:143]
    ds_read_b64_tr_b16 v[88:89], v4 offset:16384
    s_add_u32 m0, s77, 33792
    s_add_u32 s64, s62, 8960
    buffer_load_dwordx4 v23, s[16:19], s64 offen lds
    v_mfma_f32_16x16x32_bf16 v[136:139], v[32:35], v[52:55], v[136:139]
    v_mfma_f32_16x16x32_bf16 v[160:163], v[32:35], v[56:59], v[160:163]
    ds_read_b64_tr_b16 v[90:91], v4 offset:17408
    v_mfma_f32_16x16x32_bf16 v[164:167], v[36:39], v[56:59], v[164:167]
    v_mfma_f32_16x16x32_bf16 v[176:179], v[40:43], v[56:59], v[176:179]
    ds_read_b64_tr_b16 v[92:93], v5 offset:16384
    s_add_u32 m0, s77, 34816
    s_add_u32 s64, s62, 17152
    buffer_load_dwordx4 v10, s[16:19], s64 offen lds
    v_mfma_f32_16x16x32_bf16 v[180:183], v[44:47], v[56:59], v[180:183]
    ds_read_b64_tr_b16 v[94:95], v5 offset:17408
    v_mfma_f32_16x16x32_bf16 v[188:191], v[44:47], v[60:63], v[188:191]
    v_mfma_f32_16x16x32_bf16 v[184:187], v[40:43], v[60:63], v[184:187]
    ds_read_b128 v[96:99], v9 offset:0
    v_mfma_f32_16x16x32_bf16 v[172:175], v[36:39], v[60:63], v[172:175]
    s_add_u32 m0, s77, 35840
    s_add_u32 s64, s62, 25344
    buffer_load_dwordx4 v23, s[16:19], s64 offen lds
    v_mfma_f32_16x16x32_bf16 v[168:171], v[32:35], v[60:63], v[168:171]
    ds_read_b128 v[100:103], v9 offset:2048
    v_mfma_f32_16x16x32_bf16 v[192:195], v[32:35], v[64:67], v[192:195]
    ds_read_b128 v[104:107], v9 offset:4096
    v_mfma_f32_16x16x32_bf16 v[196:199], v[36:39], v[64:67], v[196:199]
    v_mfma_f32_16x16x32_bf16 v[208:211], v[40:43], v[64:67], v[208:211]
    ds_read_b128 v[108:111], v9 offset:6144
    s_add_u32 m0, s61, 65536
    s_add_u32 s64, s63, 3145728
    buffer_load_dwordx4 v11, s[20:23], s64 offen nt lds
    v_mfma_f32_16x16x32_bf16 v[212:215], v[44:47], v[64:67], v[212:215]
    v_mfma_f32_16x16x32_bf16 v[220:223], v[44:47], v[68:71], v[220:223]
    ds_read_b128 v[112:115], v9 offset:8192
    v_mfma_f32_16x16x32_bf16 v[216:219], v[40:43], v[68:71], v[216:219]
    ds_read_b128 v[116:119], v9 offset:10240
    v_mfma_f32_16x16x32_bf16 v[204:207], v[36:39], v[68:71], v[204:207]
    s_add_u32 m0, s61, 73728
    s_add_u32 s64, s63, 3145728
    buffer_load_dwordx4 v11, s[24:27], s64 offen nt lds
    v_mfma_f32_16x16x32_bf16 v[200:203], v[32:35], v[68:71], v[200:203]
    ds_read_b128 v[120:123], v9 offset:12288
    v_mfma_f32_16x16x32_bf16 v[224:227], v[32:35], v[72:75], v[224:227]
    v_mfma_f32_16x16x32_bf16 v[228:231], v[36:39], v[72:75], v[228:231]
    ds_read_b128 v[124:127], v9 offset:14336
    v_mfma_f32_16x16x32_bf16 v[240:243], v[40:43], v[72:75], v[240:243]
    s_add_u32 m0, s61, 69632
    s_add_u32 s64, s63, 3276800
    buffer_load_dwordx4 v11, s[20:23], s64 offen nt lds
    v_mfma_f32_16x16x32_bf16 v[244:247], v[44:47], v[72:75], v[244:247]
    v_mfma_f32_16x16x32_bf16 v[252:255], v[44:47], v[76:79], v[252:255]
    v_mfma_f32_16x16x32_bf16 v[248:251], v[40:43], v[76:79], v[248:251]
    v_mfma_f32_16x16x32_bf16 v[236:239], v[36:39], v[76:79], v[236:239]
    s_add_u32 m0, s61, 77824
    s_add_u32 s64, s63, 3276800
    buffer_load_dwordx4 v11, s[24:27], s64 offen nt lds
    v_mfma_f32_16x16x32_bf16 v[232:235], v[32:35], v[76:79], v[232:235]
    s_waitcnt vmcnt(8) lgkmcnt(0)
    s_barrier
    v_mfma_f32_16x16x32_bf16 v[128:131], v[80:83], v[96:99], v[128:131]
    ds_read_b64_tr_b16 v[32:33], v2 offset:32768
    v_mfma_f32_16x16x32_bf16 v[132:135], v[84:87], v[96:99], v[132:135]
    ds_read_b64_tr_b16 v[34:35], v2 offset:33792
    v_mfma_f32_16x16x32_bf16 v[144:147], v[88:91], v[96:99], v[144:147]
    s_add_u32 m0, s77, 49152
    s_add_u32 s64, s62, 131840
    buffer_load_dwordx4 v10, s[16:19], s64 offen lds
    v_mfma_f32_16x16x32_bf16 v[148:151], v[92:95], v[96:99], v[148:151]
    ds_read_b64_tr_b16 v[36:37], v3 offset:32768
    v_mfma_f32_16x16x32_bf16 v[156:159], v[92:95], v[100:103], v[156:159]
    v_mfma_f32_16x16x32_bf16 v[152:155], v[88:91], v[100:103], v[152:155]
    ds_read_b64_tr_b16 v[38:39], v3 offset:33792
    v_mfma_f32_16x16x32_bf16 v[140:143], v[84:87], v[100:103], v[140:143]
    ds_read_b64_tr_b16 v[40:41], v4 offset:32768
    s_add_u32 m0, s77, 50176
    s_add_u32 s64, s62, 140032
    buffer_load_dwordx4 v23, s[16:19], s64 offen lds
    v_mfma_f32_16x16x32_bf16 v[136:139], v[80:83], v[100:103], v[136:139]
    v_mfma_f32_16x16x32_bf16 v[160:163], v[80:83], v[104:107], v[160:163]
    ds_read_b64_tr_b16 v[42:43], v4 offset:33792
    v_mfma_f32_16x16x32_bf16 v[164:167], v[84:87], v[104:107], v[164:167]
    v_mfma_f32_16x16x32_bf16 v[176:179], v[88:91], v[104:107], v[176:179]
    ds_read_b64_tr_b16 v[44:45], v5 offset:32768
    s_add_u32 m0, s77, 51200
    s_add_u32 s64, s62, 148224
    buffer_load_dwordx4 v10, s[16:19], s64 offen lds
    v_mfma_f32_16x16x32_bf16 v[180:183], v[92:95], v[104:107], v[180:183]
    ds_read_b64_tr_b16 v[46:47], v5 offset:33792
    v_mfma_f32_16x16x32_bf16 v[188:191], v[92:95], v[108:111], v[188:191]
    v_mfma_f32_16x16x32_bf16 v[184:187], v[88:91], v[108:111], v[184:187]
    ds_read_b128 v[48:51], v1 offset:0
    v_mfma_f32_16x16x32_bf16 v[172:175], v[84:87], v[108:111], v[172:175]
    s_add_u32 m0, s77, 52224
    s_add_u32 s64, s62, 156416
    buffer_load_dwordx4 v23, s[16:19], s64 offen lds
    v_mfma_f32_16x16x32_bf16 v[168:171], v[80:83], v[108:111], v[168:171]
    ds_read_b128 v[52:55], v1 offset:2048
    v_mfma_f32_16x16x32_bf16 v[192:195], v[80:83], v[112:115], v[192:195]
    ds_read_b128 v[56:59], v1 offset:4096
    v_mfma_f32_16x16x32_bf16 v[196:199], v[84:87], v[112:115], v[196:199]
    v_mfma_f32_16x16x32_bf16 v[208:211], v[88:91], v[112:115], v[208:211]
    ds_read_b128 v[60:63], v1 offset:6144
    s_add_u32 m0, s61, 81920
    s_add_u32 s64, s63, 3407872
    buffer_load_dwordx4 v11, s[20:23], s64 offen nt lds
    v_mfma_f32_16x16x32_bf16 v[212:215], v[92:95], v[112:115], v[212:215]
    v_mfma_f32_16x16x32_bf16 v[220:223], v[92:95], v[116:119], v[220:223]
    ds_read_b128 v[64:67], v1 offset:8192
    v_mfma_f32_16x16x32_bf16 v[216:219], v[88:91], v[116:119], v[216:219]
    ds_read_b128 v[68:71], v1 offset:10240
    v_mfma_f32_16x16x32_bf16 v[204:207], v[84:87], v[116:119], v[204:207]
    s_add_u32 m0, s61, 90112
    s_add_u32 s64, s63, 3407872
    buffer_load_dwordx4 v11, s[24:27], s64 offen nt lds
    v_mfma_f32_16x16x32_bf16 v[200:203], v[80:83], v[116:119], v[200:203]
    ds_read_b128 v[72:75], v1 offset:12288
    v_mfma_f32_16x16x32_bf16 v[224:227], v[80:83], v[120:123], v[224:227]
    v_mfma_f32_16x16x32_bf16 v[228:231], v[84:87], v[120:123], v[228:231]
    ds_read_b128 v[76:79], v1 offset:14336
    v_mfma_f32_16x16x32_bf16 v[240:243], v[88:91], v[120:123], v[240:243]
    s_add_u32 m0, s61, 86016
    s_add_u32 s64, s63, 3538944
    buffer_load_dwordx4 v11, s[20:23], s64 offen nt lds
    v_mfma_f32_16x16x32_bf16 v[244:247], v[92:95], v[120:123], v[244:247]
    v_mfma_f32_16x16x32_bf16 v[252:255], v[92:95], v[124:127], v[252:255]
    v_mfma_f32_16x16x32_bf16 v[248:251], v[88:91], v[124:127], v[248:251]
    v_mfma_f32_16x16x32_bf16 v[236:239], v[84:87], v[124:127], v[236:239]
    s_add_u32 m0, s61, 94208
    s_add_u32 s64, s63, 3538944
    buffer_load_dwordx4 v11, s[24:27], s64 offen nt lds
    v_mfma_f32_16x16x32_bf16 v[232:235], v[80:83], v[124:127], v[232:235]
    s_waitcnt vmcnt(16) lgkmcnt(0)
    s_barrier
    v_mfma_f32_16x16x32_bf16 v[128:131], v[32:35], v[48:51], v[128:131]
    ds_read_b64_tr_b16 v[80:81], v2 offset:49152
    v_mfma_f32_16x16x32_bf16 v[132:135], v[36:39], v[48:51], v[132:135]
    ds_read_b64_tr_b16 v[82:83], v2 offset:50176
    v_mfma_f32_16x16x32_bf16 v[144:147], v[40:43], v[48:51], v[144:147]
    s_add_u32 m0, s77, 131072
    s_add_u32 s64, s62, 896
    buffer_load_dwordx4 v10, s[16:19], s64 offen lds
    v_mfma_f32_16x16x32_bf16 v[148:151], v[44:47], v[48:51], v[148:151]
    ds_read_b64_tr_b16 v[84:85], v3 offset:49152
    v_mfma_f32_16x16x32_bf16 v[156:159], v[44:47], v[52:55], v[156:159]
    v_mfma_f32_16x16x32_bf16 v[152:155], v[40:43], v[52:55], v[152:155]
    ds_read_b64_tr_b16 v[86:87], v3 offset:50176
    v_mfma_f32_16x16x32_bf16 v[140:143], v[36:39], v[52:55], v[140:143]
    ds_read_b64_tr_b16 v[88:89], v4 offset:49152
    s_add_u32 m0, s77, 132096
    s_add_u32 s64, s62, 9088
    buffer_load_dwordx4 v23, s[16:19], s64 offen lds
    v_mfma_f32_16x16x32_bf16 v[136:139], v[32:35], v[52:55], v[136:139]
    v_mfma_f32_16x16x32_bf16 v[160:163], v[32:35], v[56:59], v[160:163]
    ds_read_b64_tr_b16 v[90:91], v4 offset:50176
    v_mfma_f32_16x16x32_bf16 v[164:167], v[36:39], v[56:59], v[164:167]
    v_mfma_f32_16x16x32_bf16 v[176:179], v[40:43], v[56:59], v[176:179]
    ds_read_b64_tr_b16 v[92:93], v5 offset:49152
    s_add_u32 m0, s77, 133120
    s_add_u32 s64, s62, 17280
    buffer_load_dwordx4 v10, s[16:19], s64 offen lds
    v_mfma_f32_16x16x32_bf16 v[180:183], v[44:47], v[56:59], v[180:183]
    ds_read_b64_tr_b16 v[94:95], v5 offset:50176
    v_mfma_f32_16x16x32_bf16 v[188:191], v[44:47], v[60:63], v[188:191]
    v_mfma_f32_16x16x32_bf16 v[184:187], v[40:43], v[60:63], v[184:187]
    ds_read_b128 v[96:99], v6 offset:0
    v_mfma_f32_16x16x32_bf16 v[172:175], v[36:39], v[60:63], v[172:175]
    s_add_u32 m0, s77, 134144
    s_add_u32 s64, s62, 25472
    buffer_load_dwordx4 v23, s[16:19], s64 offen lds
    v_mfma_f32_16x16x32_bf16 v[168:171], v[32:35], v[60:63], v[168:171]
    ds_read_b128 v[100:103], v6 offset:2048
    v_mfma_f32_16x16x32_bf16 v[192:195], v[32:35], v[64:67], v[192:195]
    ds_read_b128 v[104:107], v6 offset:4096
    v_mfma_f32_16x16x32_bf16 v[196:199], v[36:39], v[64:67], v[196:199]
    v_mfma_f32_16x16x32_bf16 v[208:211], v[40:43], v[64:67], v[208:211]
    ds_read_b128 v[108:111], v6 offset:6144
    s_add_u32 m0, s61, 98304
    s_add_u32 s64, s63, 3670016
    buffer_load_dwordx4 v11, s[20:23], s64 offen nt lds
    v_mfma_f32_16x16x32_bf16 v[212:215], v[44:47], v[64:67], v[212:215]
    v_mfma_f32_16x16x32_bf16 v[220:223], v[44:47], v[68:71], v[220:223]
    ds_read_b128 v[112:115], v6 offset:8192
    v_mfma_f32_16x16x32_bf16 v[216:219], v[40:43], v[68:71], v[216:219]
    ds_read_b128 v[116:119], v6 offset:10240
    v_mfma_f32_16x16x32_bf16 v[204:207], v[36:39], v[68:71], v[204:207]
    s_add_u32 m0, s61, 106496
    s_add_u32 s64, s63, 3670016
    buffer_load_dwordx4 v11, s[24:27], s64 offen nt lds
    v_mfma_f32_16x16x32_bf16 v[200:203], v[32:35], v[68:71], v[200:203]
    ds_read_b128 v[120:123], v6 offset:12288
    v_mfma_f32_16x16x32_bf16 v[224:227], v[32:35], v[72:75], v[224:227]
    v_mfma_f32_16x16x32_bf16 v[228:231], v[36:39], v[72:75], v[228:231]
    ds_read_b128 v[124:127], v6 offset:14336
    v_mfma_f32_16x16x32_bf16 v[240:243], v[40:43], v[72:75], v[240:243]
    s_add_u32 m0, s61, 102400
    s_add_u32 s64, s63, 3801088
    buffer_load_dwordx4 v11, s[20:23], s64 offen nt lds
    v_mfma_f32_16x16x32_bf16 v[244:247], v[44:47], v[72:75], v[244:247]
    v_mfma_f32_16x16x32_bf16 v[252:255], v[44:47], v[76:79], v[252:255]
    v_mfma_f32_16x16x32_bf16 v[248:251], v[40:43], v[76:79], v[248:251]
    v_mfma_f32_16x16x32_bf16 v[236:239], v[36:39], v[76:79], v[236:239]
    s_add_u32 m0, s61, 110592
    s_add_u32 s64, s63, 3801088
    buffer_load_dwordx4 v11, s[24:27], s64 offen nt lds
    v_mfma_f32_16x16x32_bf16 v[232:235], v[32:35], v[76:79], v[232:235]
    s_waitcnt vmcnt(8) lgkmcnt(0)
    s_barrier
    v_mfma_f32_16x16x32_bf16 v[128:131], v[80:83], v[96:99], v[128:131]
    ds_read_b64_tr_b16 v[32:33], v2 offset:0
    v_mfma_f32_16x16x32_bf16 v[132:135], v[84:87], v[96:99], v[132:135]
    ds_read_b64_tr_b16 v[34:35], v2 offset:1024
    v_mfma_f32_16x16x32_bf16 v[144:147], v[88:91], v[96:99], v[144:147]
    s_add_u32 m0, s77, 147456
    s_add_u32 s64, s62, 131968
    buffer_load_dwordx4 v10, s[16:19], s64 offen lds
    v_mfma_f32_16x16x32_bf16 v[148:151], v[92:95], v[96:99], v[148:151]
    ds_read_b64_tr_b16 v[36:37], v3 offset:0
    v_mfma_f32_16x16x32_bf16 v[156:159], v[92:95], v[100:103], v[156:159]
    v_mfma_f32_16x16x32_bf16 v[152:155], v[88:91], v[100:103], v[152:155]
    ds_read_b64_tr_b16 v[38:39], v3 offset:1024
    v_mfma_f32_16x16x32_bf16 v[140:143], v[84:87], v[100:103], v[140:143]
    ds_read_b64_tr_b16 v[40:41], v4 offset:0
    s_add_u32 m0, s77, 148480
    s_add_u32 s64, s62, 140160
    buffer_load_dwordx4 v23, s[16:19], s64 offen lds
    v_mfma_f32_16x16x32_bf16 v[136:139], v[80:83], v[100:103], v[136:139]
    v_mfma_f32_16x16x32_bf16 v[160:163], v[80:83], v[104:107], v[160:163]
    ds_read_b64_tr_b16 v[42:43], v4 offset:1024
    v_mfma_f32_16x16x32_bf16 v[164:167], v[84:87], v[104:107], v[164:167]
    v_mfma_f32_16x16x32_bf16 v[176:179], v[88:91], v[104:107], v[176:179]
    ds_read_b64_tr_b16 v[44:45], v5 offset:0
    s_add_u32 m0, s77, 149504
    s_add_u32 s64, s62, 148352
    buffer_load_dwordx4 v10, s[16:19], s64 offen lds
    v_mfma_f32_16x16x32_bf16 v[180:183], v[92:95], v[104:107], v[180:183]
    ds_read_b64_tr_b16 v[46:47], v5 offset:1024
    v_mfma_f32_16x16x32_bf16 v[188:191], v[92:95], v[108:111], v[188:191]
    v_mfma_f32_16x16x32_bf16 v[184:187], v[88:91], v[108:111], v[184:187]
    ds_read_b128 v[48:51], v1 offset:32768
    v_mfma_f32_16x16x32_bf16 v[172:175], v[84:87], v[108:111], v[172:175]
    s_add_u32 m0, s77, 150528
    s_add_u32 s64, s62, 156544
    buffer_load_dwordx4 v23, s[16:19], s64 offen lds
    v_mfma_f32_16x16x32_bf16 v[168:171], v[80:83], v[108:111], v[168:171]
    ds_read_b128 v[52:55], v1 offset:34816
    v_mfma_f32_16x16x32_bf16 v[192:195], v[80:83], v[112:115], v[192:195]
    ds_read_b128 v[56:59], v1 offset:36864
    v_mfma_f32_16x16x32_bf16 v[196:199], v[84:87], v[112:115], v[196:199]
    v_mfma_f32_16x16x32_bf16 v[208:211], v[88:91], v[112:115], v[208:211]
    ds_read_b128 v[60:63], v1 offset:38912
    s_add_u32 m0, s61, 114688
    s_add_u32 s64, s63, 3932160
    buffer_load_dwordx4 v11, s[20:23], s64 offen nt lds
    v_mfma_f32_16x16x32_bf16 v[212:215], v[92:95], v[112:115], v[212:215]
    v_mfma_f32_16x16x32_bf16 v[220:223], v[92:95], v[116:119], v[220:223]
    ds_read_b128 v[64:67], v1 offset:40960
    v_mfma_f32_16x16x32_bf16 v[216:219], v[88:91], v[116:119], v[216:219]
    ds_read_b128 v[68:71], v1 offset:43008
    v_mfma_f32_16x16x32_bf16 v[204:207], v[84:87], v[116:119], v[204:207]
    s_add_u32 m0, s61, 122880
    s_add_u32 s64, s63, 3932160
    buffer_load_dwordx4 v11, s[24:27], s64 offen nt lds
    v_mfma_f32_16x16x32_bf16 v[200:203], v[80:83], v[116:119], v[200:203]
    ds_read_b128 v[72:75], v1 offset:45056
    v_mfma_f32_16x16x32_bf16 v[224:227], v[80:83], v[120:123], v[224:227]
    v_mfma_f32_16x16x32_bf16 v[228:231], v[84:87], v[120:123], v[228:231]
    ds_read_b128 v[76:79], v1 offset:47104
    v_mfma_f32_16x16x32_bf16 v[240:243], v[88:91], v[120:123], v[240:243]
    s_add_u32 m0, s61, 118784
    s_add_u32 s64, s63, 4063232
    buffer_load_dwordx4 v11, s[20:23], s64 offen nt lds
    v_mfma_f32_16x16x32_bf16 v[244:247], v[92:95], v[120:123], v[244:247]
    v_mfma_f32_16x16x32_bf16 v[252:255], v[92:95], v[124:127], v[252:255]
    v_mfma_f32_16x16x32_bf16 v[248:251], v[88:91], v[124:127], v[248:251]
    v_mfma_f32_16x16x32_bf16 v[236:239], v[84:87], v[124:127], v[236:239]
    s_add_u32 m0, s61, 126976
    s_add_u32 s64, s63, 4063232
    buffer_load_dwordx4 v11, s[24:27], s64 offen nt lds
    v_mfma_f32_16x16x32_bf16 v[232:235], v[80:83], v[124:127], v[232:235]
    s_waitcnt vmcnt(16) lgkmcnt(0)
    s_barrier
    v_mfma_f32_16x16x32_bf16 v[128:131], v[32:35], v[48:51], v[128:131]
    ds_read_b64_tr_b16 v[80:81], v2 offset:16384
    v_mfma_f32_16x16x32_bf16 v[132:135], v[36:39], v[48:51], v[132:135]
    ds_read_b64_tr_b16 v[82:83], v2 offset:17408
    v_mfma_f32_16x16x32_bf16 v[144:147], v[40:43], v[48:51], v[144:147]
    s_mov_b32 s94, 0
    s_add_u32 m0, s60, 0
    s_add_u32 s64, s78, 0
    buffer_load_dwordx4 v10, s[28:31], s64 offen lds
    v_mfma_f32_16x16x32_bf16 v[148:151], v[44:47], v[48:51], v[148:151]
    ds_read_b64_tr_b16 v[84:85], v3 offset:16384
    v_mfma_f32_16x16x32_bf16 v[156:159], v[44:47], v[52:55], v[156:159]
    v_mfma_f32_16x16x32_bf16 v[152:155], v[40:43], v[52:55], v[152:155]
    ds_read_b64_tr_b16 v[86:87], v3 offset:17408
    v_mfma_f32_16x16x32_bf16 v[140:143], v[36:39], v[52:55], v[140:143]
    ds_read_b64_tr_b16 v[88:89], v4 offset:16384
    s_add_u32 m0, s60, 1024
    s_add_u32 s64, s78, 8192
    buffer_load_dwordx4 v23, s[28:31], s64 offen lds
    v_mfma_f32_16x16x32_bf16 v[136:139], v[32:35], v[52:55], v[136:139]
    v_mfma_f32_16x16x32_bf16 v[160:163], v[32:35], v[56:59], v[160:163]
    ds_read_b64_tr_b16 v[90:91], v4 offset:17408
    v_mfma_f32_16x16x32_bf16 v[164:167], v[36:39], v[56:59], v[164:167]
    v_mfma_f32_16x16x32_bf16 v[176:179], v[40:43], v[56:59], v[176:179]
    ds_read_b64_tr_b16 v[92:93], v5 offset:16384
    s_add_u32 m0, s61, 65536
    s_add_u32 s64, s79, 0
    buffer_load_dwordx4 v12, s[32:35], s64 offen lds
    v_mfma_f32_16x16x32_bf16 v[180:183], v[44:47], v[56:59], v[180:183]
    ds_read_b64_tr_b16 v[94:95], v5 offset:17408
    v_mfma_f32_16x16x32_bf16 v[188:191], v[44:47], v[60:63], v[188:191]
    v_mfma_f32_16x16x32_bf16 v[184:187], v[40:43], v[60:63], v[184:187]
    ds_read_b128 v[96:99], v6 offset:32768
    v_mfma_f32_16x16x32_bf16 v[172:175], v[36:39], v[60:63], v[172:175]
    s_add_u32 m0, s61, 73728
    s_add_u32 s64, s79, 98304
    buffer_load_dwordx4 v12, s[32:35], s64 offen lds
    v_mfma_f32_16x16x32_bf16 v[168:171], v[32:35], v[60:63], v[168:171]
    ds_read_b128 v[100:103], v6 offset:34816
    v_mfma_f32_16x16x32_bf16 v[192:195], v[32:35], v[64:67], v[192:195]
    ds_read_b128 v[104:107], v6 offset:36864
    v_mfma_f32_16x16x32_bf16 v[196:199], v[36:39], v[64:67], v[196:199]
    v_mfma_f32_16x16x32_bf16 v[208:211], v[40:43], v[64:67], v[208:211]
    ds_read_b128 v[108:111], v6 offset:38912
    s_add_u32 m0, s60, 8192
    s_add_u32 s64, s78, 65536
    buffer_load_dwordx4 v10, s[28:31], s64 offen lds
    v_mfma_f32_16x16x32_bf16 v[212:215], v[44:47], v[64:67], v[212:215]
    v_mfma_f32_16x16x32_bf16 v[220:223], v[44:47], v[68:71], v[220:223]
    ds_read_b128 v[112:115], v6 offset:40960
    v_mfma_f32_16x16x32_bf16 v[216:219], v[40:43], v[68:71], v[216:219]
    ds_read_b128 v[116:119], v6 offset:43008
    v_mfma_f32_16x16x32_bf16 v[204:207], v[36:39], v[68:71], v[204:207]
    s_add_u32 m0, s60, 9216
    s_add_u32 s64, s78, 73728
    buffer_load_dwordx4 v23, s[28:31], s64 offen lds
    v_mfma_f32_16x16x32_bf16 v[200:203], v[32:35], v[68:71], v[200:203]
    ds_read_b128 v[120:123], v6 offset:45056
    v_mfma_f32_16x16x32_bf16 v[224:227], v[32:35], v[72:75], v[224:227]
    v_mfma_f32_16x16x32_bf16 v[228:231], v[36:39], v[72:75], v[228:231]
    ds_read_b128 v[124:127], v6 offset:47104
    v_mfma_f32_16x16x32_bf16 v[240:243], v[40:43], v[72:75], v[240:243]
    s_add_u32 m0, s61, 69632
    s_add_u32 s64, s79, 49152
    buffer_load_dwordx4 v12, s[32:35], s64 offen lds
    v_mfma_f32_16x16x32_bf16 v[244:247], v[44:47], v[72:75], v[244:247]
    v_mfma_f32_16x16x32_bf16 v[252:255], v[44:47], v[76:79], v[252:255]
    v_mfma_f32_16x16x32_bf16 v[248:251], v[40:43], v[76:79], v[248:251]
    v_mfma_f32_16x16x32_bf16 v[236:239], v[36:39], v[76:79], v[236:239]
    s_add_u32 m0, s61, 77824
    s_add_u32 s64, s79, 147456
    buffer_load_dwordx4 v12, s[32:35], s64 offen lds
    v_mfma_f32_16x16x32_bf16 v[232:235], v[32:35], v[76:79], v[232:235]
    s_waitcnt vmcnt(8) lgkmcnt(0)
    s_barrier
    v_mfma_f32_16x16x32_bf16 v[128:131], v[80:83], v[96:99], v[128:131]
    ds_read_b64_tr_b16 v[32:33], v2 offset:32768
    v_mfma_f32_16x16x32_bf16 v[132:135], v[84:87], v[96:99], v[132:135]
    ds_read_b64_tr_b16 v[34:35], v2 offset:33792
    v_mfma_f32_16x16x32_bf16 v[144:147], v[88:91], v[96:99], v[144:147]
    s_add_u32 m0, s60, 16384
    s_add_u32 s64, s78, 128
    buffer_load_dwordx4 v10, s[28:31], s64 offen lds
    v_mfma_f32_16x16x32_bf16 v[148:151], v[92:95], v[96:99], v[148:151]
    ds_read_b64_tr_b16 v[36:37], v3 offset:32768
    v_mfma_f32_16x16x32_bf16 v[156:159], v[92:95], v[100:103], v[156:159]
    v_mfma_f32_16x16x32_bf16 v[152:155], v[88:91], v[100:103], v[152:155]
    ds_read_b64_tr_b16 v[38:39], v3 offset:33792
    v_mfma_f32_16x16x32_bf16 v[140:143], v[84:87], v[100:103], v[140:143]
    ds_read_b64_tr_b16 v[40:41], v4 offset:32768
    s_add_u32 m0, s60, 17408
    s_add_u32 s64, s78, 8320
    buffer_load_dwordx4 v23, s[28:31], s64 offen lds
    v_mfma_f32_16x16x32_bf16 v[136:139], v[80:83], v[100:103], v[136:139]
    v_mfma_f32_16x16x32_bf16 v[160:163], v[80:83], v[104:107], v[160:163]
    ds_read_b64_tr_b16 v[42:43], v4 offset:33792
    v_mfma_f32_16x16x32_bf16 v[164:167], v[84:87], v[104:107], v[164:167]
    v_mfma_f32_16x16x32_bf16 v[176:179], v[88:91], v[104:107], v[176:179]
    ds_read_b64_tr_b16 v[44:45], v5 offset:32768
    s_add_u32 m0, s61, 81920
    s_add_u32 s64, s79, 196608
    buffer_load_dwordx4 v12, s[32:35], s64 offen lds
    v_mfma_f32_16x16x32_bf16 v[180:183], v[92:95], v[104:107], v[180:183]
    ds_read_b64_tr_b16 v[46:47], v5 offset:33792
    v_mfma_f32_16x16x32_bf16 v[188:191], v[92:95], v[108:111], v[188:191]
    v_mfma_f32_16x16x32_bf16 v[184:187], v[88:91], v[108:111], v[184:187]
    ds_read_b128 v[48:51], v7 offset:0
    v_mfma_f32_16x16x32_bf16 v[172:175], v[84:87], v[108:111], v[172:175]
    s_add_u32 m0, s61, 90112
    s_add_u32 s64, s79, 294912
    buffer_load_dwordx4 v12, s[32:35], s64 offen lds
    v_mfma_f32_16x16x32_bf16 v[168:171], v[80:83], v[108:111], v[168:171]
    ds_read_b128 v[52:55], v7 offset:2048
    v_mfma_f32_16x16x32_bf16 v[192:195], v[80:83], v[112:115], v[192:195]
    ds_read_b128 v[56:59], v7 offset:4096
    v_mfma_f32_16x16x32_bf16 v[196:199], v[84:87], v[112:115], v[196:199]
    v_mfma_f32_16x16x32_bf16 v[208:211], v[88:91], v[112:115], v[208:211]
    ds_read_b128 v[60:63], v7 offset:6144
    s_add_u32 m0, s60, 24576
    s_add_u32 s64, s78, 65664
    buffer_load_dwordx4 v10, s[28:31], s64 offen lds
    v_mfma_f32_16x16x32_bf16 v[212:215], v[92:95], v[112:115], v[212:215]
    v_mfma_f32_16x16x32_bf16 v[220:223], v[92:95], v[116:119], v[220:223]
    ds_read_b128 v[64:67], v7 offset:8192
    v_mfma_f32_16x16x32_bf16 v[216:219], v[88:91], v[116:119], v[216:219]
    ds_read_b128 v[68:71], v7 offset:10240
    v_mfma_f32_16x16x32_bf16 v[204:207], v[84:87], v[116:119], v[204:207]
    s_add_u32 m0, s60, 25600
    s_add_u32 s64, s78, 73856
    buffer_load_dwordx4 v23, s[28:31], s64 offen lds
    v_mfma_f32_16x16x32_bf16 v[200:203], v[80:83], v[116:119], v[200:203]
    ds_read_b128 v[72:75], v7 offset:12288
    v_mfma_f32_16x16x32_bf16 v[224:227], v[80:83], v[120:123], v[224:227]
    v_mfma_f32_16x16x32_bf16 v[228:231], v[84:87], v[120:123], v[228:231]
    ds_read_b128 v[76:79], v7 offset:14336
    v_mfma_f32_16x16x32_bf16 v[240:243], v[88:91], v[120:123], v[240:243]
    s_add_u32 m0, s61, 86016
    s_add_u32 s64, s79, 245760
    buffer_load_dwordx4 v12, s[32:35], s64 offen lds
    v_mfma_f32_16x16x32_bf16 v[244:247], v[92:95], v[120:123], v[244:247]
    v_mfma_f32_16x16x32_bf16 v[252:255], v[92:95], v[124:127], v[252:255]
    v_mfma_f32_16x16x32_bf16 v[248:251], v[88:91], v[124:127], v[248:251]
    v_mfma_f32_16x16x32_bf16 v[236:239], v[84:87], v[124:127], v[236:239]
    s_add_u32 m0, s61, 94208
    s_add_u32 s64, s79, 344064
    buffer_load_dwordx4 v12, s[32:35], s64 offen lds
    v_mfma_f32_16x16x32_bf16 v[232:235], v[80:83], v[124:127], v[232:235]
    s_waitcnt vmcnt(16) lgkmcnt(0)
    s_barrier
    v_mfma_f32_16x16x32_bf16 v[128:131], v[32:35], v[48:51], v[128:131]
    ds_read_b64_tr_b16 v[80:81], v2 offset:49152
    v_mfma_f32_16x16x32_bf16 v[132:135], v[36:39], v[48:51], v[132:135]
    ds_read_b64_tr_b16 v[82:83], v2 offset:50176
    v_mfma_f32_16x16x32_bf16 v[144:147], v[40:43], v[48:51], v[144:147]
    s_add_u32 m0, s60, 32768
    s_add_u32 s64, s78, 256
    buffer_load_dwordx4 v10, s[28:31], s64 offen lds
    v_mfma_f32_16x16x32_bf16 v[148:151], v[44:47], v[48:51], v[148:151]
    ds_read_b64_tr_b16 v[84:85], v3 offset:49152
    v_mfma_f32_16x16x32_bf16 v[156:159], v[44:47], v[52:55], v[156:159]
    v_mfma_f32_16x16x32_bf16 v[152:155], v[40:43], v[52:55], v[152:155]
    ds_read_b64_tr_b16 v[86:87], v3 offset:50176
    v_mfma_f32_16x16x32_bf16 v[140:143], v[36:39], v[52:55], v[140:143]
    ds_read_b64_tr_b16 v[88:89], v4 offset:49152
    s_add_u32 m0, s60, 33792
    s_add_u32 s64, s78, 8448
    buffer_load_dwordx4 v23, s[28:31], s64 offen lds
    v_mfma_f32_16x16x32_bf16 v[136:139], v[32:35], v[52:55], v[136:139]
    v_mfma_f32_16x16x32_bf16 v[160:163], v[32:35], v[56:59], v[160:163]
    ds_read_b64_tr_b16 v[90:91], v4 offset:50176
    v_mfma_f32_16x16x32_bf16 v[164:167], v[36:39], v[56:59], v[164:167]
    v_mfma_f32_16x16x32_bf16 v[176:179], v[40:43], v[56:59], v[176:179]
    ds_read_b64_tr_b16 v[92:93], v5 offset:49152
    s_add_u32 m0, s61, 98304
    s_add_u32 s64, s79, 393216
    buffer_load_dwordx4 v12, s[32:35], s64 offen lds
    v_mfma_f32_16x16x32_bf16 v[180:183], v[44:47], v[56:59], v[180:183]
    ds_read_b64_tr_b16 v[94:95], v5 offset:50176
    v_mfma_f32_16x16x32_bf16 v[188:191], v[44:47], v[60:63], v[188:191]
    v_mfma_f32_16x16x32_bf16 v[184:187], v[40:43], v[60:63], v[184:187]
    ds_read_b128 v[96:99], v9 offset:0
    v_mfma_f32_16x16x32_bf16 v[172:175], v[36:39], v[60:63], v[172:175]
    s_add_u32 m0, s61, 106496
    s_add_u32 s64, s79, 491520
    buffer_load_dwordx4 v12, s[32:35], s64 offen lds
    v_mfma_f32_16x16x32_bf16 v[168:171], v[32:35], v[60:63], v[168:171]
    ds_read_b128 v[100:103], v9 offset:2048
    v_mfma_f32_16x16x32_bf16 v[192:195], v[32:35], v[64:67], v[192:195]
    ds_read_b128 v[104:107], v9 offset:4096
    v_mfma_f32_16x16x32_bf16 v[196:199], v[36:39], v[64:67], v[196:199]
    v_mfma_f32_16x16x32_bf16 v[208:211], v[40:43], v[64:67], v[208:211]
    ds_read_b128 v[108:111], v9 offset:6144
    s_add_u32 m0, s60, 40960
    s_add_u32 s64, s78, 65792
    buffer_load_dwordx4 v10, s[28:31], s64 offen lds
    v_mfma_f32_16x16x32_bf16 v[212:215], v[44:47], v[64:67], v[212:215]
    v_mfma_f32_16x16x32_bf16 v[220:223], v[44:47], v[68:71], v[220:223]
    ds_read_b128 v[112:115], v9 offset:8192
    v_mfma_f32_16x16x32_bf16 v[216:219], v[40:43], v[68:71], v[216:219]
    ds_read_b128 v[116:119], v9 offset:10240
    v_mfma_f32_16x16x32_bf16 v[204:207], v[36:39], v[68:71], v[204:207]
    s_add_u32 m0, s60, 41984
    s_add_u32 s64, s78, 73984
    buffer_load_dwordx4 v23, s[28:31], s64 offen lds
    v_mfma_f32_16x16x32_bf16 v[200:203], v[32:35], v[68:71], v[200:203]
    ds_read_b128 v[120:123], v9 offset:12288
    v_mfma_f32_16x16x32_bf16 v[224:227], v[32:35], v[72:75], v[224:227]
    v_mfma_f32_16x16x32_bf16 v[228:231], v[36:39], v[72:75], v[228:231]
    ds_read_b128 v[124:127], v9 offset:14336
    v_mfma_f32_16x16x32_bf16 v[240:243], v[40:43], v[72:75], v[240:243]
    s_add_u32 m0, s61, 102400
    s_add_u32 s64, s79, 442368
    buffer_load_dwordx4 v12, s[32:35], s64 offen lds
    v_mfma_f32_16x16x32_bf16 v[244:247], v[44:47], v[72:75], v[244:247]
    v_mfma_f32_16x16x32_bf16 v[252:255], v[44:47], v[76:79], v[252:255]
    v_mfma_f32_16x16x32_bf16 v[248:251], v[40:43], v[76:79], v[248:251]
    v_mfma_f32_16x16x32_bf16 v[236:239], v[36:39], v[76:79], v[236:239]
    s_add_u32 m0, s61, 110592
    s_add_u32 s64, s79, 540672
    buffer_load_dwordx4 v12, s[32:35], s64 offen lds
    v_mfma_f32_16x16x32_bf16 v[232:235], v[32:35], v[76:79], v[232:235]
    s_waitcnt vmcnt(16) lgkmcnt(0)
    s_barrier
    v_mfma_f32_16x16x32_bf16 v[252:255], v[92:95], v[124:127], v[252:255]
    v_add_u32 v1, s77, v21
    v_xor_b32 v5, 64, v1
    v_xor_b32 v2, 0, v22
    v_xor_b32 v3, 64, v22
    v_xor_b32 v4, 128, v22
    v_mfma_f32_16x16x32_bf16 v[248:251], v[88:91], v[124:127], v[248:251]
    ds_read_b128 v[44:47], v1 offset:0
    v_mfma_f32_16x16x32_bf16 v[244:247], v[92:95], v[120:123], v[244:247]
    s_add_u32 m0, s60, 49152
    s_add_u32 s64, s78, 384
    buffer_load_dwordx4 v10, s[28:31], s64 offen lds
    v_mfma_f32_16x16x32_bf16 v[240:243], v[88:91], v[120:123], v[240:243]
    ds_read_b128 v[48:51], v1 offset:2048
    v_mfma_f32_16x16x32_bf16 v[236:239], v[84:87], v[124:127], v[236:239]
    ds_read_b64_tr_b16 v[32:33], v2 offset:0
    v_mfma_f32_16x16x32_bf16 v[232:235], v[80:83], v[124:127], v[232:235]
    v_mfma_f32_16x16x32_bf16 v[228:231], v[84:87], v[120:123], v[228:231]
    ds_read_b64_tr_b16 v[34:35], v2 offset:1024
    s_add_u32 m0, s60, 50176
    s_add_u32 s64, s78, 8576
    buffer_load_dwordx4 v23, s[28:31], s64 offen lds
    v_mfma_f32_16x16x32_bf16 v[224:227], v[80:83], v[120:123], v[224:227]
    ds_read_b64_tr_b16 v[36:37], v3 offset:0
    v_mfma_f32_16x16x32_bf16 v[220:223], v[92:95], v[116:119], v[220:223]
    v_cvt_pk_bf16_f32 v255, v254, v255
    v_cvt_pk_bf16_f32 v254, v252, v253
    v_mfma_f32_16x16x32_bf16 v[216:219], v[88:91], v[116:119], v[216:219]
    v_cvt_pk_bf16_f32 v253, v250, v251
    v_cvt_pk_bf16_f32 v252, v248, v249
    ds_read_b64_tr_b16 v[38:39], v3 offset:1024
    v_mfma_f32_16x16x32_bf16 v[212:215], v[92:95], v[112:115], v[212:215]
    v_cvt_pk_bf16_f32 v251, v246, v247
    v_cvt_pk_bf16_f32 v250, v244, v245
    s_add_u32 m0, s61, 114688
    s_add_u32 s64, s79, 589824
    buffer_load_dwordx4 v12, s[32:35], s64 offen lds
    v_mfma_f32_16x16x32_bf16 v[208:211], v[88:91], v[112:115], v[208:211]
    v_cvt_pk_bf16_f32 v249, v242, v243
    v_cvt_pk_bf16_f32 v248, v240, v241
    ds_read_b64_tr_b16 v[40:41], v4 offset:0
    v_mfma_f32_16x16x32_bf16 v[204:207], v[84:87], v[116:119], v[204:207]
    v_cvt_pk_bf16_f32 v247, v238, v239
    v_cvt_pk_bf16_f32 v246, v236, v237
    ds_read_b64_tr_b16 v[42:43], v4 offset:1024
    v_mfma_f32_16x16x32_bf16 v[200:203], v[80:83], v[116:119], v[200:203]
    v_cvt_pk_bf16_f32 v245, v234, v235
    v_cvt_pk_bf16_f32 v244, v232, v233
    v_mfma_f32_16x16x32_bf16 v[196:199], v[84:87], v[112:115], v[196:199]
    v_cvt_pk_bf16_f32 v243, v230, v231
    v_cvt_pk_bf16_f32 v242, v228, v229
    ds_read_b128 v[64:67], v5 offset:0
    s_add_u32 m0, s61, 122880
    s_add_u32 s64, s79, 688128
    buffer_load_dwordx4 v12, s[32:35], s64 offen lds
    v_mfma_f32_16x16x32_bf16 v[192:195], v[80:83], v[112:115], v[192:195]
    v_cvt_pk_bf16_f32 v241, v226, v227
    v_cvt_pk_bf16_f32 v240, v224, v225
    ds_read_b128 v[68:71], v5 offset:2048
    v_mfma_f32_16x16x32_bf16 v[188:191], v[92:95], v[108:111], v[188:191]
    v_cvt_pk_bf16_f32 v239, v222, v223
    v_cvt_pk_bf16_f32 v238, v220, v221
    v_mfma_f32_16x16x32_bf16 v[184:187], v[88:91], v[108:111], v[184:187]
    v_cvt_pk_bf16_f32 v237, v218, v219
    v_cvt_pk_bf16_f32 v236, v216, v217
    ds_read_b64_tr_b16 v[52:53], v2 offset:8192
    v_mfma_f32_16x16x32_bf16 v[180:183], v[92:95], v[104:107], v[180:183]
    v_cvt_pk_bf16_f32 v235, v214, v215
    v_cvt_pk_bf16_f32 v234, v212, v213
    s_add_u32 m0, s60, 57344
    s_add_u32 s64, s78, 65920
    buffer_load_dwordx4 v10, s[28:31], s64 offen lds
    v_mfma_f32_16x16x32_bf16 v[176:179], v[88:91], v[104:107], v[176:179]
    v_cvt_pk_bf16_f32 v233, v210, v211
    v_cvt_pk_bf16_f32 v232, v208, v209
    ds_read_b64_tr_b16 v[54:55], v2 offset:9216
    v_mfma_f32_16x16x32_bf16 v[172:175], v[84:87], v[108:111], v[172:175]
    v_cvt_pk_bf16_f32 v231, v206, v207
    v_cvt_pk_bf16_f32 v230, v204, v205
    ds_read_b64_tr_b16 v[56:57], v3 offset:8192
    v_mfma_f32_16x16x32_bf16 v[168:171], v[80:83], v[108:111], v[168:171]
    v_cvt_pk_bf16_f32 v229, v202, v203
    v_cvt_pk_bf16_f32 v228, v200, v201
    v_mfma_f32_16x16x32_bf16 v[164:167], v[84:87], v[104:107], v[164:167]
    v_cvt_pk_bf16_f32 v227, v198, v199
    v_cvt_pk_bf16_f32 v226, v196, v197
    ds_read_b64_tr_b16 v[58:59], v3 offset:9216
    s_add_u32 m0, s60, 58368
    s_add_u32 s64, s78, 74112
    buffer_load_dwordx4 v23, s[28:31], s64 offen lds
    v_mfma_f32_16x16x32_bf16 v[160:163], v[80:83], v[104:107], v[160:163]
    v_cvt_pk_bf16_f32 v225, v194, v195
    v_cvt_pk_bf16_f32 v224, v192, v193
    ds_read_b64_tr_b16 v[60:61], v4 offset:8192
    v_mfma_f32_16x16x32_bf16 v[156:159], v[92:95], v[100:103], v[156:159]
    v_cvt_pk_bf16_f32 v223, v190, v191
    v_cvt_pk_bf16_f32 v222, v188, v189
    v_mfma_f32_16x16x32_bf16 v[152:155], v[88:91], v[100:103], v[152:155]
    v_cvt_pk_bf16_f32 v221, v186, v187
    v_cvt_pk_bf16_f32 v220, v184, v185
    ds_read_b64_tr_b16 v[62:63], v4 offset:9216
    v_mfma_f32_16x16x32_bf16 v[148:151], v[92:95], v[96:99], v[148:151]
    v_cvt_pk_bf16_f32 v219, v182, v183
    v_cvt_pk_bf16_f32 v218, v180, v181
    s_add_u32 m0, s61, 118784
    s_add_u32 s64, s79, 638976
    buffer_load_dwordx4 v12, s[32:35], s64 offen lds
    v_mfma_f32_16x16x32_bf16 v[144:147], v[88:91], v[96:99], v[144:147]
    v_cvt_pk_bf16_f32 v217, v178, v179
    v_cvt_pk_bf16_f32 v216, v176, v177
    v_mfma_f32_16x16x32_bf16 v[140:143], v[84:87], v[100:103], v[140:143]
    v_cvt_pk_bf16_f32 v215, v174, v175
    v_cvt_pk_bf16_f32 v214, v172, v173
    v_mfma_f32_16x16x32_bf16 v[136:139], v[80:83], v[100:103], v[136:139]
    v_cvt_pk_bf16_f32 v213, v170, v171
    v_cvt_pk_bf16_f32 v212, v168, v169
    v_mfma_f32_16x16x32_bf16 v[132:135], v[84:87], v[96:99], v[132:135]
    v_cvt_pk_bf16_f32 v211, v166, v167
    v_cvt_pk_bf16_f32 v210, v164, v165
    s_add_u32 m0, s61, 126976
    s_add_u32 s64, s79, 737280
    buffer_load_dwordx4 v12, s[32:35], s64 offen lds
    v_mfma_f32_16x16x32_bf16 v[128:131], v[80:83], v[96:99], v[128:131]
    v_cvt_pk_bf16_f32 v209, v162, v163
    v_cvt_pk_bf16_f32 v208, v160, v161
    v_cvt_pk_bf16_f32 v207, v158, v159
    v_cvt_pk_bf16_f32 v206, v156, v157
    v_cvt_pk_bf16_f32 v205, v154, v155
    v_cvt_pk_bf16_f32 v204, v152, v153
    v_cvt_pk_bf16_f32 v203, v150, v151
    v_cvt_pk_bf16_f32 v202, v148, v149
    v_cvt_pk_bf16_f32 v201, v146, v147
    v_cvt_pk_bf16_f32 v200, v144, v145
    v_cvt_pk_bf16_f32 v199, v142, v143
    v_cvt_pk_bf16_f32 v198, v140, v141
    v_cvt_pk_bf16_f32 v197, v138, v139
    v_cvt_pk_bf16_f32 v196, v136, v137
    v_cvt_pk_bf16_f32 v195, v134, v135
    v_cvt_pk_bf16_f32 v194, v132, v133
    v_cvt_pk_bf16_f32 v193, v130, v131
    v_cvt_pk_bf16_f32 v192, v128, v129
    s_lshl_b32 s58, s7, 10
    v_lshrrev_b32 v16, 4, v0
    v_and_b32 v17, 15, v0
    v_lshlrev_b32 v18, 1, v17
    v_lshl_or_b32 v18, v16, 7, v18
    buffer_load_ushort v152, v18, s[52:55], s58 offen offset:0
    buffer_load_ushort v153, v18, s[52:55], s58 offen offset:64
    buffer_load_ushort v154, v18, s[52:55], s58 offen offset:32
    buffer_load_ushort v155, v18, s[52:55], s58 offen offset:96
    s_waitcnt vmcnt(20) lgkmcnt(0)
    s_barrier
    v_mfma_f32_16x16x32_bf16 v[128:131], v[32:35], v[44:47], 0
    ds_read_b128 v[92:95], v1 offset:16384
    ds_read_b128 v[96:99], v1 offset:18432
    s_add_u32 m0, s60, 0
    s_add_u32 s64, s78, 512
    buffer_load_dwordx4 v10, s[28:31], s64 offen lds
    v_mfma_f32_16x16x32_bf16 v[128:131], v[52:55], v[64:67], v[128:131]
    ds_read_b64_tr_b16 v[80:81], v2 offset:16384
    ds_read_b64_tr_b16 v[82:83], v2 offset:17408
    v_mfma_f32_16x16x32_bf16 v[136:139], v[36:39], v[44:47], 0
    ds_read_b64_tr_b16 v[84:85], v3 offset:16384
    s_add_u32 m0, s60, 1024
    s_add_u32 s64, s78, 8704
    buffer_load_dwordx4 v23, s[28:31], s64 offen lds
    v_mfma_f32_16x16x32_bf16 v[136:139], v[56:59], v[64:67], v[136:139]
    ds_read_b64_tr_b16 v[86:87], v3 offset:17408
    ds_read_b64_tr_b16 v[88:89], v4 offset:16384
    s_add_u32 m0, s61, 65536
    s_add_u32 s64, s79, 786432
    buffer_load_dwordx4 v12, s[32:35], s64 offen lds
    v_mfma_f32_16x16x32_bf16 v[144:147], v[44:47], v[40:43], 0
    ds_read_b64_tr_b16 v[90:91], v4 offset:17408
    v_mfma_f32_16x16x32_bf16 v[144:147], v[64:67], v[60:63], v[144:147]
    ds_read_b128 v[112:115], v5 offset:16384
    ds_read_b128 v[116:119], v5 offset:18432
    s_add_u32 m0, s61, 73728
    s_add_u32 s64, s79, 884736
    buffer_load_dwordx4 v12, s[32:35], s64 offen lds
    v_mfma_f32_16x16x32_bf16 v[132:135], v[32:35], v[48:51], 0
    ds_read_b64_tr_b16 v[100:101], v2 offset:24576
    ds_read_b64_tr_b16 v[102:103], v2 offset:25600
    s_add_u32 m0, s60, 8192
    s_add_u32 s64, s78, 66048
    buffer_load_dwordx4 v10, s[28:31], s64 offen lds
    v_mfma_f32_16x16x32_bf16 v[132:135], v[52:55], v[68:71], v[132:135]
    ds_read_b64_tr_b16 v[104:105], v3 offset:24576
    v_mfma_f32_16x16x32_bf16 v[140:143], v[36:39], v[48:51], 0
    ds_read_b64_tr_b16 v[106:107], v3 offset:25600
    ds_read_b64_tr_b16 v[108:109], v4 offset:24576
    s_add_u32 m0, s60, 9216
    s_add_u32 s64, s78, 74240
    buffer_load_dwordx4 v23, s[28:31], s64 offen lds
    v_mfma_f32_16x16x32_bf16 v[140:143], v[56:59], v[68:71], v[140:143]
    ds_read_b64_tr_b16 v[110:111], v4 offset:25600
    s_add_u32 m0, s61, 69632
    s_add_u32 s64, s79, 835584
    buffer_load_dwordx4 v12, s[32:35], s64 offen lds
    v_mfma_f32_16x16x32_bf16 v[148:151], v[48:51], v[40:43], 0
    v_mfma_f32_16x16x32_bf16 v[148:151], v[68:71], v[60:63], v[148:151]
    s_add_u32 m0, s61, 77824
    s_add_u32 s64, s79, 933888
    buffer_load_dwordx4 v12, s[32:35], s64 offen lds
    s_waitcnt vmcnt(20) lgkmcnt(0)
    s_barrier
    v_mfma_f32_16x16x32_bf16 v[128:131], v[80:83], v[92:95], v[128:131]
    ds_read_b128 v[44:47], v1 offset:32768
    ds_read_b128 v[48:51], v1 offset:34816
    s_add_u32 m0, s60, 16384
    s_add_u32 s64, s78, 640
    buffer_load_dwordx4 v10, s[28:31], s64 offen lds
    v_mfma_f32_16x16x32_bf16 v[128:131], v[100:103], v[112:115], v[128:131]
    ds_read_b64_tr_b16 v[32:33], v2 offset:32768
    ds_read_b64_tr_b16 v[34:35], v2 offset:33792
    v_mfma_f32_16x16x32_bf16 v[136:139], v[84:87], v[92:95], v[136:139]
    ds_read_b64_tr_b16 v[36:37], v3 offset:32768
    s_add_u32 m0, s60, 17408
    s_add_u32 s64, s78, 8832
    buffer_load_dwordx4 v23, s[28:31], s64 offen lds
    v_mfma_f32_16x16x32_bf16 v[136:139], v[104:107], v[112:115], v[136:139]
    ds_read_b64_tr_b16 v[38:39], v3 offset:33792
    ds_read_b64_tr_b16 v[40:41], v4 offset:32768
    s_add_u32 m0, s61, 81920
    s_add_u32 s64, s79, 983040
    buffer_load_dwordx4 v12, s[32:35], s64 offen lds
    v_mfma_f32_16x16x32_bf16 v[144:147], v[92:95], v[88:91], v[144:147]
    ds_read_b64_tr_b16 v[42:43], v4 offset:33792
    s_add_u32 m0, s61, 90112
    s_add_u32 s64, s79, 1081344
    buffer_load_dwordx4 v12, s[32:35], s64 offen lds
    v_mfma_f32_16x16x32_bf16 v[144:147], v[112:115], v[108:111], v[144:147]
    ds_read_b128 v[64:67], v5 offset:32768
    ds_read_b128 v[68:71], v5 offset:34816
    v_mfma_f32_16x16x32_bf16 v[132:135], v[80:83], v[96:99], v[132:135]
    ds_read_b64_tr_b16 v[52:53], v2 offset:40960
    ds_read_b64_tr_b16 v[54:55], v2 offset:41984
    s_add_u32 m0, s60, 24576
    s_add_u32 s64, s78, 66176
    buffer_load_dwordx4 v10, s[28:31], s64 offen lds
    v_mfma_f32_16x16x32_bf16 v[132:135], v[100:103], v[116:119], v[132:135]
    ds_read_b64_tr_b16 v[56:57], v3 offset:40960
    s_add_u32 m0, s60, 25600
    s_add_u32 s64, s78, 74368
    buffer_load_dwordx4 v23, s[28:31], s64 offen lds
    v_mfma_f32_16x16x32_bf16 v[140:143], v[84:87], v[96:99], v[140:143]
    ds_read_b64_tr_b16 v[58:59], v3 offset:41984
    ds_read_b64_tr_b16 v[60:61], v4 offset:40960
    s_add_u32 m0, s61, 86016
    s_add_u32 s64, s79, 1032192
    buffer_load_dwordx4 v12, s[32:35], s64 offen lds
    v_mfma_f32_16x16x32_bf16 v[140:143], v[104:107], v[116:119], v[140:143]
    ds_read_b64_tr_b16 v[62:63], v4 offset:41984
    v_mfma_f32_16x16x32_bf16 v[148:151], v[96:99], v[88:91], v[148:151]
    s_add_u32 m0, s61, 94208
    s_add_u32 s64, s79, 1130496
    buffer_load_dwordx4 v12, s[32:35], s64 offen lds
    v_mfma_f32_16x16x32_bf16 v[148:151], v[116:119], v[108:111], v[148:151]
    v_lshlrev_b32 v16, 2, v16
    v_sub_u32 v16, v17, v16
    v_mov_b32 v17, 0x3f80
    v_mov_b32 v18, 0x3f800000
    s_waitcnt vmcnt(20) lgkmcnt(0)
    s_barrier
    v_mfma_f32_16x16x32_bf16 v[128:131], v[32:35], v[44:47], v[128:131]
    ds_read_b128 v[92:95], v1 offset:49152
    ds_read_b128 v[96:99], v1 offset:51200
    s_add_u32 m0, s60, 32768
    s_add_u32 s64, s78, 768
    buffer_load_dwordx4 v10, s[28:31], s64 offen lds
    v_mfma_f32_16x16x32_bf16 v[128:131], v[52:55], v[64:67], v[128:131]
    ds_read_b64_tr_b16 v[80:81], v2 offset:49152
    ds_read_b64_tr_b16 v[82:83], v2 offset:50176
    v_mfma_f32_16x16x32_bf16 v[136:139], v[36:39], v[44:47], v[136:139]
    ds_read_b64_tr_b16 v[84:85], v3 offset:49152
    s_add_u32 m0, s60, 33792
    s_add_u32 s64, s78, 8960
    buffer_load_dwordx4 v23, s[28:31], s64 offen lds
    v_mfma_f32_16x16x32_bf16 v[136:139], v[56:59], v[64:67], v[136:139]
    ds_read_b64_tr_b16 v[86:87], v3 offset:50176
    ds_read_b64_tr_b16 v[88:89], v4 offset:49152
    s_add_u32 m0, s61, 98304
    s_add_u32 s64, s79, 1179648
    buffer_load_dwordx4 v12, s[32:35], s64 offen lds
    v_mfma_f32_16x16x32_bf16 v[144:147], v[44:47], v[40:43], v[144:147]
    ds_read_b64_tr_b16 v[90:91], v4 offset:50176
    s_add_u32 m0, s61, 106496
    s_add_u32 s64, s79, 1277952
    buffer_load_dwordx4 v12, s[32:35], s64 offen lds
    v_mfma_f32_16x16x32_bf16 v[144:147], v[64:67], v[60:63], v[144:147]
    ds_read_b128 v[112:115], v5 offset:49152
    ds_read_b128 v[116:119], v5 offset:51200
    v_mfma_f32_16x16x32_bf16 v[132:135], v[32:35], v[48:51], v[132:135]
    ds_read_b64_tr_b16 v[100:101], v2 offset:57344
    ds_read_b64_tr_b16 v[102:103], v2 offset:58368
    s_add_u32 m0, s60, 40960
    s_add_u32 s64, s78, 66304
    buffer_load_dwordx4 v10, s[28:31], s64 offen lds
    v_mfma_f32_16x16x32_bf16 v[132:135], v[52:55], v[68:71], v[132:135]
    ds_read_b64_tr_b16 v[104:105], v3 offset:57344
    s_add_u32 m0, s60, 41984
    s_add_u32 s64, s78, 74496
    buffer_load_dwordx4 v23, s[28:31], s64 offen lds
    v_mfma_f32_16x16x32_bf16 v[140:143], v[36:39], v[48:51], v[140:143]
    ds_read_b64_tr_b16 v[106:107], v3 offset:58368
    ds_read_b64_tr_b16 v[108:109], v4 offset:57344
    s_add_u32 m0, s61, 102400
    s_add_u32 s64, s79, 1228800
    buffer_load_dwordx4 v12, s[32:35], s64 offen lds
    v_mfma_f32_16x16x32_bf16 v[140:143], v[56:59], v[68:71], v[140:143]
    ds_read_b64_tr_b16 v[110:111], v4 offset:58368
    v_mfma_f32_16x16x32_bf16 v[148:151], v[48:51], v[40:43], v[148:151]
    s_add_u32 m0, s61, 110592
    s_add_u32 s64, s79, 1327104
    buffer_load_dwordx4 v12, s[32:35], s64 offen lds
    v_mfma_f32_16x16x32_bf16 v[148:151], v[68:71], v[60:63], v[148:151]
    v_cmp_eq_u32 vcc, 0, v16
    v_mov_b32 v178, 0
    v_mov_b32 v180, 0
    v_cndmask_b32 v176, 0, v17, vcc
    s_waitcnt vmcnt(16) lgkmcnt(0)
    s_barrier
    v_mfma_f32_16x16x32_bf16 v[128:131], v[80:83], v[92:95], v[128:131]
    ds_read_b128 v[44:47], v1 offset:0
    ds_read_b128 v[48:51], v1 offset:2048
    s_add_u32 m0, s60, 49152
    s_add_u32 s64, s78, 896
    buffer_load_dwordx4 v10, s[28:31], s64 offen lds
    v_mfma_f32_16x16x32_bf16 v[128:131], v[100:103], v[112:115], v[128:131]
    ds_read_b64_tr_b16 v[32:33], v2 offset:0
    ds_read_b64_tr_b16 v[34:35], v2 offset:1024
    v_mfma_f32_16x16x32_bf16 v[136:139], v[84:87], v[92:95], v[136:139]
    ds_read_b64_tr_b16 v[36:37], v3 offset:0
    s_add_u32 m0, s60, 50176
    s_add_u32 s64, s78, 9088
    buffer_load_dwordx4 v23, s[28:31], s64 offen lds
    v_mfma_f32_16x16x32_bf16 v[136:139], v[104:107], v[112:115], v[136:139]
    ds_read_b64_tr_b16 v[38:39], v3 offset:1024
    ds_read_b64_tr_b16 v[40:41], v4 offset:0
    s_add_u32 m0, s61, 114688
    s_add_u32 s64, s79, 1376256
    buffer_load_dwordx4 v12, s[32:35], s64 offen lds
    v_mfma_f32_16x16x32_bf16 v[144:147], v[92:95], v[88:91], v[144:147]
    ds_read_b64_tr_b16 v[42:43], v4 offset:1024
    s_add_u32 m0, s61, 122880
    s_add_u32 s64, s79, 1474560
    buffer_load_dwordx4 v12, s[32:35], s64 offen lds
    v_mfma_f32_16x16x32_bf16 v[144:147], v[112:115], v[108:111], v[144:147]
    ds_read_b128 v[64:67], v5 offset:0
    ds_read_b128 v[68:71], v5 offset:2048
    v_mfma_f32_16x16x32_bf16 v[132:135], v[80:83], v[96:99], v[132:135]
    ds_read_b64_tr_b16 v[52:53], v2 offset:8192
    ds_read_b64_tr_b16 v[54:55], v2 offset:9216
    s_add_u32 m0, s60, 57344
    s_add_u32 s64, s78, 66432
    buffer_load_dwordx4 v10, s[28:31], s64 offen lds
    v_mfma_f32_16x16x32_bf16 v[132:135], v[100:103], v[116:119], v[132:135]
    ds_read_b64_tr_b16 v[56:57], v3 offset:8192
    s_add_u32 m0, s60, 58368
    s_add_u32 s64, s78, 74624
    buffer_load_dwordx4 v23, s[28:31], s64 offen lds
    v_mfma_f32_16x16x32_bf16 v[140:143], v[84:87], v[96:99], v[140:143]
    ds_read_b64_tr_b16 v[58:59], v3 offset:9216
    ds_read_b64_tr_b16 v[60:61], v4 offset:8192
    s_add_u32 m0, s61, 118784
    s_add_u32 s64, s79, 1425408
    buffer_load_dwordx4 v12, s[32:35], s64 offen lds
    v_mfma_f32_16x16x32_bf16 v[140:143], v[104:107], v[116:119], v[140:143]
    ds_read_b64_tr_b16 v[62:63], v4 offset:9216
    v_mfma_f32_16x16x32_bf16 v[148:151], v[96:99], v[88:91], v[148:151]
    s_add_u32 m0, s61, 126976
    s_add_u32 s64, s79, 1523712
    buffer_load_dwordx4 v12, s[32:35], s64 offen lds
    v_mfma_f32_16x16x32_bf16 v[148:151], v[116:119], v[108:111], v[148:151]
    v_cmp_eq_u32 vcc, 1, v16
    v_mov_b32 v184, 0x3f803f80
    v_mov_b32 v185, 0x3f803f80
    v_cndmask_b32 v176, v176, v18, vcc
    s_waitcnt vmcnt(16) lgkmcnt(0)
    s_barrier
    v_mfma_f32_16x16x32_bf16 v[128:131], v[32:35], v[44:47], v[128:131]
    ds_read_b128 v[92:95], v1 offset:16384
    ds_read_b128 v[96:99], v1 offset:18432
    s_mov_b32 s94, 0
    s_add_u32 m0, s77, 0
    s_add_u32 s64, s80, 0
    buffer_load_dwordx4 v10, s[36:39], s64 offen lds
    v_mfma_f32_16x16x32_bf16 v[128:131], v[52:55], v[64:67], v[128:131]
    ds_read_b64_tr_b16 v[80:81], v2 offset:16384
    ds_read_b64_tr_b16 v[82:83], v2 offset:17408
    v_mfma_f32_16x16x32_bf16 v[136:139], v[36:39], v[44:47], v[136:139]
    ds_read_b64_tr_b16 v[84:85], v3 offset:16384
    s_add_u32 m0, s77, 1024
    s_add_u32 s64, s80, 8192
    buffer_load_dwordx4 v23, s[36:39], s64 offen lds
    v_mfma_f32_16x16x32_bf16 v[136:139], v[56:59], v[64:67], v[136:139]
    ds_read_b64_tr_b16 v[86:87], v3 offset:17408
    ds_read_b64_tr_b16 v[88:89], v4 offset:16384
    v_mfma_f32_16x16x32_bf16 v[144:147], v[44:47], v[40:43], v[144:147]
    ds_read_b64_tr_b16 v[90:91], v4 offset:17408
    s_add_u32 m0, s77, 2048
    s_add_u32 s64, s80, 16384
    buffer_load_dwordx4 v10, s[36:39], s64 offen lds
    v_mfma_f32_16x16x32_bf16 v[144:147], v[64:67], v[60:63], v[144:147]
    ds_read_b128 v[112:115], v5 offset:16384
    ds_read_b128 v[116:119], v5 offset:18432
    v_mfma_f32_16x16x32_bf16 v[132:135], v[32:35], v[48:51], v[132:135]
    ds_read_b64_tr_b16 v[100:101], v2 offset:24576
    ds_read_b64_tr_b16 v[102:103], v2 offset:25600
    s_add_u32 m0, s77, 3072
    s_add_u32 s64, s80, 24576
    buffer_load_dwordx4 v23, s[36:39], s64 offen lds
    v_mfma_f32_16x16x32_bf16 v[132:135], v[52:55], v[68:71], v[132:135]
    ds_read_b64_tr_b16 v[104:105], v3 offset:24576
    s_add_u32 m0, s61, 65536
    s_add_u32 s64, s82, 0
    buffer_load_dwordx4 v11, s[40:43], s64 offen lds
    v_mfma_f32_16x16x32_bf16 v[140:143], v[36:39], v[48:51], v[140:143]
    ds_read_b64_tr_b16 v[106:107], v3 offset:25600
    ds_read_b64_tr_b16 v[108:109], v4 offset:24576
    v_mfma_f32_16x16x32_bf16 v[140:143], v[56:59], v[68:71], v[140:143]
    ds_read_b64_tr_b16 v[110:111], v4 offset:25600
    s_add_u32 m0, s61, 69632
    s_add_u32 s64, s82, 131072
    buffer_load_dwordx4 v11, s[40:43], s64 offen lds
    v_mfma_f32_16x16x32_bf16 v[148:151], v[48:51], v[40:43], v[148:151]
    v_mfma_f32_16x16x32_bf16 v[148:151], v[68:71], v[60:63], v[148:151]
    v_cmp_eq_u32 vcc, 2, v16
    v_mov_b32 v179, 0
    v_mov_b32 v181, 0
    v_cndmask_b32 v177, 0, v17, vcc
    s_waitcnt vmcnt(14) lgkmcnt(0)
    s_barrier
    v_mfma_f32_16x16x32_bf16 v[128:131], v[80:83], v[92:95], v[128:131]
    ds_read_b128 v[44:47], v1 offset:32768
    ds_read_b128 v[48:51], v1 offset:34816
    s_add_u32 m0, s77, 16384
    s_add_u32 s64, s81, 0
    buffer_load_dwordx4 v10, s[36:39], s64 offen lds
    v_mfma_f32_16x16x32_bf16 v[128:131], v[100:103], v[112:115], v[128:131]
    ds_read_b64_tr_b16 v[32:33], v2 offset:32768
    ds_read_b64_tr_b16 v[34:35], v2 offset:33792
    v_mfma_f32_16x16x32_bf16 v[136:139], v[84:87], v[92:95], v[136:139]
    ds_read_b64_tr_b16 v[36:37], v3 offset:32768
    s_add_u32 m0, s77, 17408
    s_add_u32 s64, s81, 8192
    buffer_load_dwordx4 v23, s[36:39], s64 offen lds
    v_mfma_f32_16x16x32_bf16 v[136:139], v[104:107], v[112:115], v[136:139]
    ds_read_b64_tr_b16 v[38:39], v3 offset:33792
    ds_read_b64_tr_b16 v[40:41], v4 offset:32768
    v_mfma_f32_16x16x32_bf16 v[144:147], v[92:95], v[88:91], v[144:147]
    ds_read_b64_tr_b16 v[42:43], v4 offset:33792
    s_add_u32 m0, s77, 18432
    s_add_u32 s64, s81, 16384
    buffer_load_dwordx4 v10, s[36:39], s64 offen lds
    v_mfma_f32_16x16x32_bf16 v[144:147], v[112:115], v[108:111], v[144:147]
    ds_read_b128 v[64:67], v5 offset:32768
    ds_read_b128 v[68:71], v5 offset:34816
    v_mfma_f32_16x16x32_bf16 v[132:135], v[80:83], v[96:99], v[132:135]
    ds_read_b64_tr_b16 v[52:53], v2 offset:40960
    ds_read_b64_tr_b16 v[54:55], v2 offset:41984
    s_add_u32 m0, s77, 19456
    s_add_u32 s64, s81, 24576
    buffer_load_dwordx4 v23, s[36:39], s64 offen lds
    v_mfma_f32_16x16x32_bf16 v[132:135], v[100:103], v[116:119], v[132:135]
    ds_read_b64_tr_b16 v[56:57], v3 offset:40960
    s_add_u32 m0, s61, 73728
    s_add_u32 s64, s82, 262144
    buffer_load_dwordx4 v11, s[40:43], s64 offen lds
    v_mfma_f32_16x16x32_bf16 v[140:143], v[84:87], v[96:99], v[140:143]
    ds_read_b64_tr_b16 v[58:59], v3 offset:41984
    ds_read_b64_tr_b16 v[60:61], v4 offset:40960
    v_mfma_f32_16x16x32_bf16 v[140:143], v[104:107], v[116:119], v[140:143]
    ds_read_b64_tr_b16 v[62:63], v4 offset:41984
    s_add_u32 m0, s61, 77824
    s_add_u32 s64, s82, 393216
    buffer_load_dwordx4 v11, s[40:43], s64 offen lds
    v_mfma_f32_16x16x32_bf16 v[148:151], v[96:99], v[88:91], v[148:151]
    v_mfma_f32_16x16x32_bf16 v[148:151], v[116:119], v[108:111], v[148:151]
    v_cmp_eq_u32 vcc, 3, v16
    v_mov_b32 v186, 0x3f803f80
    v_mov_b32 v187, 0x3f803f80
    v_cndmask_b32 v177, v177, v18, vcc
    s_waitcnt vmcnt(12) lgkmcnt(0)
    s_barrier
    v_mfma_f32_16x16x32_bf16 v[128:131], v[32:35], v[44:47], v[128:131]
    ds_read_b128 v[92:95], v1 offset:49152
    ds_read_b128 v[96:99], v1 offset:51200
    v_mfma_f32_16x16x32_bf16 v[128:131], v[52:55], v[64:67], v[128:131]
    ds_read_b64_tr_b16 v[80:81], v2 offset:49152
    ds_read_b64_tr_b16 v[82:83], v2 offset:50176
    v_mfma_f32_16x16x32_bf16 v[136:139], v[36:39], v[44:47], v[136:139]
    ds_read_b64_tr_b16 v[84:85], v3 offset:49152
    v_mfma_f32_16x16x32_bf16 v[136:139], v[56:59], v[64:67], v[136:139]
    ds_read_b64_tr_b16 v[86:87], v3 offset:50176
    ds_read_b64_tr_b16 v[88:89], v4 offset:49152
    v_mfma_f32_16x16x32_bf16 v[144:147], v[44:47], v[40:43], v[144:147]
    ds_read_b64_tr_b16 v[90:91], v4 offset:50176
    v_mfma_f32_16x16x32_bf16 v[144:147], v[64:67], v[60:63], v[144:147]
    ds_read_b128 v[112:115], v5 offset:49152
    ds_read_b128 v[116:119], v5 offset:51200
    v_mfma_f32_16x16x32_bf16 v[132:135], v[32:35], v[48:51], v[132:135]
    ds_read_b64_tr_b16 v[100:101], v2 offset:57344
    ds_read_b64_tr_b16 v[102:103], v2 offset:58368
    v_mov_b32 v182, v176
    v_mov_b32 v183, v177
    v_mfma_f32_16x16x32_bf16 v[132:135], v[52:55], v[68:71], v[132:135]
    ds_read_b64_tr_b16 v[104:105], v3 offset:57344
    v_mfma_f32_16x16x32_bf16 v[140:143], v[36:39], v[48:51], v[140:143]
    ds_read_b64_tr_b16 v[106:107], v3 offset:58368
    ds_read_b64_tr_b16 v[108:109], v4 offset:57344
    v_mfma_f32_16x16x32_bf16 v[140:143], v[56:59], v[68:71], v[140:143]
    ds_read_b64_tr_b16 v[110:111], v4 offset:58368
    v_mfma_f32_16x16x32_bf16 v[148:151], v[48:51], v[40:43], v[148:151]
    v_mfma_f32_16x16x32_bf16 v[148:151], v[68:71], v[60:63], v[148:151]
    s_waitcnt lgkmcnt(0)
    s_barrier
    v_mfma_f32_16x16x32_bf16 v[128:131], v[80:83], v[92:95], v[128:131]
    v_mfma_f32_16x16x32_bf16 v[128:131], v[100:103], v[112:115], v[128:131]
    v_mfma_f32_16x16x32_bf16 v[136:139], v[84:87], v[92:95], v[136:139]
    v_mfma_f32_16x16x32_bf16 v[136:139], v[104:107], v[112:115], v[136:139]
    v_mfma_f32_16x16x32_bf16 v[144:147], v[92:95], v[88:91], v[144:147]
    v_mfma_f32_16x16x32_bf16 v[144:147], v[112:115], v[108:111], v[144:147]
    v_mfma_f32_16x16x32_bf16 v[132:135], v[80:83], v[96:99], v[132:135]
    v_mfma_f32_16x16x32_bf16 v[132:135], v[100:103], v[116:119], v[132:135]
    v_mfma_f32_16x16x32_bf16 v[140:143], v[84:87], v[96:99], v[140:143]
    v_mfma_f32_16x16x32_bf16 v[140:143], v[104:107], v[116:119], v[140:143]
    v_mfma_f32_16x16x32_bf16 v[148:151], v[96:99], v[88:91], v[148:151]
    v_mfma_f32_16x16x32_bf16 v[148:151], v[116:119], v[108:111], v[148:151]
    s_waitcnt vmcnt(44)
    s_branch a1_epi
stream_s:
    s_add_u32 s66, s66, 18874368
    s_lshl_b32 s56, s2, 2
    s_add_u32 s56, s56, s65
    s_lshl_b32 s57, s56, 12
    s_lshl_b32 s56, s56, 11
    s_mov_b32 exec_hi, 0
    s_mov_b32 exec_lo, 0xffff
    buffer_load_dword v25, v24, s[16:19], s56 offen
    s_mov_b64 exec, -1
    s_waitcnt vmcnt(5) lgkmcnt(0)
    s_barrier
    ds_read_b64_tr_b16 v[32:33], v2 offset:0
    ds_read_b64_tr_b16 v[34:35], v2 offset:1024
    ds_read_b64_tr_b16 v[36:37], v3 offset:0
    ds_read_b64_tr_b16 v[38:39], v3 offset:1024
    ds_read_b64_tr_b16 v[40:41], v4 offset:0
    ds_read_b64_tr_b16 v[42:43], v4 offset:1024
    ds_read_b64_tr_b16 v[44:45], v5 offset:0
    ds_read_b64_tr_b16 v[46:47], v5 offset:1024
    ds_read_b128 v[48:51], v1 offset:32768
    ds_read_b128 v[52:55], v1 offset:34816
    ds_read_b128 v[56:59], v1 offset:36864
    ds_read_b128 v[60:63], v1 offset:38912
    ds_read_b128 v[64:67], v1 offset:40960
    ds_read_b128 v[68:71], v1 offset:43008
    ds_read_b128 v[72:75], v1 offset:45056
    ds_read_b128 v[76:79], v1 offset:47104
    s_waitcnt vmcnt(5) lgkmcnt(0)
    s_barrier
    v_mfma_f32_16x16x32_bf16 v[128:131], v[48:51], v[32:35], 0
    ds_read_b64_tr_b16 v[80:81], v2 offset:16384
    v_mfma_f32_16x16x32_bf16 v[136:139], v[48:51], v[36:39], 0
    ds_read_b64_tr_b16 v[82:83], v2 offset:17408
    v_mfma_f32_16x16x32_bf16 v[144:147], v[48:51], v[40:43], 0
    v_mfma_f32_16x16x32_bf16 v[152:155], v[48:51], v[44:47], 0
    ds_read_b64_tr_b16 v[84:85], v3 offset:16384
    v_mfma_f32_16x16x32_bf16 v[156:159], v[52:55], v[44:47], 0
    v_mfma_f32_16x16x32_bf16 v[148:151], v[52:55], v[40:43], 0
    ds_read_b64_tr_b16 v[86:87], v3 offset:17408
    v_mfma_f32_16x16x32_bf16 v[140:143], v[52:55], v[36:39], 0
    ds_read_b64_tr_b16 v[88:89], v4 offset:16384
    v_mfma_f32_16x16x32_bf16 v[132:135], v[52:55], v[32:35], 0
    v_mfma_f32_16x16x32_bf16 v[160:163], v[56:59], v[32:35], 0
    ds_read_b64_tr_b16 v[90:91], v4 offset:17408
    v_mfma_f32_16x16x32_bf16 v[168:171], v[56:59], v[36:39], 0
    v_mfma_f32_16x16x32_bf16 v[176:179], v[56:59], v[40:43], 0
    ds_read_b64_tr_b16 v[92:93], v5 offset:16384
    v_mfma_f32_16x16x32_bf16 v[184:187], v[56:59], v[44:47], 0
    ds_read_b64_tr_b16 v[94:95], v5 offset:17408
    v_mfma_f32_16x16x32_bf16 v[188:191], v[60:63], v[44:47], 0
    v_mfma_f32_16x16x32_bf16 v[180:183], v[60:63], v[40:43], 0
    ds_read_b128 v[96:99], v6 offset:32768
    v_mfma_f32_16x16x32_bf16 v[172:175], v[60:63], v[36:39], 0
    v_mfma_f32_16x16x32_bf16 v[164:167], v[60:63], v[32:35], 0
    ds_read_b128 v[100:103], v6 offset:34816
    v_mfma_f32_16x16x32_bf16 v[192:195], v[64:67], v[32:35], 0
    ds_read_b128 v[104:107], v6 offset:36864
    v_mfma_f32_16x16x32_bf16 v[200:203], v[64:67], v[36:39], 0
    v_mfma_f32_16x16x32_bf16 v[208:211], v[64:67], v[40:43], 0
    ds_read_b128 v[108:111], v6 offset:38912
    v_mfma_f32_16x16x32_bf16 v[216:219], v[64:67], v[44:47], 0
    v_mfma_f32_16x16x32_bf16 v[220:223], v[68:71], v[44:47], 0
    ds_read_b128 v[112:115], v6 offset:40960
    v_mfma_f32_16x16x32_bf16 v[212:215], v[68:71], v[40:43], 0
    ds_read_b128 v[116:119], v6 offset:43008
    v_mfma_f32_16x16x32_bf16 v[204:207], v[68:71], v[36:39], 0
    v_mfma_f32_16x16x32_bf16 v[196:199], v[68:71], v[32:35], 0
    ds_read_b128 v[120:123], v6 offset:45056
    v_mfma_f32_16x16x32_bf16 v[224:227], v[72:75], v[32:35], 0
    v_mfma_f32_16x16x32_bf16 v[232:235], v[72:75], v[36:39], 0
    ds_read_b128 v[124:127], v6 offset:47104
    v_mfma_f32_16x16x32_bf16 v[240:243], v[72:75], v[40:43], 0
    v_mfma_f32_16x16x32_bf16 v[248:251], v[72:75], v[44:47], 0
    v_mfma_f32_16x16x32_bf16 v[252:255], v[76:79], v[44:47], 0
    v_mfma_f32_16x16x32_bf16 v[244:247], v[76:79], v[40:43], 0
    v_mfma_f32_16x16x32_bf16 v[236:239], v[76:79], v[36:39], 0
    v_mfma_f32_16x16x32_bf16 v[228:231], v[76:79], v[32:35], 0
    s_waitcnt vmcnt(1) lgkmcnt(0)
    s_barrier
    v_mfma_f32_16x16x32_bf16 v[128:131], v[96:99], v[80:83], v[128:131]
    ds_read_b64_tr_b16 v[32:33], v2 offset:32768
    v_mfma_f32_16x16x32_bf16 v[136:139], v[96:99], v[84:87], v[136:139]
    ds_read_b64_tr_b16 v[34:35], v2 offset:33792
    v_mfma_f32_16x16x32_bf16 v[144:147], v[96:99], v[88:91], v[144:147]
    v_mfma_f32_16x16x32_bf16 v[152:155], v[96:99], v[92:95], v[152:155]
    ds_read_b64_tr_b16 v[36:37], v3 offset:32768
    v_mfma_f32_16x16x32_bf16 v[156:159], v[100:103], v[92:95], v[156:159]
    v_mfma_f32_16x16x32_bf16 v[148:151], v[100:103], v[88:91], v[148:151]
    ds_read_b64_tr_b16 v[38:39], v3 offset:33792
    v_mfma_f32_16x16x32_bf16 v[140:143], v[100:103], v[84:87], v[140:143]
    ds_read_b64_tr_b16 v[40:41], v4 offset:32768
    v_mfma_f32_16x16x32_bf16 v[132:135], v[100:103], v[80:83], v[132:135]
    v_mfma_f32_16x16x32_bf16 v[160:163], v[104:107], v[80:83], v[160:163]
    ds_read_b64_tr_b16 v[42:43], v4 offset:33792
    v_mfma_f32_16x16x32_bf16 v[168:171], v[104:107], v[84:87], v[168:171]
    v_mfma_f32_16x16x32_bf16 v[176:179], v[104:107], v[88:91], v[176:179]
    ds_read_b64_tr_b16 v[44:45], v5 offset:32768
    v_mfma_f32_16x16x32_bf16 v[184:187], v[104:107], v[92:95], v[184:187]
    ds_read_b64_tr_b16 v[46:47], v5 offset:33792
    v_mfma_f32_16x16x32_bf16 v[188:191], v[108:111], v[92:95], v[188:191]
    v_mfma_f32_16x16x32_bf16 v[180:183], v[108:111], v[88:91], v[180:183]
    ds_read_b128 v[48:51], v7 offset:0
    v_mfma_f32_16x16x32_bf16 v[172:175], v[108:111], v[84:87], v[172:175]
    v_mfma_f32_16x16x32_bf16 v[164:167], v[108:111], v[80:83], v[164:167]
    ds_read_b128 v[52:55], v7 offset:2048
    v_mfma_f32_16x16x32_bf16 v[192:195], v[112:115], v[80:83], v[192:195]
    ds_read_b128 v[56:59], v7 offset:4096
    v_mfma_f32_16x16x32_bf16 v[200:203], v[112:115], v[84:87], v[200:203]
    v_mfma_f32_16x16x32_bf16 v[208:211], v[112:115], v[88:91], v[208:211]
    ds_read_b128 v[60:63], v7 offset:6144
    v_mfma_f32_16x16x32_bf16 v[216:219], v[112:115], v[92:95], v[216:219]
    v_mfma_f32_16x16x32_bf16 v[220:223], v[116:119], v[92:95], v[220:223]
    ds_read_b128 v[64:67], v7 offset:8192
    v_mfma_f32_16x16x32_bf16 v[212:215], v[116:119], v[88:91], v[212:215]
    ds_read_b128 v[68:71], v7 offset:10240
    v_mfma_f32_16x16x32_bf16 v[204:207], v[116:119], v[84:87], v[204:207]
    v_mfma_f32_16x16x32_bf16 v[196:199], v[116:119], v[80:83], v[196:199]
    ds_read_b128 v[72:75], v7 offset:12288
    v_mfma_f32_16x16x32_bf16 v[224:227], v[120:123], v[80:83], v[224:227]
    v_mfma_f32_16x16x32_bf16 v[232:235], v[120:123], v[84:87], v[232:235]
    ds_read_b128 v[76:79], v7 offset:14336
    v_mfma_f32_16x16x32_bf16 v[240:243], v[120:123], v[88:91], v[240:243]
    v_mfma_f32_16x16x32_bf16 v[248:251], v[120:123], v[92:95], v[248:251]
    v_mfma_f32_16x16x32_bf16 v[252:255], v[124:127], v[92:95], v[252:255]
    v_mfma_f32_16x16x32_bf16 v[244:247], v[124:127], v[88:91], v[244:247]
    v_mfma_f32_16x16x32_bf16 v[236:239], v[124:127], v[84:87], v[236:239]
    v_mfma_f32_16x16x32_bf16 v[228:231], v[124:127], v[80:83], v[228:231]
    s_waitcnt lgkmcnt(0)
    s_barrier
    v_mfma_f32_16x16x32_bf16 v[128:131], v[48:51], v[32:35], v[128:131]
    ds_read_b64_tr_b16 v[80:81], v2 offset:49152
    v_mfma_f32_16x16x32_bf16 v[136:139], v[48:51], v[36:39], v[136:139]
    ds_read_b64_tr_b16 v[82:83], v2 offset:50176
    v_mfma_f32_16x16x32_bf16 v[144:147], v[48:51], v[40:43], v[144:147]
    v_mfma_f32_16x16x32_bf16 v[152:155], v[48:51], v[44:47], v[152:155]
    ds_read_b64_tr_b16 v[84:85], v3 offset:49152
    v_mfma_f32_16x16x32_bf16 v[156:159], v[52:55], v[44:47], v[156:159]
    v_mfma_f32_16x16x32_bf16 v[148:151], v[52:55], v[40:43], v[148:151]
    ds_read_b64_tr_b16 v[86:87], v3 offset:50176
    v_mfma_f32_16x16x32_bf16 v[140:143], v[52:55], v[36:39], v[140:143]
    ds_read_b64_tr_b16 v[88:89], v4 offset:49152
    v_mfma_f32_16x16x32_bf16 v[132:135], v[52:55], v[32:35], v[132:135]
    v_mfma_f32_16x16x32_bf16 v[160:163], v[56:59], v[32:35], v[160:163]
    ds_read_b64_tr_b16 v[90:91], v4 offset:50176
    v_mfma_f32_16x16x32_bf16 v[168:171], v[56:59], v[36:39], v[168:171]
    v_mfma_f32_16x16x32_bf16 v[176:179], v[56:59], v[40:43], v[176:179]
    ds_read_b64_tr_b16 v[92:93], v5 offset:49152
    v_mfma_f32_16x16x32_bf16 v[184:187], v[56:59], v[44:47], v[184:187]
    ds_read_b64_tr_b16 v[94:95], v5 offset:50176
    v_mfma_f32_16x16x32_bf16 v[188:191], v[60:63], v[44:47], v[188:191]
    v_mfma_f32_16x16x32_bf16 v[180:183], v[60:63], v[40:43], v[180:183]
    ds_read_b128 v[96:99], v9 offset:0
    v_mfma_f32_16x16x32_bf16 v[172:175], v[60:63], v[36:39], v[172:175]
    v_mfma_f32_16x16x32_bf16 v[164:167], v[60:63], v[32:35], v[164:167]
    ds_read_b128 v[100:103], v9 offset:2048
    v_mfma_f32_16x16x32_bf16 v[192:195], v[64:67], v[32:35], v[192:195]
    ds_read_b128 v[104:107], v9 offset:4096
    v_mfma_f32_16x16x32_bf16 v[200:203], v[64:67], v[36:39], v[200:203]
    v_mfma_f32_16x16x32_bf16 v[208:211], v[64:67], v[40:43], v[208:211]
    ds_read_b128 v[108:111], v9 offset:6144
    v_mfma_f32_16x16x32_bf16 v[216:219], v[64:67], v[44:47], v[216:219]
    v_mfma_f32_16x16x32_bf16 v[220:223], v[68:71], v[44:47], v[220:223]
    ds_read_b128 v[112:115], v9 offset:8192
    v_mfma_f32_16x16x32_bf16 v[212:215], v[68:71], v[40:43], v[212:215]
    ds_read_b128 v[116:119], v9 offset:10240
    v_mfma_f32_16x16x32_bf16 v[204:207], v[68:71], v[36:39], v[204:207]
    v_mfma_f32_16x16x32_bf16 v[196:199], v[68:71], v[32:35], v[196:199]
    ds_read_b128 v[120:123], v9 offset:12288
    v_mfma_f32_16x16x32_bf16 v[224:227], v[72:75], v[32:35], v[224:227]
    v_mfma_f32_16x16x32_bf16 v[232:235], v[72:75], v[36:39], v[232:235]
    ds_read_b128 v[124:127], v9 offset:14336
    v_mfma_f32_16x16x32_bf16 v[240:243], v[72:75], v[40:43], v[240:243]
    v_mfma_f32_16x16x32_bf16 v[248:251], v[72:75], v[44:47], v[248:251]
    v_mfma_f32_16x16x32_bf16 v[252:255], v[76:79], v[44:47], v[252:255]
    v_mfma_f32_16x16x32_bf16 v[244:247], v[76:79], v[40:43], v[244:247]
    v_mfma_f32_16x16x32_bf16 v[236:239], v[76:79], v[36:39], v[236:239]
    v_mfma_f32_16x16x32_bf16 v[228:231], v[76:79], v[32:35], v[228:231]
    s_waitcnt lgkmcnt(0)
    s_barrier
    v_mfma_f32_16x16x32_bf16 v[128:131], v[96:99], v[80:83], v[128:131]
    ds_read_b64_tr_b16 v[32:33], v2 offset:0
    v_mfma_f32_16x16x32_bf16 v[136:139], v[96:99], v[84:87], v[136:139]
    ds_read_b64_tr_b16 v[34:35], v2 offset:1024
    v_mfma_f32_16x16x32_bf16 v[144:147], v[96:99], v[88:91], v[144:147]
    v_mfma_f32_16x16x32_bf16 v[152:155], v[96:99], v[92:95], v[152:155]
    ds_read_b64_tr_b16 v[36:37], v3 offset:0
    v_mfma_f32_16x16x32_bf16 v[156:159], v[100:103], v[92:95], v[156:159]
    v_mfma_f32_16x16x32_bf16 v[148:151], v[100:103], v[88:91], v[148:151]
    ds_read_b64_tr_b16 v[38:39], v3 offset:1024
    v_mfma_f32_16x16x32_bf16 v[140:143], v[100:103], v[84:87], v[140:143]
    ds_read_b64_tr_b16 v[40:41], v4 offset:0
    v_mfma_f32_16x16x32_bf16 v[132:135], v[100:103], v[80:83], v[132:135]
    v_mfma_f32_16x16x32_bf16 v[160:163], v[104:107], v[80:83], v[160:163]
    ds_read_b64_tr_b16 v[42:43], v4 offset:1024
    v_mfma_f32_16x16x32_bf16 v[168:171], v[104:107], v[84:87], v[168:171]
    v_mfma_f32_16x16x32_bf16 v[176:179], v[104:107], v[88:91], v[176:179]
    ds_read_b64_tr_b16 v[44:45], v5 offset:0
    v_mfma_f32_16x16x32_bf16 v[184:187], v[104:107], v[92:95], v[184:187]
    ds_read_b64_tr_b16 v[46:47], v5 offset:1024
    v_mfma_f32_16x16x32_bf16 v[188:191], v[108:111], v[92:95], v[188:191]
    v_mfma_f32_16x16x32_bf16 v[180:183], v[108:111], v[88:91], v[180:183]
    ds_read_b128 v[48:51], v1 offset:0
    v_mfma_f32_16x16x32_bf16 v[172:175], v[108:111], v[84:87], v[172:175]
    v_mfma_f32_16x16x32_bf16 v[164:167], v[108:111], v[80:83], v[164:167]
    ds_read_b128 v[52:55], v1 offset:2048
    v_mfma_f32_16x16x32_bf16 v[192:195], v[112:115], v[80:83], v[192:195]
    ds_read_b128 v[56:59], v1 offset:4096
    s_lshl_b32 s56, s2, 2
    s_add_u32 s56, s56, s65
    s_lshl_b32 s57, s56, 12
    s_lshl_b32 s56, s56, 11
    s_mov_b32 exec_hi, 0
    s_mov_b32 exec_lo, 0xffff
    buffer_load_dword v25, v24, s[28:31], s56 offen
    s_mov_b32 exec_lo, 0xffff
    buffer_load_dword v25, v24, s[32:35], s56 offen
    s_mov_b64 exec, -1
    v_mfma_f32_16x16x32_bf16 v[200:203], v[112:115], v[84:87], v[200:203]
    v_mfma_f32_16x16x32_bf16 v[208:211], v[112:115], v[88:91], v[208:211]
    ds_read_b128 v[60:63], v1 offset:6144
    v_mfma_f32_16x16x32_bf16 v[216:219], v[112:115], v[92:95], v[216:219]
    v_mfma_f32_16x16x32_bf16 v[220:223], v[116:119], v[92:95], v[220:223]
    ds_read_b128 v[64:67], v1 offset:8192
    v_mfma_f32_16x16x32_bf16 v[212:215], v[116:119], v[88:91], v[212:215]
    ds_read_b128 v[68:71], v1 offset:10240
    v_mfma_f32_16x16x32_bf16 v[204:207], v[116:119], v[84:87], v[204:207]
    v_mfma_f32_16x16x32_bf16 v[196:199], v[116:119], v[80:83], v[196:199]
    ds_read_b128 v[72:75], v1 offset:12288
    v_mfma_f32_16x16x32_bf16 v[224:227], v[120:123], v[80:83], v[224:227]
    v_mfma_f32_16x16x32_bf16 v[232:235], v[120:123], v[84:87], v[232:235]
    ds_read_b128 v[76:79], v1 offset:14336
    v_mfma_f32_16x16x32_bf16 v[240:243], v[120:123], v[88:91], v[240:243]
    v_mfma_f32_16x16x32_bf16 v[248:251], v[120:123], v[92:95], v[248:251]
    v_mfma_f32_16x16x32_bf16 v[252:255], v[124:127], v[92:95], v[252:255]
    v_mfma_f32_16x16x32_bf16 v[244:247], v[124:127], v[88:91], v[244:247]
    v_mfma_f32_16x16x32_bf16 v[236:239], v[124:127], v[84:87], v[236:239]
    v_mfma_f32_16x16x32_bf16 v[228:231], v[124:127], v[80:83], v[228:231]
    s_waitcnt lgkmcnt(0)
    s_barrier
    v_mfma_f32_16x16x32_bf16 v[128:131], v[48:51], v[32:35], v[128:131]
    ds_read_b64_tr_b16 v[80:81], v2 offset:16384
    v_mfma_f32_16x16x32_bf16 v[136:139], v[48:51], v[36:39], v[136:139]
    ds_read_b64_tr_b16 v[82:83], v2 offset:17408
    v_mfma_f32_16x16x32_bf16 v[144:147], v[48:51], v[40:43], v[144:147]
    v_mfma_f32_16x16x32_bf16 v[152:155], v[48:51], v[44:47], v[152:155]
    ds_read_b64_tr_b16 v[84:85], v3 offset:16384
    v_mfma_f32_16x16x32_bf16 v[156:159], v[52:55], v[44:47], v[156:159]
    v_mfma_f32_16x16x32_bf16 v[148:151], v[52:55], v[40:43], v[148:151]
    ds_read_b64_tr_b16 v[86:87], v3 offset:17408
    v_mfma_f32_16x16x32_bf16 v[140:143], v[52:55], v[36:39], v[140:143]
    ds_read_b64_tr_b16 v[88:89], v4 offset:16384
    v_mfma_f32_16x16x32_bf16 v[132:135], v[52:55], v[32:35], v[132:135]
    v_mfma_f32_16x16x32_bf16 v[160:163], v[56:59], v[32:35], v[160:163]
    ds_read_b64_tr_b16 v[90:91], v4 offset:17408
    v_mfma_f32_16x16x32_bf16 v[168:171], v[56:59], v[36:39], v[168:171]
    v_mfma_f32_16x16x32_bf16 v[176:179], v[56:59], v[40:43], v[176:179]
    ds_read_b64_tr_b16 v[92:93], v5 offset:16384
    v_mfma_f32_16x16x32_bf16 v[184:187], v[56:59], v[44:47], v[184:187]
    ds_read_b64_tr_b16 v[94:95], v5 offset:17408
    v_mfma_f32_16x16x32_bf16 v[188:191], v[60:63], v[44:47], v[188:191]
    v_mfma_f32_16x16x32_bf16 v[180:183], v[60:63], v[40:43], v[180:183]
    ds_read_b128 v[96:99], v6 offset:0
    v_mfma_f32_16x16x32_bf16 v[172:175], v[60:63], v[36:39], v[172:175]
    v_mfma_f32_16x16x32_bf16 v[164:167], v[60:63], v[32:35], v[164:167]
    ds_read_b128 v[100:103], v6 offset:2048
    v_mfma_f32_16x16x32_bf16 v[192:195], v[64:67], v[32:35], v[192:195]
    ds_read_b128 v[104:107], v6 offset:4096
    v_mfma_f32_16x16x32_bf16 v[200:203], v[64:67], v[36:39], v[200:203]
    v_mfma_f32_16x16x32_bf16 v[208:211], v[64:67], v[40:43], v[208:211]
    ds_read_b128 v[108:111], v6 offset:6144
    v_mfma_f32_16x16x32_bf16 v[216:219], v[64:67], v[44:47], v[216:219]
    v_mfma_f32_16x16x32_bf16 v[220:223], v[68:71], v[44:47], v[220:223]
    ds_read_b128 v[112:115], v6 offset:8192
    v_mfma_f32_16x16x32_bf16 v[212:215], v[68:71], v[40:43], v[212:215]
    ds_read_b128 v[116:119], v6 offset:10240
    v_mfma_f32_16x16x32_bf16 v[204:207], v[68:71], v[36:39], v[204:207]
    v_mfma_f32_16x16x32_bf16 v[196:199], v[68:71], v[32:35], v[196:199]
    ds_read_b128 v[120:123], v6 offset:12288
    v_mfma_f32_16x16x32_bf16 v[224:227], v[72:75], v[32:35], v[224:227]
    v_mfma_f32_16x16x32_bf16 v[232:235], v[72:75], v[36:39], v[232:235]
    ds_read_b128 v[124:127], v6 offset:14336
    v_mfma_f32_16x16x32_bf16 v[240:243], v[72:75], v[40:43], v[240:243]
    v_mfma_f32_16x16x32_bf16 v[248:251], v[72:75], v[44:47], v[248:251]
    v_mfma_f32_16x16x32_bf16 v[252:255], v[76:79], v[44:47], v[252:255]
    v_mfma_f32_16x16x32_bf16 v[244:247], v[76:79], v[40:43], v[244:247]
    v_mfma_f32_16x16x32_bf16 v[236:239], v[76:79], v[36:39], v[236:239]
    v_mfma_f32_16x16x32_bf16 v[228:231], v[76:79], v[32:35], v[228:231]
    s_waitcnt lgkmcnt(0)
    s_barrier
    v_mfma_f32_16x16x32_bf16 v[128:131], v[96:99], v[80:83], v[128:131]
    ds_read_b64_tr_b16 v[32:33], v2 offset:32768
    v_mfma_f32_16x16x32_bf16 v[136:139], v[96:99], v[84:87], v[136:139]
    ds_read_b64_tr_b16 v[34:35], v2 offset:33792
    v_mfma_f32_16x16x32_bf16 v[144:147], v[96:99], v[88:91], v[144:147]
    v_mfma_f32_16x16x32_bf16 v[152:155], v[96:99], v[92:95], v[152:155]
    ds_read_b64_tr_b16 v[36:37], v3 offset:32768
    v_mfma_f32_16x16x32_bf16 v[156:159], v[100:103], v[92:95], v[156:159]
    v_mfma_f32_16x16x32_bf16 v[148:151], v[100:103], v[88:91], v[148:151]
    ds_read_b64_tr_b16 v[38:39], v3 offset:33792
    v_mfma_f32_16x16x32_bf16 v[140:143], v[100:103], v[84:87], v[140:143]
    ds_read_b64_tr_b16 v[40:41], v4 offset:32768
    v_mfma_f32_16x16x32_bf16 v[132:135], v[100:103], v[80:83], v[132:135]
    v_mfma_f32_16x16x32_bf16 v[160:163], v[104:107], v[80:83], v[160:163]
    ds_read_b64_tr_b16 v[42:43], v4 offset:33792
    v_mfma_f32_16x16x32_bf16 v[168:171], v[104:107], v[84:87], v[168:171]
    v_mfma_f32_16x16x32_bf16 v[176:179], v[104:107], v[88:91], v[176:179]
    ds_read_b64_tr_b16 v[44:45], v5 offset:32768
    v_mfma_f32_16x16x32_bf16 v[184:187], v[104:107], v[92:95], v[184:187]
    ds_read_b64_tr_b16 v[46:47], v5 offset:33792
    v_mfma_f32_16x16x32_bf16 v[188:191], v[108:111], v[92:95], v[188:191]
    v_mfma_f32_16x16x32_bf16 v[180:183], v[108:111], v[88:91], v[180:183]
    ds_read_b128 v[48:51], v1 offset:32768
    v_mfma_f32_16x16x32_bf16 v[172:175], v[108:111], v[84:87], v[172:175]
    v_mfma_f32_16x16x32_bf16 v[164:167], v[108:111], v[80:83], v[164:167]
    ds_read_b128 v[52:55], v1 offset:34816
    v_mfma_f32_16x16x32_bf16 v[192:195], v[112:115], v[80:83], v[192:195]
    ds_read_b128 v[56:59], v1 offset:36864
    v_mfma_f32_16x16x32_bf16 v[200:203], v[112:115], v[84:87], v[200:203]
    v_mfma_f32_16x16x32_bf16 v[208:211], v[112:115], v[88:91], v[208:211]
    ds_read_b128 v[60:63], v1 offset:38912
    v_mfma_f32_16x16x32_bf16 v[216:219], v[112:115], v[92:95], v[216:219]
    v_mfma_f32_16x16x32_bf16 v[220:223], v[116:119], v[92:95], v[220:223]
    ds_read_b128 v[64:67], v1 offset:40960
    v_mfma_f32_16x16x32_bf16 v[212:215], v[116:119], v[88:91], v[212:215]
    ds_read_b128 v[68:71], v1 offset:43008
    v_mfma_f32_16x16x32_bf16 v[204:207], v[116:119], v[84:87], v[204:207]
    v_mfma_f32_16x16x32_bf16 v[196:199], v[116:119], v[80:83], v[196:199]
    ds_read_b128 v[72:75], v1 offset:45056
    v_mfma_f32_16x16x32_bf16 v[224:227], v[120:123], v[80:83], v[224:227]
    v_mfma_f32_16x16x32_bf16 v[232:235], v[120:123], v[84:87], v[232:235]
    ds_read_b128 v[76:79], v1 offset:47104
    v_mfma_f32_16x16x32_bf16 v[240:243], v[120:123], v[88:91], v[240:243]
    v_mfma_f32_16x16x32_bf16 v[248:251], v[120:123], v[92:95], v[248:251]
    v_mfma_f32_16x16x32_bf16 v[252:255], v[124:127], v[92:95], v[252:255]
    v_mfma_f32_16x16x32_bf16 v[244:247], v[124:127], v[88:91], v[244:247]
    v_mfma_f32_16x16x32_bf16 v[236:239], v[124:127], v[84:87], v[236:239]
    v_mfma_f32_16x16x32_bf16 v[228:231], v[124:127], v[80:83], v[228:231]
    s_waitcnt lgkmcnt(0)
    s_barrier
    v_mfma_f32_16x16x32_bf16 v[128:131], v[48:51], v[32:35], v[128:131]
    ds_read_b64_tr_b16 v[80:81], v2 offset:49152
    v_mfma_f32_16x16x32_bf16 v[136:139], v[48:51], v[36:39], v[136:139]
    ds_read_b64_tr_b16 v[82:83], v2 offset:50176
    v_mfma_f32_16x16x32_bf16 v[144:147], v[48:51], v[40:43], v[144:147]
    v_mfma_f32_16x16x32_bf16 v[152:155], v[48:51], v[44:47], v[152:155]
    ds_read_b64_tr_b16 v[84:85], v3 offset:49152
    v_mfma_f32_16x16x32_bf16 v[156:159], v[52:55], v[44:47], v[156:159]
    v_mfma_f32_16x16x32_bf16 v[148:151], v[52:55], v[40:43], v[148:151]
    ds_read_b64_tr_b16 v[86:87], v3 offset:50176
    v_mfma_f32_16x16x32_bf16 v[140:143], v[52:55], v[36:39], v[140:143]
    ds_read_b64_tr_b16 v[88:89], v4 offset:49152
    v_mfma_f32_16x16x32_bf16 v[132:135], v[52:55], v[32:35], v[132:135]
    v_mfma_f32_16x16x32_bf16 v[160:163], v[56:59], v[32:35], v[160:163]
    ds_read_b64_tr_b16 v[90:91], v4 offset:50176
    v_mfma_f32_16x16x32_bf16 v[168:171], v[56:59], v[36:39], v[168:171]
    v_mfma_f32_16x16x32_bf16 v[176:179], v[56:59], v[40:43], v[176:179]
    ds_read_b64_tr_b16 v[92:93], v5 offset:49152
    v_mfma_f32_16x16x32_bf16 v[184:187], v[56:59], v[44:47], v[184:187]
    ds_read_b64_tr_b16 v[94:95], v5 offset:50176
    v_mfma_f32_16x16x32_bf16 v[188:191], v[60:63], v[44:47], v[188:191]
    v_mfma_f32_16x16x32_bf16 v[180:183], v[60:63], v[40:43], v[180:183]
    ds_read_b128 v[96:99], v6 offset:32768
    v_mfma_f32_16x16x32_bf16 v[172:175], v[60:63], v[36:39], v[172:175]
    v_mfma_f32_16x16x32_bf16 v[164:167], v[60:63], v[32:35], v[164:167]
    ds_read_b128 v[100:103], v6 offset:34816
    v_mfma_f32_16x16x32_bf16 v[192:195], v[64:67], v[32:35], v[192:195]
    ds_read_b128 v[104:107], v6 offset:36864
    v_mfma_f32_16x16x32_bf16 v[200:203], v[64:67], v[36:39], v[200:203]
    v_mfma_f32_16x16x32_bf16 v[208:211], v[64:67], v[40:43], v[208:211]
    ds_read_b128 v[108:111], v6 offset:38912
    v_mfma_f32_16x16x32_bf16 v[216:219], v[64:67], v[44:47], v[216:219]
    v_mfma_f32_16x16x32_bf16 v[220:223], v[68:71], v[44:47], v[220:223]
    ds_read_b128 v[112:115], v6 offset:40960
    v_mfma_f32_16x16x32_bf16 v[212:215], v[68:71], v[40:43], v[212:215]
    ds_read_b128 v[116:119], v6 offset:43008
    v_mfma_f32_16x16x32_bf16 v[204:207], v[68:71], v[36:39], v[204:207]
    v_mfma_f32_16x16x32_bf16 v[196:199], v[68:71], v[32:35], v[196:199]
    ds_read_b128 v[120:123], v6 offset:45056
    v_mfma_f32_16x16x32_bf16 v[224:227], v[72:75], v[32:35], v[224:227]
    v_mfma_f32_16x16x32_bf16 v[232:235], v[72:75], v[36:39], v[232:235]
    ds_read_b128 v[124:127], v6 offset:47104
    v_mfma_f32_16x16x32_bf16 v[240:243], v[72:75], v[40:43], v[240:243]
    v_mfma_f32_16x16x32_bf16 v[248:251], v[72:75], v[44:47], v[248:251]
    v_mfma_f32_16x16x32_bf16 v[252:255], v[76:79], v[44:47], v[252:255]
    v_mfma_f32_16x16x32_bf16 v[244:247], v[76:79], v[40:43], v[244:247]
    v_mfma_f32_16x16x32_bf16 v[236:239], v[76:79], v[36:39], v[236:239]
    v_mfma_f32_16x16x32_bf16 v[228:231], v[76:79], v[32:35], v[228:231]
    s_waitcnt lgkmcnt(0)
    s_barrier
    v_mfma_f32_16x16x32_bf16 v[128:131], v[96:99], v[80:83], v[128:131]
    ds_read_b64_tr_b16 v[32:33], v2 offset:0
    v_mfma_f32_16x16x32_bf16 v[136:139], v[96:99], v[84:87], v[136:139]
    ds_read_b64_tr_b16 v[34:35], v2 offset:1024
    v_mfma_f32_16x16x32_bf16 v[144:147], v[96:99], v[88:91], v[144:147]
    v_mfma_f32_16x16x32_bf16 v[152:155], v[96:99], v[92:95], v[152:155]
    ds_read_b64_tr_b16 v[36:37], v3 offset:0
    v_mfma_f32_16x16x32_bf16 v[156:159], v[100:103], v[92:95], v[156:159]
    v_mfma_f32_16x16x32_bf16 v[148:151], v[100:103], v[88:91], v[148:151]
    ds_read_b64_tr_b16 v[38:39], v3 offset:1024
    v_mfma_f32_16x16x32_bf16 v[140:143], v[100:103], v[84:87], v[140:143]
    ds_read_b64_tr_b16 v[40:41], v4 offset:0
    v_mfma_f32_16x16x32_bf16 v[132:135], v[100:103], v[80:83], v[132:135]
    v_mfma_f32_16x16x32_bf16 v[160:163], v[104:107], v[80:83], v[160:163]
    ds_read_b64_tr_b16 v[42:43], v4 offset:1024
    v_mfma_f32_16x16x32_bf16 v[168:171], v[104:107], v[84:87], v[168:171]
    v_mfma_f32_16x16x32_bf16 v[176:179], v[104:107], v[88:91], v[176:179]
    ds_read_b64_tr_b16 v[44:45], v5 offset:0
    v_mfma_f32_16x16x32_bf16 v[184:187], v[104:107], v[92:95], v[184:187]
    ds_read_b64_tr_b16 v[46:47], v5 offset:1024
    v_mfma_f32_16x16x32_bf16 v[188:191], v[108:111], v[92:95], v[188:191]
    v_mfma_f32_16x16x32_bf16 v[180:183], v[108:111], v[88:91], v[180:183]
    ds_read_b128 v[48:51], v7 offset:0
    v_mfma_f32_16x16x32_bf16 v[172:175], v[108:111], v[84:87], v[172:175]
    v_mfma_f32_16x16x32_bf16 v[164:167], v[108:111], v[80:83], v[164:167]
    ds_read_b128 v[52:55], v7 offset:2048
    v_mfma_f32_16x16x32_bf16 v[192:195], v[112:115], v[80:83], v[192:195]
    ds_read_b128 v[56:59], v7 offset:4096
    s_lshl_b32 s56, s2, 2
    s_add_u32 s56, s56, s65
    s_lshl_b32 s57, s56, 12
    s_lshl_b32 s56, s56, 11
    s_mov_b32 exec_hi, 0
    s_mov_b32 exec_lo, 0xffff
    buffer_load_dword v25, v24, s[36:39], s56 offen
    s_mov_b64 exec, -1
    v_mfma_f32_16x16x32_bf16 v[200:203], v[112:115], v[84:87], v[200:203]
    v_mfma_f32_16x16x32_bf16 v[208:211], v[112:115], v[88:91], v[208:211]
    ds_read_b128 v[60:63], v7 offset:6144
    v_mfma_f32_16x16x32_bf16 v[216:219], v[112:115], v[92:95], v[216:219]
    v_mfma_f32_16x16x32_bf16 v[220:223], v[116:119], v[92:95], v[220:223]
    ds_read_b128 v[64:67], v7 offset:8192
    v_mfma_f32_16x16x32_bf16 v[212:215], v[116:119], v[88:91], v[212:215]
    ds_read_b128 v[68:71], v7 offset:10240
    v_mfma_f32_16x16x32_bf16 v[204:207], v[116:119], v[84:87], v[204:207]
    v_mfma_f32_16x16x32_bf16 v[196:199], v[116:119], v[80:83], v[196:199]
    ds_read_b128 v[72:75], v7 offset:12288
    v_mfma_f32_16x16x32_bf16 v[224:227], v[120:123], v[80:83], v[224:227]
    v_mfma_f32_16x16x32_bf16 v[232:235], v[120:123], v[84:87], v[232:235]
    ds_read_b128 v[76:79], v7 offset:14336
    v_mfma_f32_16x16x32_bf16 v[240:243], v[120:123], v[88:91], v[240:243]
    v_mfma_f32_16x16x32_bf16 v[248:251], v[120:123], v[92:95], v[248:251]
    v_mfma_f32_16x16x32_bf16 v[252:255], v[124:127], v[92:95], v[252:255]
    v_mfma_f32_16x16x32_bf16 v[244:247], v[124:127], v[88:91], v[244:247]
    v_mfma_f32_16x16x32_bf16 v[236:239], v[124:127], v[84:87], v[236:239]
    v_mfma_f32_16x16x32_bf16 v[228:231], v[124:127], v[80:83], v[228:231]
    s_waitcnt lgkmcnt(0)
    s_barrier
    v_mfma_f32_16x16x32_bf16 v[128:131], v[48:51], v[32:35], v[128:131]
    ds_read_b64_tr_b16 v[80:81], v2 offset:16384
    v_mfma_f32_16x16x32_bf16 v[136:139], v[48:51], v[36:39], v[136:139]
    ds_read_b64_tr_b16 v[82:83], v2 offset:17408
    v_mfma_f32_16x16x32_bf16 v[144:147], v[48:51], v[40:43], v[144:147]
    v_mfma_f32_16x16x32_bf16 v[152:155], v[48:51], v[44:47], v[152:155]
    ds_read_b64_tr_b16 v[84:85], v3 offset:16384
    v_mfma_f32_16x16x32_bf16 v[156:159], v[52:55], v[44:47], v[156:159]
    v_mfma_f32_16x16x32_bf16 v[148:151], v[52:55], v[40:43], v[148:151]
    ds_read_b64_tr_b16 v[86:87], v3 offset:17408
    v_mfma_f32_16x16x32_bf16 v[140:143], v[52:55], v[36:39], v[140:143]
    ds_read_b64_tr_b16 v[88:89], v4 offset:16384
    v_mfma_f32_16x16x32_bf16 v[132:135], v[52:55], v[32:35], v[132:135]
    v_mfma_f32_16x16x32_bf16 v[160:163], v[56:59], v[32:35], v[160:163]
    ds_read_b64_tr_b16 v[90:91], v4 offset:17408
    v_mfma_f32_16x16x32_bf16 v[168:171], v[56:59], v[36:39], v[168:171]
    v_mfma_f32_16x16x32_bf16 v[176:179], v[56:59], v[40:43], v[176:179]
    ds_read_b64_tr_b16 v[92:93], v5 offset:16384
    v_mfma_f32_16x16x32_bf16 v[184:187], v[56:59], v[44:47], v[184:187]
    ds_read_b64_tr_b16 v[94:95], v5 offset:17408
    v_mfma_f32_16x16x32_bf16 v[188:191], v[60:63], v[44:47], v[188:191]
    v_mfma_f32_16x16x32_bf16 v[180:183], v[60:63], v[40:43], v[180:183]
    ds_read_b128 v[96:99], v9 offset:0
    v_mfma_f32_16x16x32_bf16 v[172:175], v[60:63], v[36:39], v[172:175]
    v_mfma_f32_16x16x32_bf16 v[164:167], v[60:63], v[32:35], v[164:167]
    ds_read_b128 v[100:103], v9 offset:2048
    v_mfma_f32_16x16x32_bf16 v[192:195], v[64:67], v[32:35], v[192:195]
    ds_read_b128 v[104:107], v9 offset:4096
    v_mfma_f32_16x16x32_bf16 v[200:203], v[64:67], v[36:39], v[200:203]
    v_mfma_f32_16x16x32_bf16 v[208:211], v[64:67], v[40:43], v[208:211]
    ds_read_b128 v[108:111], v9 offset:6144
    v_mfma_f32_16x16x32_bf16 v[216:219], v[64:67], v[44:47], v[216:219]
    v_mfma_f32_16x16x32_bf16 v[220:223], v[68:71], v[44:47], v[220:223]
    ds_read_b128 v[112:115], v9 offset:8192
    v_mfma_f32_16x16x32_bf16 v[212:215], v[68:71], v[40:43], v[212:215]
    ds_read_b128 v[116:119], v9 offset:10240
    v_mfma_f32_16x16x32_bf16 v[204:207], v[68:71], v[36:39], v[204:207]
    v_mfma_f32_16x16x32_bf16 v[196:199], v[68:71], v[32:35], v[196:199]
    ds_read_b128 v[120:123], v9 offset:12288
    v_mfma_f32_16x16x32_bf16 v[224:227], v[72:75], v[32:35], v[224:227]
    v_mfma_f32_16x16x32_bf16 v[232:235], v[72:75], v[36:39], v[232:235]
    ds_read_b128 v[124:127], v9 offset:14336
    v_mfma_f32_16x16x32_bf16 v[240:243], v[72:75], v[40:43], v[240:243]
    v_mfma_f32_16x16x32_bf16 v[248:251], v[72:75], v[44:47], v[248:251]
    v_mfma_f32_16x16x32_bf16 v[252:255], v[76:79], v[44:47], v[252:255]
    v_mfma_f32_16x16x32_bf16 v[244:247], v[76:79], v[40:43], v[244:247]
    v_mfma_f32_16x16x32_bf16 v[236:239], v[76:79], v[36:39], v[236:239]
    v_mfma_f32_16x16x32_bf16 v[228:231], v[76:79], v[32:35], v[228:231]
    s_waitcnt lgkmcnt(0)
    s_barrier
    v_mfma_f32_16x16x32_bf16 v[128:131], v[96:99], v[80:83], v[128:131]
    ds_read_b64_tr_b16 v[32:33], v2 offset:32768
    v_mfma_f32_16x16x32_bf16 v[136:139], v[96:99], v[84:87], v[136:139]
    ds_read_b64_tr_b16 v[34:35], v2 offset:33792
    v_mfma_f32_16x16x32_bf16 v[144:147], v[96:99], v[88:91], v[144:147]
    v_mfma_f32_16x16x32_bf16 v[152:155], v[96:99], v[92:95], v[152:155]
    ds_read_b64_tr_b16 v[36:37], v3 offset:32768
    v_mfma_f32_16x16x32_bf16 v[156:159], v[100:103], v[92:95], v[156:159]
    v_mfma_f32_16x16x32_bf16 v[148:151], v[100:103], v[88:91], v[148:151]
    ds_read_b64_tr_b16 v[38:39], v3 offset:33792
    v_mfma_f32_16x16x32_bf16 v[140:143], v[100:103], v[84:87], v[140:143]
    ds_read_b64_tr_b16 v[40:41], v4 offset:32768
    v_mfma_f32_16x16x32_bf16 v[132:135], v[100:103], v[80:83], v[132:135]
    v_mfma_f32_16x16x32_bf16 v[160:163], v[104:107], v[80:83], v[160:163]
    ds_read_b64_tr_b16 v[42:43], v4 offset:33792
    v_mfma_f32_16x16x32_bf16 v[168:171], v[104:107], v[84:87], v[168:171]
    v_mfma_f32_16x16x32_bf16 v[176:179], v[104:107], v[88:91], v[176:179]
    ds_read_b64_tr_b16 v[44:45], v5 offset:32768
    v_mfma_f32_16x16x32_bf16 v[184:187], v[104:107], v[92:95], v[184:187]
    ds_read_b64_tr_b16 v[46:47], v5 offset:33792
    v_mfma_f32_16x16x32_bf16 v[188:191], v[108:111], v[92:95], v[188:191]
    v_mfma_f32_16x16x32_bf16 v[180:183], v[108:111], v[88:91], v[180:183]
    ds_read_b128 v[48:51], v1 offset:0
    v_mfma_f32_16x16x32_bf16 v[172:175], v[108:111], v[84:87], v[172:175]
    v_mfma_f32_16x16x32_bf16 v[164:167], v[108:111], v[80:83], v[164:167]
    ds_read_b128 v[52:55], v1 offset:2048
    v_mfma_f32_16x16x32_bf16 v[192:195], v[112:115], v[80:83], v[192:195]
    ds_read_b128 v[56:59], v1 offset:4096
    v_mfma_f32_16x16x32_bf16 v[200:203], v[112:115], v[84:87], v[200:203]
    v_mfma_f32_16x16x32_bf16 v[208:211], v[112:115], v[88:91], v[208:211]
    ds_read_b128 v[60:63], v1 offset:6144
    v_mfma_f32_16x16x32_bf16 v[216:219], v[112:115], v[92:95], v[216:219]
    v_mfma_f32_16x16x32_bf16 v[220:223], v[116:119], v[92:95], v[220:223]
    ds_read_b128 v[64:67], v1 offset:8192
    v_mfma_f32_16x16x32_bf16 v[212:215], v[116:119], v[88:91], v[212:215]
    ds_read_b128 v[68:71], v1 offset:10240
    v_mfma_f32_16x16x32_bf16 v[204:207], v[116:119], v[84:87], v[204:207]
    v_mfma_f32_16x16x32_bf16 v[196:199], v[116:119], v[80:83], v[196:199]
    ds_read_b128 v[72:75], v1 offset:12288
    v_mfma_f32_16x16x32_bf16 v[224:227], v[120:123], v[80:83], v[224:227]
    v_mfma_f32_16x16x32_bf16 v[232:235], v[120:123], v[84:87], v[232:235]
    ds_read_b128 v[76:79], v1 offset:14336
    v_mfma_f32_16x16x32_bf16 v[240:243], v[120:123], v[88:91], v[240:243]
    v_mfma_f32_16x16x32_bf16 v[248:251], v[120:123], v[92:95], v[248:251]
    v_mfma_f32_16x16x32_bf16 v[252:255], v[124:127], v[92:95], v[252:255]
    v_mfma_f32_16x16x32_bf16 v[244:247], v[124:127], v[88:91], v[244:247]
    v_mfma_f32_16x16x32_bf16 v[236:239], v[124:127], v[84:87], v[236:239]
    v_mfma_f32_16x16x32_bf16 v[228:231], v[124:127], v[80:83], v[228:231]
    s_waitcnt lgkmcnt(0)
    s_barrier
    v_mfma_f32_16x16x32_bf16 v[128:131], v[48:51], v[32:35], v[128:131]
    ds_read_b64_tr_b16 v[80:81], v2 offset:49152
    v_mfma_f32_16x16x32_bf16 v[136:139], v[48:51], v[36:39], v[136:139]
    ds_read_b64_tr_b16 v[82:83], v2 offset:50176
    v_mfma_f32_16x16x32_bf16 v[144:147], v[48:51], v[40:43], v[144:147]
    v_mfma_f32_16x16x32_bf16 v[152:155], v[48:51], v[44:47], v[152:155]
    ds_read_b64_tr_b16 v[84:85], v3 offset:49152
    v_mfma_f32_16x16x32_bf16 v[156:159], v[52:55], v[44:47], v[156:159]
    v_mfma_f32_16x16x32_bf16 v[148:151], v[52:55], v[40:43], v[148:151]
    ds_read_b64_tr_b16 v[86:87], v3 offset:50176
    v_mfma_f32_16x16x32_bf16 v[140:143], v[52:55], v[36:39], v[140:143]
    ds_read_b64_tr_b16 v[88:89], v4 offset:49152
    v_mfma_f32_16x16x32_bf16 v[132:135], v[52:55], v[32:35], v[132:135]
    v_mfma_f32_16x16x32_bf16 v[160:163], v[56:59], v[32:35], v[160:163]
    ds_read_b64_tr_b16 v[90:91], v4 offset:50176
    v_mfma_f32_16x16x32_bf16 v[168:171], v[56:59], v[36:39], v[168:171]
    v_mfma_f32_16x16x32_bf16 v[176:179], v[56:59], v[40:43], v[176:179]
    ds_read_b64_tr_b16 v[92:93], v5 offset:49152
    v_mfma_f32_16x16x32_bf16 v[184:187], v[56:59], v[44:47], v[184:187]
    ds_read_b64_tr_b16 v[94:95], v5 offset:50176
    v_mfma_f32_16x16x32_bf16 v[188:191], v[60:63], v[44:47], v[188:191]
    v_mfma_f32_16x16x32_bf16 v[180:183], v[60:63], v[40:43], v[180:183]
    ds_read_b128 v[96:99], v6 offset:0
    v_mfma_f32_16x16x32_bf16 v[172:175], v[60:63], v[36:39], v[172:175]
    v_mfma_f32_16x16x32_bf16 v[164:167], v[60:63], v[32:35], v[164:167]
    ds_read_b128 v[100:103], v6 offset:2048
    v_mfma_f32_16x16x32_bf16 v[192:195], v[64:67], v[32:35], v[192:195]
    ds_read_b128 v[104:107], v6 offset:4096
    s_lshl_b32 s56, s2, 2
    s_add_u32 s56, s56, s65
    s_lshl_b32 s57, s56, 12
    s_lshl_b32 s56, s56, 11
    s_mov_b32 exec_hi, 0
    s_mov_b32 exec_lo, -1
    buffer_load_dword v25, v24, s[40:43], s57 offen
    s_mov_b64 exec, -1
    v_mfma_f32_16x16x32_bf16 v[200:203], v[64:67], v[36:39], v[200:203]
    v_mfma_f32_16x16x32_bf16 v[208:211], v[64:67], v[40:43], v[208:211]
    ds_read_b128 v[108:111], v6 offset:6144
    v_mfma_f32_16x16x32_bf16 v[216:219], v[64:67], v[44:47], v[216:219]
    v_mfma_f32_16x16x32_bf16 v[220:223], v[68:71], v[44:47], v[220:223]
    ds_read_b128 v[112:115], v6 offset:8192
    v_mfma_f32_16x16x32_bf16 v[212:215], v[68:71], v[40:43], v[212:215]
    ds_read_b128 v[116:119], v6 offset:10240
    v_mfma_f32_16x16x32_bf16 v[204:207], v[68:71], v[36:39], v[204:207]
    v_mfma_f32_16x16x32_bf16 v[196:199], v[68:71], v[32:35], v[196:199]
    ds_read_b128 v[120:123], v6 offset:12288
    v_mfma_f32_16x16x32_bf16 v[224:227], v[72:75], v[32:35], v[224:227]
    v_mfma_f32_16x16x32_bf16 v[232:235], v[72:75], v[36:39], v[232:235]
    ds_read_b128 v[124:127], v6 offset:14336
    v_mfma_f32_16x16x32_bf16 v[240:243], v[72:75], v[40:43], v[240:243]
    v_mfma_f32_16x16x32_bf16 v[248:251], v[72:75], v[44:47], v[248:251]
    v_mfma_f32_16x16x32_bf16 v[252:255], v[76:79], v[44:47], v[252:255]
    v_mfma_f32_16x16x32_bf16 v[244:247], v[76:79], v[40:43], v[244:247]
    v_mfma_f32_16x16x32_bf16 v[236:239], v[76:79], v[36:39], v[236:239]
    v_mfma_f32_16x16x32_bf16 v[228:231], v[76:79], v[32:35], v[228:231]
    s_waitcnt lgkmcnt(0)
    s_barrier
    v_mfma_f32_16x16x32_bf16 v[128:131], v[96:99], v[80:83], v[128:131]
    ds_read_b64_tr_b16 v[32:33], v2 offset:0
    v_mfma_f32_16x16x32_bf16 v[136:139], v[96:99], v[84:87], v[136:139]
    ds_read_b64_tr_b16 v[34:35], v2 offset:1024
    v_mfma_f32_16x16x32_bf16 v[144:147], v[96:99], v[88:91], v[144:147]
    v_mfma_f32_16x16x32_bf16 v[152:155], v[96:99], v[92:95], v[152:155]
    ds_read_b64_tr_b16 v[36:37], v3 offset:0
    v_mfma_f32_16x16x32_bf16 v[156:159], v[100:103], v[92:95], v[156:159]
    v_mfma_f32_16x16x32_bf16 v[148:151], v[100:103], v[88:91], v[148:151]
    ds_read_b64_tr_b16 v[38:39], v3 offset:1024
    v_mfma_f32_16x16x32_bf16 v[140:143], v[100:103], v[84:87], v[140:143]
    ds_read_b64_tr_b16 v[40:41], v4 offset:0
    v_mfma_f32_16x16x32_bf16 v[132:135], v[100:103], v[80:83], v[132:135]
    v_mfma_f32_16x16x32_bf16 v[160:163], v[104:107], v[80:83], v[160:163]
    ds_read_b64_tr_b16 v[42:43], v4 offset:1024
    v_mfma_f32_16x16x32_bf16 v[168:171], v[104:107], v[84:87], v[168:171]
    v_mfma_f32_16x16x32_bf16 v[176:179], v[104:107], v[88:91], v[176:179]
    ds_read_b64_tr_b16 v[44:45], v5 offset:0
    v_mfma_f32_16x16x32_bf16 v[184:187], v[104:107], v[92:95], v[184:187]
    ds_read_b64_tr_b16 v[46:47], v5 offset:1024
    v_mfma_f32_16x16x32_bf16 v[188:191], v[108:111], v[92:95], v[188:191]
    v_mfma_f32_16x16x32_bf16 v[180:183], v[108:111], v[88:91], v[180:183]
    ds_read_b128 v[48:51], v1 offset:32768
    v_mfma_f32_16x16x32_bf16 v[172:175], v[108:111], v[84:87], v[172:175]
    v_mfma_f32_16x16x32_bf16 v[164:167], v[108:111], v[80:83], v[164:167]
    ds_read_b128 v[52:55], v1 offset:34816
    v_mfma_f32_16x16x32_bf16 v[192:195], v[112:115], v[80:83], v[192:195]
    ds_read_b128 v[56:59], v1 offset:36864
    s_cmp_lg_u32 s3, 4
    s_cbranch_scc1 cpf_1
    s_getpc_b64 s[86:87]
here_2:
    s_sub_u32 s86, s86, here_2-concat_heads__linear_kernel_hedgehog__compressed_kv_cla__prompt_kernel
    s_subb_u32 s87, s87, 0
    s_lshr_b32 s56, s2, 3
    s_mul_i32 s56, s56, 3072
    v_lshlrev_b32 v18, 7, v0
    v_add_u32 v18, s56, v18
    v_min_u32 v18, code_end-concat_heads__linear_kernel_hedgehog__compressed_kv_cla__prompt_kernel-4, v18
    v_mov_b32 v19, s87
    v_add_co_u32 v18, vcc, s86, v18
    s_nop 1
    v_addc_co_u32 v19, vcc, 0, v19, vcc
    s_mov_b64 exec, 0xffffff
    global_load_dword v25, v[18:19], off
    s_mov_b64 exec, -1
cpf_1:
    v_mfma_f32_16x16x32_bf16 v[200:203], v[112:115], v[84:87], v[200:203]
    v_mfma_f32_16x16x32_bf16 v[208:211], v[112:115], v[88:91], v[208:211]
    ds_read_b128 v[60:63], v1 offset:38912
    v_mfma_f32_16x16x32_bf16 v[216:219], v[112:115], v[92:95], v[216:219]
    v_mfma_f32_16x16x32_bf16 v[220:223], v[116:119], v[92:95], v[220:223]
    ds_read_b128 v[64:67], v1 offset:40960
    v_mfma_f32_16x16x32_bf16 v[212:215], v[116:119], v[88:91], v[212:215]
    ds_read_b128 v[68:71], v1 offset:43008
    v_mfma_f32_16x16x32_bf16 v[204:207], v[116:119], v[84:87], v[204:207]
    v_mfma_f32_16x16x32_bf16 v[196:199], v[116:119], v[80:83], v[196:199]
    ds_read_b128 v[72:75], v1 offset:45056
    v_mfma_f32_16x16x32_bf16 v[224:227], v[120:123], v[80:83], v[224:227]
    v_mfma_f32_16x16x32_bf16 v[232:235], v[120:123], v[84:87], v[232:235]
    ds_read_b128 v[76:79], v1 offset:47104
    v_mfma_f32_16x16x32_bf16 v[240:243], v[120:123], v[88:91], v[240:243]
    v_mfma_f32_16x16x32_bf16 v[248:251], v[120:123], v[92:95], v[248:251]
    v_mfma_f32_16x16x32_bf16 v[252:255], v[124:127], v[92:95], v[252:255]
    v_mfma_f32_16x16x32_bf16 v[244:247], v[124:127], v[88:91], v[244:247]
    v_mfma_f32_16x16x32_bf16 v[236:239], v[124:127], v[84:87], v[236:239]
    v_mfma_f32_16x16x32_bf16 v[228:231], v[124:127], v[80:83], v[228:231]
    s_waitcnt lgkmcnt(0)
    s_barrier
    v_mfma_f32_16x16x32_bf16 v[128:131], v[48:51], v[32:35], v[128:131]
    ds_read_b64_tr_b16 v[80:81], v2 offset:16384
    v_mfma_f32_16x16x32_bf16 v[136:139], v[48:51], v[36:39], v[136:139]
    ds_read_b64_tr_b16 v[82:83], v2 offset:17408
    v_mfma_f32_16x16x32_bf16 v[144:147], v[48:51], v[40:43], v[144:147]
    v_mfma_f32_16x16x32_bf16 v[152:155], v[48:51], v[44:47], v[152:155]
    ds_read_b64_tr_b16 v[84:85], v3 offset:16384
    v_mfma_f32_16x16x32_bf16 v[156:159], v[52:55], v[44:47], v[156:159]
    v_mfma_f32_16x16x32_bf16 v[148:151], v[52:55], v[40:43], v[148:151]
    ds_read_b64_tr_b16 v[86:87], v3 offset:17408
    v_mfma_f32_16x16x32_bf16 v[140:143], v[52:55], v[36:39], v[140:143]
    ds_read_b64_tr_b16 v[88:89], v4 offset:16384
    v_mfma_f32_16x16x32_bf16 v[132:135], v[52:55], v[32:35], v[132:135]
    v_mfma_f32_16x16x32_bf16 v[160:163], v[56:59], v[32:35], v[160:163]
    ds_read_b64_tr_b16 v[90:91], v4 offset:17408
    v_mfma_f32_16x16x32_bf16 v[168:171], v[56:59], v[36:39], v[168:171]
    v_mfma_f32_16x16x32_bf16 v[176:179], v[56:59], v[40:43], v[176:179]
    ds_read_b64_tr_b16 v[92:93], v5 offset:16384
    v_mfma_f32_16x16x32_bf16 v[184:187], v[56:59], v[44:47], v[184:187]
    ds_read_b64_tr_b16 v[94:95], v5 offset:17408
    v_mfma_f32_16x16x32_bf16 v[188:191], v[60:63], v[44:47], v[188:191]
    v_mfma_f32_16x16x32_bf16 v[180:183], v[60:63], v[40:43], v[180:183]
    ds_read_b128 v[96:99], v6 offset:32768
    v_mfma_f32_16x16x32_bf16 v[172:175], v[60:63], v[36:39], v[172:175]
    v_mfma_f32_16x16x32_bf16 v[164:167], v[60:63], v[32:35], v[164:167]
    ds_read_b128 v[100:103], v6 offset:34816
    v_mfma_f32_16x16x32_bf16 v[192:195], v[64:67], v[32:35], v[192:195]
    ds_read_b128 v[104:107], v6 offset:36864
    v_mfma_f32_16x16x32_bf16 v[200:203], v[64:67], v[36:39], v[200:203]
    v_mfma_f32_16x16x32_bf16 v[208:211], v[64:67], v[40:43], v[208:211]
    ds_read_b128 v[108:111], v6 offset:38912
    v_mfma_f32_16x16x32_bf16 v[216:219], v[64:67], v[44:47], v[216:219]
    v_mfma_f32_16x16x32_bf16 v[220:223], v[68:71], v[44:47], v[220:223]
    ds_read_b128 v[112:115], v6 offset:40960
    v_mfma_f32_16x16x32_bf16 v[212:215], v[68:71], v[40:43], v[212:215]
    ds_read_b128 v[116:119], v6 offset:43008
    v_mfma_f32_16x16x32_bf16 v[204:207], v[68:71], v[36:39], v[204:207]
    v_mfma_f32_16x16x32_bf16 v[196:199], v[68:71], v[32:35], v[196:199]
    ds_read_b128 v[120:123], v6 offset:45056
    v_mfma_f32_16x16x32_bf16 v[224:227], v[72:75], v[32:35], v[224:227]
    v_mfma_f32_16x16x32_bf16 v[232:235], v[72:75], v[36:39], v[232:235]
    ds_read_b128 v[124:127], v6 offset:47104
    v_mfma_f32_16x16x32_bf16 v[240:243], v[72:75], v[40:43], v[240:243]
    v_mfma_f32_16x16x32_bf16 v[248:251], v[72:75], v[44:47], v[248:251]
    v_mfma_f32_16x16x32_bf16 v[252:255], v[76:79], v[44:47], v[252:255]
    v_mfma_f32_16x16x32_bf16 v[244:247], v[76:79], v[40:43], v[244:247]
    v_mfma_f32_16x16x32_bf16 v[236:239], v[76:79], v[36:39], v[236:239]
    v_mfma_f32_16x16x32_bf16 v[228:231], v[76:79], v[32:35], v[228:231]
    s_waitcnt lgkmcnt(0)
    s_barrier
    v_mfma_f32_16x16x32_bf16 v[128:131], v[96:99], v[80:83], v[128:131]
    ds_read_b64_tr_b16 v[32:33], v2 offset:32768
    v_mfma_f32_16x16x32_bf16 v[136:139], v[96:99], v[84:87], v[136:139]
    ds_read_b64_tr_b16 v[34:35], v2 offset:33792
    v_mfma_f32_16x16x32_bf16 v[144:147], v[96:99], v[88:91], v[144:147]
    v_mfma_f32_16x16x32_bf16 v[152:155], v[96:99], v[92:95], v[152:155]
    ds_read_b64_tr_b16 v[36:37], v3 offset:32768
    v_mfma_f32_16x16x32_bf16 v[156:159], v[100:103], v[92:95], v[156:159]
    v_mfma_f32_16x16x32_bf16 v[148:151], v[100:103], v[88:91], v[148:151]
    ds_read_b64_tr_b16 v[38:39], v3 offset:33792
    v_mfma_f32_16x16x32_bf16 v[140:143], v[100:103], v[84:87], v[140:143]
    ds_read_b64_tr_b16 v[40:41], v4 offset:32768
    v_mfma_f32_16x16x32_bf16 v[132:135], v[100:103], v[80:83], v[132:135]
    v_mfma_f32_16x16x32_bf16 v[160:163], v[104:107], v[80:83], v[160:163]
    ds_read_b64_tr_b16 v[42:43], v4 offset:33792
    v_mfma_f32_16x16x32_bf16 v[168:171], v[104:107], v[84:87], v[168:171]
    v_mfma_f32_16x16x32_bf16 v[176:179], v[104:107], v[88:91], v[176:179]
    ds_read_b64_tr_b16 v[44:45], v5 offset:32768
    v_mfma_f32_16x16x32_bf16 v[184:187], v[104:107], v[92:95], v[184:187]
    ds_read_b64_tr_b16 v[46:47], v5 offset:33792
    v_mfma_f32_16x16x32_bf16 v[188:191], v[108:111], v[92:95], v[188:191]
    v_mfma_f32_16x16x32_bf16 v[180:183], v[108:111], v[88:91], v[180:183]
    ds_read_b128 v[48:51], v7 offset:0
    v_mfma_f32_16x16x32_bf16 v[172:175], v[108:111], v[84:87], v[172:175]
    v_mfma_f32_16x16x32_bf16 v[164:167], v[108:111], v[80:83], v[164:167]
    ds_read_b128 v[52:55], v7 offset:2048
    v_mfma_f32_16x16x32_bf16 v[192:195], v[112:115], v[80:83], v[192:195]
    ds_read_b128 v[56:59], v7 offset:4096
    v_mfma_f32_16x16x32_bf16 v[200:203], v[112:115], v[84:87], v[200:203]
    v_mfma_f32_16x16x32_bf16 v[208:211], v[112:115], v[88:91], v[208:211]
    ds_read_b128 v[60:63], v7 offset:6144
    v_mfma_f32_16x16x32_bf16 v[216:219], v[112:115], v[92:95], v[216:219]
    v_mfma_f32_16x16x32_bf16 v[220:223], v[116:119], v[92:95], v[220:223]
    ds_read_b128 v[64:67], v7 offset:8192
    v_mfma_f32_16x16x32_bf16 v[212:215], v[116:119], v[88:91], v[212:215]
    ds_read_b128 v[68:71], v7 offset:10240
    v_mfma_f32_16x16x32_bf16 v[204:207], v[116:119], v[84:87], v[204:207]
    v_mfma_f32_16x16x32_bf16 v[196:199], v[116:119], v[80:83], v[196:199]
    ds_read_b128 v[72:75], v7 offset:12288
    v_mfma_f32_16x16x32_bf16 v[224:227], v[120:123], v[80:83], v[224:227]
    v_mfma_f32_16x16x32_bf16 v[232:235], v[120:123], v[84:87], v[232:235]
    ds_read_b128 v[76:79], v7 offset:14336
    v_mfma_f32_16x16x32_bf16 v[240:243], v[120:123], v[88:91], v[240:243]
    v_mfma_f32_16x16x32_bf16 v[248:251], v[120:123], v[92:95], v[248:251]
    v_mfma_f32_16x16x32_bf16 v[252:255], v[124:127], v[92:95], v[252:255]
    v_mfma_f32_16x16x32_bf16 v[244:247], v[124:127], v[88:91], v[244:247]
    v_mfma_f32_16x16x32_bf16 v[236:239], v[124:127], v[84:87], v[236:239]
    v_mfma_f32_16x16x32_bf16 v[228:231], v[124:127], v[80:83], v[228:231]
    s_waitcnt lgkmcnt(0)
    s_barrier
    v_mfma_f32_16x16x32_bf16 v[128:131], v[48:51], v[32:35], v[128:131]
    ds_read_b64_tr_b16 v[80:81], v2 offset:49152
    v_mfma_f32_16x16x32_bf16 v[136:139], v[48:51], v[36:39], v[136:139]
    ds_read_b64_tr_b16 v[82:83], v2 offset:50176
    v_mfma_f32_16x16x32_bf16 v[144:147], v[48:51], v[40:43], v[144:147]
    v_mfma_f32_16x16x32_bf16 v[152:155], v[48:51], v[44:47], v[152:155]
    ds_read_b64_tr_b16 v[84:85], v3 offset:49152
    v_mfma_f32_16x16x32_bf16 v[156:159], v[52:55], v[44:47], v[156:159]
    v_mfma_f32_16x16x32_bf16 v[148:151], v[52:55], v[40:43], v[148:151]
    ds_read_b64_tr_b16 v[86:87], v3 offset:50176
    v_mfma_f32_16x16x32_bf16 v[140:143], v[52:55], v[36:39], v[140:143]
    ds_read_b64_tr_b16 v[88:89], v4 offset:49152
    v_mfma_f32_16x16x32_bf16 v[132:135], v[52:55], v[32:35], v[132:135]
    v_mfma_f32_16x16x32_bf16 v[160:163], v[56:59], v[32:35], v[160:163]
    ds_read_b64_tr_b16 v[90:91], v4 offset:50176
    v_mfma_f32_16x16x32_bf16 v[168:171], v[56:59], v[36:39], v[168:171]
    v_mfma_f32_16x16x32_bf16 v[176:179], v[56:59], v[40:43], v[176:179]
    ds_read_b64_tr_b16 v[92:93], v5 offset:49152
    v_mfma_f32_16x16x32_bf16 v[184:187], v[56:59], v[44:47], v[184:187]
    ds_read_b64_tr_b16 v[94:95], v5 offset:50176
    v_mfma_f32_16x16x32_bf16 v[188:191], v[60:63], v[44:47], v[188:191]
    v_mfma_f32_16x16x32_bf16 v[180:183], v[60:63], v[40:43], v[180:183]
    ds_read_b128 v[96:99], v9 offset:0
    v_mfma_f32_16x16x32_bf16 v[172:175], v[60:63], v[36:39], v[172:175]
    v_mfma_f32_16x16x32_bf16 v[164:167], v[60:63], v[32:35], v[164:167]
    ds_read_b128 v[100:103], v9 offset:2048
    v_mfma_f32_16x16x32_bf16 v[192:195], v[64:67], v[32:35], v[192:195]
    ds_read_b128 v[104:107], v9 offset:4096
    v_mov_b32 v26, -1
    v_mov_b32 v27, -1
    v_mov_b32 v28, -1
    v_mov_b32 v29, -1
    s_lshl_b32 s58, s2, 13
    s_add_u32 s58, s58, s60
    s_add_u32 s58, s58, 56098816
    buffer_store_dwordx4 v[26:29], v15, s[8:11], s58 offen sc1
    buffer_store_dwordx4 v[26:29], v15, s[8:11], s58 offen offset:1024 sc1
    s_lshl_b32 s58, s2, 10
    s_add_u32 s58, s58, 68681728
    s_cmp_eq_u32 s65, 0
    s_cselect_b32 s58, s58, 1073741824
    buffer_store_dwordx4 v[26:29], v15, s[8:11], s58 offen sc1
    s_lshl_b32 s58, s2, 2
    s_add_u32 s58, s58, s65
    s_lshl_b32 s58, s58, 6
    s_add_u32 s58, s58, 55574528
    s_mov_b64 exec, 15
    buffer_store_dwordx4 v[26:29], v15, s[8:11], s58 offen sc1
    s_mov_b64 exec, -1
    v_mfma_f32_16x16x32_bf16 v[200:203], v[64:67], v[36:39], v[200:203]
    v_mfma_f32_16x16x32_bf16 v[208:211], v[64:67], v[40:43], v[208:211]
    ds_read_b128 v[108:111], v9 offset:6144
    v_mfma_f32_16x16x32_bf16 v[216:219], v[64:67], v[44:47], v[216:219]
    v_mfma_f32_16x16x32_bf16 v[220:223], v[68:71], v[44:47], v[220:223]
    ds_read_b128 v[112:115], v9 offset:8192
    v_mfma_f32_16x16x32_bf16 v[212:215], v[68:71], v[40:43], v[212:215]
    ds_read_b128 v[116:119], v9 offset:10240
    v_mfma_f32_16x16x32_bf16 v[204:207], v[68:71], v[36:39], v[204:207]
    v_mfma_f32_16x16x32_bf16 v[196:199], v[68:71], v[32:35], v[196:199]
    ds_read_b128 v[120:123], v9 offset:12288
    v_mfma_f32_16x16x32_bf16 v[224:227], v[72:75], v[32:35], v[224:227]
    v_mfma_f32_16x16x32_bf16 v[232:235], v[72:75], v[36:39], v[232:235]
    ds_read_b128 v[124:127], v9 offset:14336
    v_mfma_f32_16x16x32_bf16 v[240:243], v[72:75], v[40:43], v[240:243]
    v_mfma_f32_16x16x32_bf16 v[248:251], v[72:75], v[44:47], v[248:251]
    v_mfma_f32_16x16x32_bf16 v[252:255], v[76:79], v[44:47], v[252:255]
    v_mfma_f32_16x16x32_bf16 v[244:247], v[76:79], v[40:43], v[244:247]
    v_mfma_f32_16x16x32_bf16 v[236:239], v[76:79], v[36:39], v[236:239]
    v_mfma_f32_16x16x32_bf16 v[228:231], v[76:79], v[32:35], v[228:231]
    s_waitcnt lgkmcnt(0)
    s_barrier
    v_mfma_f32_16x16x32_bf16 v[252:255], v[124:127], v[92:95], v[252:255]
    v_add_u32 v1, s77, v21
    v_xor_b32 v5, 64, v1
    v_xor_b32 v2, 32, v22
    v_xor_b32 v3, 96, v22
    v_xor_b32 v4, 160, v22
    v_mfma_f32_16x16x32_bf16 v[248:251], v[120:123], v[92:95], v[248:251]
    ds_read_b128 v[44:47], v1 offset:0
    v_mfma_f32_16x16x32_bf16 v[244:247], v[124:127], v[88:91], v[244:247]
    v_mfma_f32_16x16x32_bf16 v[240:243], v[120:123], v[88:91], v[240:243]
    ds_read_b128 v[48:51], v1 offset:2048
    v_mfma_f32_16x16x32_bf16 v[236:239], v[124:127], v[84:87], v[236:239]
    ds_read_b64_tr_b16 v[32:33], v2 offset:0
    v_mfma_f32_16x16x32_bf16 v[232:235], v[120:123], v[84:87], v[232:235]
    v_mfma_f32_16x16x32_bf16 v[228:231], v[124:127], v[80:83], v[228:231]
    ds_read_b64_tr_b16 v[34:35], v2 offset:1024
    v_mfma_f32_16x16x32_bf16 v[224:227], v[120:123], v[80:83], v[224:227]
    ds_read_b64_tr_b16 v[36:37], v3 offset:0
    v_mfma_f32_16x16x32_bf16 v[220:223], v[116:119], v[92:95], v[220:223]
    v_cvt_pk_bf16_f32 v255, v254, v255
    v_cvt_pk_bf16_f32 v254, v252, v253
    v_lshrrev_b32 v16, 4, v0
    s_lshl_b32 s57, s65, 2
    v_add_u32 v16, s57, v16
    v_and_b32 v17, 7, v16
    v_lshlrev_b32 v17, 1, v17
    v_and_b32 v20, 15, v0
    v_xor_b32 v20, v20, v17
    v_lshlrev_b32 v20, 4, v20
    v_lshl_or_b32 v20, v16, 10, v20
    v_lshrrev_b32 v17, 2, v0
    v_lshlrev_b32 v17, 10, v17
    v_and_b32 v19, 3, v0
    v_lshl_or_b32 v17, v19, 4, v17
    s_lshr_b32 s58, s2, 4
    s_lshl_b32 s58, s58, 1
    s_add_u32 s58, s58, s65
    s_lshl_b32 s58, s58, 14
    s_and_b32 s59, s2, 15
    s_lshl_b32 s59, s59, 6
    s_add_u32 s58, s58, s59
    s_cmp_lt_u32 s65, 2
    s_cselect_b32 s58, s58, 1073741824
    v_mfma_f32_16x16x32_bf16 v[216:219], v[112:115], v[92:95], v[216:219]
    v_cvt_pk_bf16_f32 v253, v250, v251
    v_cvt_pk_bf16_f32 v252, v248, v249
    ds_read_b64_tr_b16 v[38:39], v3 offset:1024
    v_mfma_f32_16x16x32_bf16 v[212:215], v[116:119], v[88:91], v[212:215]
    v_cvt_pk_bf16_f32 v251, v246, v247
    v_cvt_pk_bf16_f32 v250, v244, v245
    v_mfma_f32_16x16x32_bf16 v[208:211], v[112:115], v[88:91], v[208:211]
    v_cvt_pk_bf16_f32 v249, v242, v243
    v_cvt_pk_bf16_f32 v248, v240, v241
    ds_read_b64_tr_b16 v[40:41], v4 offset:0
    v_mfma_f32_16x16x32_bf16 v[204:207], v[116:119], v[84:87], v[204:207]
    v_cvt_pk_bf16_f32 v247, v238, v239
    v_cvt_pk_bf16_f32 v246, v236, v237
    ds_read_b64_tr_b16 v[42:43], v4 offset:1024
    v_mfma_f32_16x16x32_bf16 v[200:203], v[112:115], v[84:87], v[200:203]
    v_cvt_pk_bf16_f32 v245, v234, v235
    v_cvt_pk_bf16_f32 v244, v232, v233
    v_mfma_f32_16x16x32_bf16 v[196:199], v[116:119], v[80:83], v[196:199]
    v_cvt_pk_bf16_f32 v243, v230, v231
    v_cvt_pk_bf16_f32 v242, v228, v229
    ds_read_b128 v[64:67], v5 offset:0
    v_mfma_f32_16x16x32_bf16 v[192:195], v[112:115], v[80:83], v[192:195]
    v_cvt_pk_bf16_f32 v241, v226, v227
    v_cvt_pk_bf16_f32 v240, v224, v225
    ds_read_b128 v[68:71], v5 offset:2048
    v_mfma_f32_16x16x32_bf16 v[188:191], v[108:111], v[92:95], v[188:191]
    v_cvt_pk_bf16_f32 v239, v222, v223
    v_cvt_pk_bf16_f32 v238, v220, v221
    v_mfma_f32_16x16x32_bf16 v[184:187], v[104:107], v[92:95], v[184:187]
    v_cvt_pk_bf16_f32 v237, v218, v219
    v_cvt_pk_bf16_f32 v236, v216, v217
    ds_read_b64_tr_b16 v[52:53], v2 offset:8192
    v_mfma_f32_16x16x32_bf16 v[180:183], v[108:111], v[88:91], v[180:183]
    v_cvt_pk_bf16_f32 v235, v214, v215
    v_cvt_pk_bf16_f32 v234, v212, v213
    v_mfma_f32_16x16x32_bf16 v[176:179], v[104:107], v[88:91], v[176:179]
    v_cvt_pk_bf16_f32 v233, v210, v211
    v_cvt_pk_bf16_f32 v232, v208, v209
    ds_read_b64_tr_b16 v[54:55], v2 offset:9216
    v_mfma_f32_16x16x32_bf16 v[172:175], v[108:111], v[84:87], v[172:175]
    v_cvt_pk_bf16_f32 v231, v206, v207
    v_cvt_pk_bf16_f32 v230, v204, v205
    ds_read_b64_tr_b16 v[56:57], v3 offset:8192
    v_mfma_f32_16x16x32_bf16 v[168:171], v[104:107], v[84:87], v[168:171]
    v_cvt_pk_bf16_f32 v229, v202, v203
    v_cvt_pk_bf16_f32 v228, v200, v201
    v_mfma_f32_16x16x32_bf16 v[164:167], v[108:111], v[80:83], v[164:167]
    v_cvt_pk_bf16_f32 v227, v198, v199
    v_cvt_pk_bf16_f32 v226, v196, v197
    ds_read_b64_tr_b16 v[58:59], v3 offset:9216
    v_mfma_f32_16x16x32_bf16 v[160:163], v[104:107], v[80:83], v[160:163]
    v_cvt_pk_bf16_f32 v225, v194, v195
    v_cvt_pk_bf16_f32 v224, v192, v193
    ds_read_b64_tr_b16 v[60:61], v4 offset:8192
    v_mfma_f32_16x16x32_bf16 v[156:159], v[100:103], v[92:95], v[156:159]
    v_cvt_pk_bf16_f32 v223, v190, v191
    v_cvt_pk_bf16_f32 v222, v188, v189
    s_add_u32 m0, s60, 147456
    s_add_u32 s64, s58, 0
    buffer_load_dwordx4 v17, s[48:51], s64 offen lds
    v_mfma_f32_16x16x32_bf16 v[152:155], v[96:99], v[92:95], v[152:155]
    v_cvt_pk_bf16_f32 v221, v186, v187
    v_cvt_pk_bf16_f32 v220, v184, v185
    ds_read_b64_tr_b16 v[62:63], v4 offset:9216
    v_mfma_f32_16x16x32_bf16 v[148:151], v[100:103], v[88:91], v[148:151]
    v_cvt_pk_bf16_f32 v219, v182, v183
    v_cvt_pk_bf16_f32 v218, v180, v181
    v_mfma_f32_16x16x32_bf16 v[144:147], v[96:99], v[88:91], v[144:147]
    v_cvt_pk_bf16_f32 v217, v178, v179
    v_cvt_pk_bf16_f32 v216, v176, v177
    v_mfma_f32_16x16x32_bf16 v[140:143], v[100:103], v[84:87], v[140:143]
    v_cvt_pk_bf16_f32 v215, v174, v175
    v_cvt_pk_bf16_f32 v214, v172, v173
    v_mfma_f32_16x16x32_bf16 v[136:139], v[96:99], v[84:87], v[136:139]
    v_cvt_pk_bf16_f32 v213, v170, v171
    v_cvt_pk_bf16_f32 v212, v168, v169
    v_mfma_f32_16x16x32_bf16 v[132:135], v[100:103], v[80:83], v[132:135]
    v_cvt_pk_bf16_f32 v211, v166, v167
    v_cvt_pk_bf16_f32 v210, v164, v165
    v_mfma_f32_16x16x32_bf16 v[128:131], v[96:99], v[80:83], v[128:131]
    v_cvt_pk_bf16_f32 v209, v162, v163
    v_cvt_pk_bf16_f32 v208, v160, v161
    v_cvt_pk_bf16_f32 v207, v158, v159
    v_cvt_pk_bf16_f32 v206, v156, v157
    v_cvt_pk_bf16_f32 v205, v154, v155
    v_cvt_pk_bf16_f32 v204, v152, v153
    v_cvt_pk_bf16_f32 v203, v150, v151
    v_cvt_pk_bf16_f32 v202, v148, v149
    v_cvt_pk_bf16_f32 v201, v146, v147
    v_cvt_pk_bf16_f32 v200, v144, v145
    v_cvt_pk_bf16_f32 v199, v142, v143
    v_cvt_pk_bf16_f32 v198, v140, v141
    v_cvt_pk_bf16_f32 v197, v138, v139
    v_cvt_pk_bf16_f32 v196, v136, v137
    v_cvt_pk_bf16_f32 v195, v134, v135
    v_cvt_pk_bf16_f32 v194, v132, v133
    v_cvt_pk_bf16_f32 v193, v130, v131
    v_cvt_pk_bf16_f32 v192, v128, v129
    s_lshl_b32 s58, s7, 10
    v_lshrrev_b32 v16, 4, v0
    v_and_b32 v17, 15, v0
    v_lshlrev_b32 v18, 1, v17
    v_lshl_or_b32 v18, v16, 7, v18
    buffer_load_ushort v152, v18, s[52:55], s58 offen offset:512
    buffer_load_ushort v153, v18, s[52:55], s58 offen offset:576
    buffer_load_ushort v154, v18, s[52:55], s58 offen offset:544
    buffer_load_ushort v155, v18, s[52:55], s58 offen offset:608
    s_waitcnt lgkmcnt(0)
    s_barrier
    v_mfma_f32_16x16x32_bf16 v[128:131], v[32:35], v[44:47], 0
    ds_read_b128 v[92:95], v1 offset:16384
    ds_read_b128 v[96:99], v1 offset:18432
    v_mfma_f32_16x16x32_bf16 v[128:131], v[52:55], v[64:67], v[128:131]
    ds_read_b64_tr_b16 v[80:81], v2 offset:16384
    ds_read_b64_tr_b16 v[82:83], v2 offset:17408
    v_mfma_f32_16x16x32_bf16 v[136:139], v[36:39], v[44:47], 0
    ds_read_b64_tr_b16 v[84:85], v3 offset:16384
    v_mfma_f32_16x16x32_bf16 v[136:139], v[56:59], v[64:67], v[136:139]
    ds_read_b64_tr_b16 v[86:87], v3 offset:17408
    ds_read_b64_tr_b16 v[88:89], v4 offset:16384
    v_mfma_f32_16x16x32_bf16 v[144:147], v[44:47], v[40:43], 0
    ds_read_b64_tr_b16 v[90:91], v4 offset:17408
    v_mfma_f32_16x16x32_bf16 v[144:147], v[64:67], v[60:63], v[144:147]
    ds_read_b128 v[112:115], v5 offset:16384
    ds_read_b128 v[116:119], v5 offset:18432
    v_mfma_f32_16x16x32_bf16 v[132:135], v[32:35], v[48:51], 0
    ds_read_b64_tr_b16 v[100:101], v2 offset:24576
    ds_read_b64_tr_b16 v[102:103], v2 offset:25600
    v_add_u32 v192, 0x20002000, v192
    v_add_u32 v193, 0x20002000, v193
    v_add_u32 v194, 0x20002000, v194
    v_add_u32 v195, 0x20002000, v195
    s_add_u32 s99, s66, 0
    buffer_store_dwordx4 v[192:195], v15, s[8:11], s99 offen offset:0 sc1
    v_mfma_f32_16x16x32_bf16 v[132:135], v[52:55], v[68:71], v[132:135]
    ds_read_b64_tr_b16 v[104:105], v3 offset:24576
    v_mfma_f32_16x16x32_bf16 v[140:143], v[36:39], v[48:51], 0
    ds_read_b64_tr_b16 v[106:107], v3 offset:25600
    ds_read_b64_tr_b16 v[108:109], v4 offset:24576
    v_mfma_f32_16x16x32_bf16 v[140:143], v[56:59], v[68:71], v[140:143]
    ds_read_b64_tr_b16 v[110:111], v4 offset:25600
    v_mfma_f32_16x16x32_bf16 v[148:151], v[48:51], v[40:43], 0
    v_mfma_f32_16x16x32_bf16 v[148:151], v[68:71], v[60:63], v[148:151]
    s_waitcnt lgkmcnt(0)
    s_barrier
    v_mfma_f32_16x16x32_bf16 v[128:131], v[80:83], v[92:95], v[128:131]
    ds_read_b128 v[44:47], v1 offset:32768
    ds_read_b128 v[48:51], v1 offset:34816
    v_mfma_f32_16x16x32_bf16 v[128:131], v[100:103], v[112:115], v[128:131]
    ds_read_b64_tr_b16 v[32:33], v2 offset:32768
    ds_read_b64_tr_b16 v[34:35], v2 offset:33792
    v_mfma_f32_16x16x32_bf16 v[136:139], v[84:87], v[92:95], v[136:139]
    ds_read_b64_tr_b16 v[36:37], v3 offset:32768
    v_mfma_f32_16x16x32_bf16 v[136:139], v[104:107], v[112:115], v[136:139]
    ds_read_b64_tr_b16 v[38:39], v3 offset:33792
    ds_read_b64_tr_b16 v[40:41], v4 offset:32768
    v_add_u32 v196, 0x20002000, v196
    v_add_u32 v197, 0x20002000, v197
    v_add_u32 v198, 0x20002000, v198
    v_add_u32 v199, 0x20002000, v199
    s_add_u32 s99, s66, 0
    buffer_store_dwordx4 v[196:199], v15, s[8:11], s99 offen offset:1024 sc1
    v_mfma_f32_16x16x32_bf16 v[144:147], v[92:95], v[88:91], v[144:147]
    ds_read_b64_tr_b16 v[42:43], v4 offset:33792
    v_mfma_f32_16x16x32_bf16 v[144:147], v[112:115], v[108:111], v[144:147]
    ds_read_b128 v[64:67], v5 offset:32768
    ds_read_b128 v[68:71], v5 offset:34816
    v_mfma_f32_16x16x32_bf16 v[132:135], v[80:83], v[96:99], v[132:135]
    ds_read_b64_tr_b16 v[52:53], v2 offset:40960
    ds_read_b64_tr_b16 v[54:55], v2 offset:41984
    v_mfma_f32_16x16x32_bf16 v[132:135], v[100:103], v[116:119], v[132:135]
    ds_read_b64_tr_b16 v[56:57], v3 offset:40960
    v_mfma_f32_16x16x32_bf16 v[140:143], v[84:87], v[96:99], v[140:143]
    ds_read_b64_tr_b16 v[58:59], v3 offset:41984
    ds_read_b64_tr_b16 v[60:61], v4 offset:40960
    v_mfma_f32_16x16x32_bf16 v[140:143], v[104:107], v[116:119], v[140:143]
    ds_read_b64_tr_b16 v[62:63], v4 offset:41984
    v_lshlrev_b32 v16, 2, v16
    v_sub_u32 v16, v17, v16
    v_mov_b32 v17, 0x3f80
    v_mov_b32 v18, 0x3f800000
    v_mfma_f32_16x16x32_bf16 v[148:151], v[96:99], v[88:91], v[148:151]
    v_mfma_f32_16x16x32_bf16 v[148:151], v[116:119], v[108:111], v[148:151]
    s_waitcnt lgkmcnt(0)
    s_barrier
    v_mfma_f32_16x16x32_bf16 v[128:131], v[32:35], v[44:47], v[128:131]
    ds_read_b128 v[92:95], v1 offset:49152
    ds_read_b128 v[96:99], v1 offset:51200
    v_mfma_f32_16x16x32_bf16 v[128:131], v[52:55], v[64:67], v[128:131]
    ds_read_b64_tr_b16 v[80:81], v2 offset:49152
    ds_read_b64_tr_b16 v[82:83], v2 offset:50176
    v_mfma_f32_16x16x32_bf16 v[136:139], v[36:39], v[44:47], v[136:139]
    ds_read_b64_tr_b16 v[84:85], v3 offset:49152
    v_mfma_f32_16x16x32_bf16 v[136:139], v[56:59], v[64:67], v[136:139]
    ds_read_b64_tr_b16 v[86:87], v3 offset:50176
    ds_read_b64_tr_b16 v[88:89], v4 offset:49152
    v_add_u32 v200, 0x20002000, v200
    v_add_u32 v201, 0x20002000, v201
    v_add_u32 v202, 0x20002000, v202
    v_add_u32 v203, 0x20002000, v203
    s_add_u32 s99, s66, 0
    buffer_store_dwordx4 v[200:203], v15, s[8:11], s99 offen offset:2048 sc1
    v_mfma_f32_16x16x32_bf16 v[144:147], v[44:47], v[40:43], v[144:147]
    ds_read_b64_tr_b16 v[90:91], v4 offset:50176
    v_mfma_f32_16x16x32_bf16 v[144:147], v[64:67], v[60:63], v[144:147]
    ds_read_b128 v[112:115], v5 offset:49152
    ds_read_b128 v[116:119], v5 offset:51200
    v_mfma_f32_16x16x32_bf16 v[132:135], v[32:35], v[48:51], v[132:135]
    ds_read_b64_tr_b16 v[100:101], v2 offset:57344
    ds_read_b64_tr_b16 v[102:103], v2 offset:58368
    v_mfma_f32_16x16x32_bf16 v[132:135], v[52:55], v[68:71], v[132:135]
    ds_read_b64_tr_b16 v[104:105], v3 offset:57344
    v_mfma_f32_16x16x32_bf16 v[140:143], v[36:39], v[48:51], v[140:143]
    ds_read_b64_tr_b16 v[106:107], v3 offset:58368
    ds_read_b64_tr_b16 v[108:109], v4 offset:57344
    v_mfma_f32_16x16x32_bf16 v[140:143], v[56:59], v[68:71], v[140:143]
    ds_read_b64_tr_b16 v[110:111], v4 offset:58368
    v_cmp_eq_u32 vcc, 0, v16
    v_mov_b32 v178, 0
    v_mov_b32 v180, 0
    v_cndmask_b32 v176, 0, v17, vcc
    v_mfma_f32_16x16x32_bf16 v[148:151], v[48:51], v[40:43], v[148:151]
    v_mfma_f32_16x16x32_bf16 v[148:151], v[68:71], v[60:63], v[148:151]
    s_waitcnt vmcnt(7) lgkmcnt(0)
    s_barrier
    v_mfma_f32_16x16x32_bf16 v[128:131], v[80:83], v[92:95], v[128:131]
    ds_read_b128 v[44:47], v1 offset:0
    ds_read_b128 v[48:51], v1 offset:2048
    v_mfma_f32_16x16x32_bf16 v[128:131], v[100:103], v[112:115], v[128:131]
    ds_read_b64_tr_b16 v[32:33], v2 offset:0
    ds_read_b64_tr_b16 v[34:35], v2 offset:1024
    v_mfma_f32_16x16x32_bf16 v[136:139], v[84:87], v[92:95], v[136:139]
    ds_read_b64_tr_b16 v[36:37], v3 offset:0
    ds_read_b64_tr_b16 v[26:27], v8
    ds_read_b64_tr_b16 v[28:29], v8 offset:2048
    v_mfma_f32_16x16x32_bf16 v[136:139], v[104:107], v[112:115], v[136:139]
    ds_read_b64_tr_b16 v[38:39], v3 offset:1024
    ds_read_b64_tr_b16 v[40:41], v4 offset:0
    v_mfma_f32_16x16x32_bf16 v[144:147], v[92:95], v[88:91], v[144:147]
    ds_read_b64_tr_b16 v[42:43], v4 offset:1024
    v_mfma_f32_16x16x32_bf16 v[144:147], v[112:115], v[108:111], v[144:147]
    ds_read_b128 v[64:67], v5 offset:0
    ds_read_b128 v[68:71], v5 offset:2048
    v_mfma_f32_16x16x32_bf16 v[132:135], v[80:83], v[96:99], v[132:135]
    ds_read_b64_tr_b16 v[52:53], v2 offset:8192
    ds_read_b64_tr_b16 v[54:55], v2 offset:9216
    v_add_u32 v204, 0x20002000, v204
    v_add_u32 v205, 0x20002000, v205
    v_add_u32 v206, 0x20002000, v206
    v_add_u32 v207, 0x20002000, v207
    s_add_u32 s99, s66, 0
    buffer_store_dwordx4 v[204:207], v15, s[8:11], s99 offen offset:3072 sc1
    v_mfma_f32_16x16x32_bf16 v[132:135], v[100:103], v[116:119], v[132:135]
    ds_read_b64_tr_b16 v[56:57], v3 offset:8192
    v_mfma_f32_16x16x32_bf16 v[140:143], v[84:87], v[96:99], v[140:143]
    ds_read_b64_tr_b16 v[58:59], v3 offset:9216
    ds_read_b64_tr_b16 v[60:61], v4 offset:8192
    v_mfma_f32_16x16x32_bf16 v[140:143], v[104:107], v[116:119], v[140:143]
    ds_read_b64_tr_b16 v[62:63], v4 offset:9216
    v_mfma_f32_16x16x32_bf16 v[148:151], v[96:99], v[88:91], v[148:151]
    v_cmp_eq_u32 vcc, 1, v16
    v_mov_b32 v184, 0x3f803f80
    v_mov_b32 v185, 0x3f803f80
    v_cndmask_b32 v176, v176, v18, vcc
    v_mfma_f32_16x16x32_bf16 v[148:151], v[116:119], v[108:111], v[148:151]
    s_waitcnt lgkmcnt(0)
    s_barrier
    v_mfma_f32_16x16x32_bf16 v[128:131], v[32:35], v[44:47], v[128:131]
    ds_read_b128 v[92:95], v1 offset:16384
    ds_read_b128 v[96:99], v1 offset:18432
    v_mfma_f32_16x16x32_bf16 v[128:131], v[52:55], v[64:67], v[128:131]
    ds_read_b64_tr_b16 v[80:81], v2 offset:16384
    ds_read_b64_tr_b16 v[82:83], v2 offset:17408
    v_mfma_f32_16x16x32_bf16 v[136:139], v[36:39], v[44:47], v[136:139]
    ds_read_b64_tr_b16 v[84:85], v3 offset:16384
    s_and_b32 s58, s2, 15
    s_lshl_b32 s58, s58, 1
    s_add_u32 s58, s58, s65
    s_lshl_b32 s58, s58, 4
    s_lshr_b32 s59, s2, 4
    s_add_u32 s58, s58, s59
    s_lshl_b32 s58, s58, 10
    s_add_u32 s58, s58, 63963136
    s_cmp_lt_u32 s65, 2
    s_cselect_b32 s58, s58, 1073741824
    buffer_store_dwordx4 v[26:29], v15, s[8:11], s58 offen sc1
    v_mfma_f32_16x16x32_bf16 v[136:139], v[56:59], v[64:67], v[136:139]
    ds_read_b64_tr_b16 v[86:87], v3 offset:17408
    ds_read_b64_tr_b16 v[88:89], v4 offset:16384
    v_mfma_f32_16x16x32_bf16 v[144:147], v[44:47], v[40:43], v[144:147]
    ds_read_b64_tr_b16 v[90:91], v4 offset:17408
    v_mfma_f32_16x16x32_bf16 v[144:147], v[64:67], v[60:63], v[144:147]
    ds_read_b128 v[112:115], v5 offset:16384
    ds_read_b128 v[116:119], v5 offset:18432
    v_mfma_f32_16x16x32_bf16 v[132:135], v[32:35], v[48:51], v[132:135]
    ds_read_b64_tr_b16 v[100:101], v2 offset:24576
    ds_read_b64_tr_b16 v[102:103], v2 offset:25600
    v_add_u32 v208, 0x20002000, v208
    v_add_u32 v209, 0x20002000, v209
    v_add_u32 v210, 0x20002000, v210
    v_add_u32 v211, 0x20002000, v211
    s_add_u32 s99, s66, 8192
    buffer_store_dwordx4 v[208:211], v15, s[8:11], s99 offen offset:0 sc1
    v_mfma_f32_16x16x32_bf16 v[132:135], v[52:55], v[68:71], v[132:135]
    ds_read_b64_tr_b16 v[104:105], v3 offset:24576
    v_mfma_f32_16x16x32_bf16 v[140:143], v[36:39], v[48:51], v[140:143]
    ds_read_b64_tr_b16 v[106:107], v3 offset:25600
    ds_read_b64_tr_b16 v[108:109], v4 offset:24576
    v_mfma_f32_16x16x32_bf16 v[140:143], v[56:59], v[68:71], v[140:143]
    ds_read_b64_tr_b16 v[110:111], v4 offset:25600
    v_mfma_f32_16x16x32_bf16 v[148:151], v[48:51], v[40:43], v[148:151]
    v_cmp_eq_u32 vcc, 2, v16
    v_mov_b32 v179, 0
    v_mov_b32 v181, 0
    v_cndmask_b32 v177, 0, v17, vcc
    v_mfma_f32_16x16x32_bf16 v[148:151], v[68:71], v[60:63], v[148:151]
    s_waitcnt lgkmcnt(0)
    s_barrier
    v_mfma_f32_16x16x32_bf16 v[128:131], v[80:83], v[92:95], v[128:131]
    ds_read_b128 v[44:47], v1 offset:32768
    ds_read_b128 v[48:51], v1 offset:34816
    v_mfma_f32_16x16x32_bf16 v[128:131], v[100:103], v[112:115], v[128:131]
    ds_read_b64_tr_b16 v[32:33], v2 offset:32768
    ds_read_b64_tr_b16 v[34:35], v2 offset:33792
    v_mfma_f32_16x16x32_bf16 v[136:139], v[84:87], v[92:95], v[136:139]
    ds_read_b64_tr_b16 v[36:37], v3 offset:32768
    v_mfma_f32_16x16x32_bf16 v[136:139], v[104:107], v[112:115], v[136:139]
    ds_read_b64_tr_b16 v[38:39], v3 offset:33792
    ds_read_b64_tr_b16 v[40:41], v4 offset:32768
    v_add_u32 v212, 0x20002000, v212
    v_add_u32 v213, 0x20002000, v213
    v_add_u32 v214, 0x20002000, v214
    v_add_u32 v215, 0x20002000, v215
    s_add_u32 s99, s66, 8192
    buffer_store_dwordx4 v[212:215], v15, s[8:11], s99 offen offset:1024 sc1
    v_mfma_f32_16x16x32_bf16 v[144:147], v[92:95], v[88:91], v[144:147]
    ds_read_b64_tr_b16 v[42:43], v4 offset:33792
    v_mfma_f32_16x16x32_bf16 v[144:147], v[112:115], v[108:111], v[144:147]
    ds_read_b128 v[64:67], v5 offset:32768
    ds_read_b128 v[68:71], v5 offset:34816
    v_mfma_f32_16x16x32_bf16 v[132:135], v[80:83], v[96:99], v[132:135]
    ds_read_b64_tr_b16 v[52:53], v2 offset:40960
    ds_read_b64_tr_b16 v[54:55], v2 offset:41984
    v_mfma_f32_16x16x32_bf16 v[132:135], v[100:103], v[116:119], v[132:135]
    ds_read_b64_tr_b16 v[56:57], v3 offset:40960
    v_mfma_f32_16x16x32_bf16 v[140:143], v[84:87], v[96:99], v[140:143]
    ds_read_b64_tr_b16 v[58:59], v3 offset:41984
    ds_read_b64_tr_b16 v[60:61], v4 offset:40960
    v_mfma_f32_16x16x32_bf16 v[140:143], v[104:107], v[116:119], v[140:143]
    ds_read_b64_tr_b16 v[62:63], v4 offset:41984
    v_cmp_eq_u32 vcc, 3, v16
    v_mov_b32 v186, 0x3f803f80
    v_mov_b32 v187, 0x3f803f80
    v_cndmask_b32 v177, v177, v18, vcc
    v_mfma_f32_16x16x32_bf16 v[148:151], v[96:99], v[88:91], v[148:151]
    v_mfma_f32_16x16x32_bf16 v[148:151], v[116:119], v[108:111], v[148:151]
    s_waitcnt lgkmcnt(0)
    s_barrier
    v_mfma_f32_16x16x32_bf16 v[128:131], v[32:35], v[44:47], v[128:131]
    ds_read_b128 v[92:95], v1 offset:49152
    ds_read_b128 v[96:99], v1 offset:51200
    s_mov_b32 s94, 0
    s_add_u32 m0, s77, 32768
    s_add_u32 s64, s80, 128
    buffer_load_dwordx4 v10, s[36:39], s64 offen lds
    v_mfma_f32_16x16x32_bf16 v[128:131], v[52:55], v[64:67], v[128:131]
    ds_read_b64_tr_b16 v[80:81], v2 offset:49152
    ds_read_b64_tr_b16 v[82:83], v2 offset:50176
    v_mfma_f32_16x16x32_bf16 v[136:139], v[36:39], v[44:47], v[136:139]
    ds_read_b64_tr_b16 v[84:85], v3 offset:49152
    s_add_u32 m0, s77, 33792
    s_add_u32 s64, s80, 8320
    buffer_load_dwordx4 v23, s[36:39], s64 offen lds
    v_mfma_f32_16x16x32_bf16 v[136:139], v[56:59], v[64:67], v[136:139]
    ds_read_b64_tr_b16 v[86:87], v3 offset:50176
    ds_read_b64_tr_b16 v[88:89], v4 offset:49152
    s_add_u32 m0, s77, 34816
    s_add_u32 s64, s80, 16512
    buffer_load_dwordx4 v10, s[36:39], s64 offen lds
    v_mfma_f32_16x16x32_bf16 v[144:147], v[44:47], v[40:43], v[144:147]
    ds_read_b64_tr_b16 v[90:91], v4 offset:50176
    v_mfma_f32_16x16x32_bf16 v[144:147], v[64:67], v[60:63], v[144:147]
    ds_read_b128 v[112:115], v5 offset:49152
    ds_read_b128 v[116:119], v5 offset:51200
    s_add_u32 m0, s77, 35840
    s_add_u32 s64, s80, 24704
    buffer_load_dwordx4 v23, s[36:39], s64 offen lds
    v_mfma_f32_16x16x32_bf16 v[132:135], v[32:35], v[48:51], v[132:135]
    ds_read_b64_tr_b16 v[100:101], v2 offset:57344
    ds_read_b64_tr_b16 v[102:103], v2 offset:58368
    s_add_u32 m0, s61, 81920
    s_add_u32 s64, s82, 524288
    buffer_load_dwordx4 v11, s[40:43], s64 offen lds
    v_mfma_f32_16x16x32_bf16 v[132:135], v[52:55], v[68:71], v[132:135]
    ds_read_b64_tr_b16 v[104:105], v3 offset:57344
    v_mfma_f32_16x16x32_bf16 v[140:143], v[36:39], v[48:51], v[140:143]
    ds_read_b64_tr_b16 v[106:107], v3 offset:58368
    ds_read_b64_tr_b16 v[108:109], v4 offset:57344
    s_add_u32 m0, s61, 86016
    s_add_u32 s64, s82, 655360
    buffer_load_dwordx4 v11, s[40:43], s64 offen lds
    v_mfma_f32_16x16x32_bf16 v[140:143], v[56:59], v[68:71], v[140:143]
    ds_read_b64_tr_b16 v[110:111], v4 offset:58368
    v_add_u32 v216, 0x20002000, v216
    v_add_u32 v217, 0x20002000, v217
    v_add_u32 v218, 0x20002000, v218
    v_add_u32 v219, 0x20002000, v219
    s_add_u32 s99, s66, 8192
    buffer_store_dwordx4 v[216:219], v15, s[8:11], s99 offen offset:2048 sc1
    v_mfma_f32_16x16x32_bf16 v[148:151], v[48:51], v[40:43], v[148:151]
    v_mfma_f32_16x16x32_bf16 v[148:151], v[68:71], v[60:63], v[148:151]
    v_mov_b32 v182, v176
    v_mov_b32 v183, v177
    s_waitcnt lgkmcnt(0)
    s_barrier
    v_mfma_f32_16x16x32_bf16 v[128:131], v[80:83], v[92:95], v[128:131]
    s_add_u32 m0, s77, 49152
    s_add_u32 s64, s81, 128
    buffer_load_dwordx4 v10, s[36:39], s64 offen lds
    v_mfma_f32_16x16x32_bf16 v[128:131], v[100:103], v[112:115], v[128:131]
    v_mfma_f32_16x16x32_bf16 v[136:139], v[84:87], v[92:95], v[136:139]
    s_add_u32 m0, s77, 50176
    s_add_u32 s64, s81, 8320
    buffer_load_dwordx4 v23, s[36:39], s64 offen lds
    v_mfma_f32_16x16x32_bf16 v[136:139], v[104:107], v[112:115], v[136:139]
    v_mfma_f32_16x16x32_bf16 v[144:147], v[92:95], v[88:91], v[144:147]
    s_add_u32 m0, s77, 51200
    s_add_u32 s64, s81, 16512
    buffer_load_dwordx4 v10, s[36:39], s64 offen lds
    v_mfma_f32_16x16x32_bf16 v[144:147], v[112:115], v[108:111], v[144:147]
    v_mfma_f32_16x16x32_bf16 v[132:135], v[80:83], v[96:99], v[132:135]
    s_add_u32 m0, s77, 52224
    s_add_u32 s64, s81, 24704
    buffer_load_dwordx4 v23, s[36:39], s64 offen lds
    v_mfma_f32_16x16x32_bf16 v[132:135], v[100:103], v[116:119], v[132:135]
    s_add_u32 m0, s61, 90112
    s_add_u32 s64, s82, 786432
    buffer_load_dwordx4 v11, s[40:43], s64 offen lds
    v_mfma_f32_16x16x32_bf16 v[140:143], v[84:87], v[96:99], v[140:143]
    v_mfma_f32_16x16x32_bf16 v[140:143], v[104:107], v[116:119], v[140:143]
    s_add_u32 m0, s61, 94208
    s_add_u32 s64, s82, 917504
    buffer_load_dwordx4 v11, s[40:43], s64 offen lds
    v_mfma_f32_16x16x32_bf16 v[148:151], v[96:99], v[88:91], v[148:151]
    v_mfma_f32_16x16x32_bf16 v[148:151], v[116:119], v[108:111], v[148:151]
    v_add_u32 v220, 0x20002000, v220
    v_add_u32 v221, 0x20002000, v221
    v_add_u32 v222, 0x20002000, v222
    v_add_u32 v223, 0x20002000, v223
    s_add_u32 s99, s66, 8192
    buffer_store_dwordx4 v[220:223], v15, s[8:11], s99 offen offset:3072 sc1
    s_waitcnt vmcnt(21)
a1_epi:
    s_mov_b32 s90, 1069066811
    v_lshl_or_b32 v152, v154, 16, v152
    v_lshl_or_b32 v153, v155, 16, v153
    s_cmp_ge_u32 s3, 4
    s_cbranch_scc1 rs_5
    s_waitcnt vmcnt(0)
    s_cmp_lt_u32 s5, 2
    s_cbranch_scc0 se_4
    s_add_u32 s99, s66, 0
    buffer_store_dwordx4 v[192:195], v15, s[8:11], s99 offen offset:0 sc1
se_4:
    s_branch re_6
rs_5:
    v_add_u32 v224, 0x20002000, v224
    v_add_u32 v225, 0x20002000, v225
    v_add_u32 v226, 0x20002000, v226
    v_add_u32 v227, 0x20002000, v227
    s_add_u32 s99, s66, 16384
    buffer_store_dwordx4 v[224:227], v15, s[8:11], s99 offen offset:0 sc1
re_6:
    s_nop 2
    v_cvt_pk_bf16_f32 v32, v128, v129
    v_cvt_pk_bf16_f32 v36, v136, v137
    v_cvt_pk_bf16_f32 v33, v130, v131
    v_cvt_pk_bf16_f32 v37, v138, v139
    v_cvt_pk_bf16_f32 v34, v132, v133
    v_cvt_pk_bf16_f32 v38, v140, v141
    v_cvt_pk_bf16_f32 v35, v134, v135
    v_cvt_pk_bf16_f32 v39, v142, v143
    s_nop 1
    v_mfma_f32_16x16x16_bf16 v[44:47], v[152:153], v[32:33], 0
    v_mfma_f32_16x16x16_bf16 v[48:51], v[152:153], v[34:35], 0
    v_mfma_f32_16x16x16_bf16 v[52:55], v[152:153], v[36:37], 0
    v_mfma_f32_16x16x16_bf16 v[56:59], v[152:153], v[38:39], 0
    v_cvt_pk_bf16_f32 v40, v144, v145
    v_cvt_pk_bf16_f32 v41, v146, v147
    v_cvt_pk_bf16_f32 v42, v148, v149
    v_cvt_pk_bf16_f32 v43, v150, v151
    s_lshl_b32 s56, s3, 12
    v_add_u32 v1, s56, v21
    v_mov_b32 v2, v22
    v_xor_b32 v3, 32, v22
    v_xor_b32 v4, 64, v22
    v_xor_b32 v5, 96, v22
    v_xor_b32 v6, 128, v22
    v_xor_b32 v7, 160, v22
    v_xor_b32 v8, 192, v22
    v_xor_b32 v9, 224, v22
    v_max3_f32 v72, v44, v45, v46
    v_max3_f32 v73, -v44, -v45, -v46
    v_max3_f32 v74, v48, v49, v50
    v_max3_f32 v75, -v48, -v49, -v50
    v_max3_f32 v76, v52, v53, v54
    v_max3_f32 v77, -v52, -v53, -v54
    v_max3_f32 v78, v56, v57, v58
    v_max3_f32 v79, -v56, -v57, -v58
    v_max_f32 v72, v72, v47
    v_max_f32_e64 v73, v73, -v47
    v_max_f32 v74, v74, v51
    v_max_f32_e64 v75, v75, -v51
    v_max_f32 v76, v76, v55
    v_max_f32_e64 v77, v77, -v55
    v_max_f32 v78, v78, v59
    v_max_f32_e64 v79, v79, -v59
    s_cmp_ge_u32 s3, 4
    s_cbranch_scc1 rs_9
    s_cmp_lt_u32 s5, 2
    s_cbranch_scc0 se_8
    s_add_u32 s99, s66, 0
    buffer_store_dwordx4 v[196:199], v15, s[8:11], s99 offen offset:1024 sc1
se_8:
    s_branch re_10
rs_9:
    v_add_u32 v228, 0x20002000, v228
    v_add_u32 v229, 0x20002000, v229
    v_add_u32 v230, 0x20002000, v230
    v_add_u32 v231, 0x20002000, v231
    s_add_u32 s99, s66, 16384
    buffer_store_dwordx4 v[228:231], v15, s[8:11], s99 offen offset:1024 sc1
re_10:
    s_nop 1
    v_permlane32_swap_b32 v72, v73
    v_permlane32_swap_b32 v74, v75
    v_permlane32_swap_b32 v76, v77
    v_permlane32_swap_b32 v78, v79
    v_max_f32 v72, v72, v73
    v_max_f32 v74, v74, v75
    v_max_f32 v76, v76, v77
    v_max_f32 v78, v78, v79
    s_nop 1
    v_permlane16_swap_b32 v72, v74
    v_permlane16_swap_b32 v76, v78
    s_nop 0
    v_max_f32 v72, v72, v74
    v_max_f32 v76, v76, v78
    v_mul_f32 v72, s90, v72
    v_mul_f32 v76, s90, v76
    s_nop 0
    v_mov_b32 v74, v72
    v_mov_b32 v78, v76
    s_nop 1
    v_permlane16_swap_b32 v72, v74
    v_permlane16_swap_b32 v76, v78
    s_nop 0
    v_mov_b32 v73, v72
    v_mov_b32 v75, v74
    v_mov_b32 v77, v76
    v_mov_b32 v79, v78
    s_nop 1
    v_permlane32_swap_b32 v72, v73
    v_permlane32_swap_b32 v74, v75
    v_permlane32_swap_b32 v76, v77
    v_permlane32_swap_b32 v78, v79
    s_nop 0
    s_cmp_ge_u32 s3, 4
    s_cbranch_scc1 rs_13
    s_cmp_lt_u32 s5, 2
    s_cbranch_scc0 se_12
    s_add_u32 s99, s66, 0
    buffer_store_dwordx4 v[200:203], v15, s[8:11], s99 offen offset:2048 sc1
se_12:
    s_branch re_14
rs_13:
    v_add_u32 v232, 0x20002000, v232
    v_add_u32 v233, 0x20002000, v233
    v_add_u32 v234, 0x20002000, v234
    v_add_u32 v235, 0x20002000, v235
    s_add_u32 s99, s66, 16384
    buffer_store_dwordx4 v[232:235], v15, s[8:11], s99 offen offset:2048 sc1
re_14:
    v_fma_f32 v88, v44, s90, -v72
    v_fma_f32 v92, -v44, s90, -v73
    v_fma_f32 v89, v45, s90, -v72
    v_fma_f32 v93, -v45, s90, -v73
    v_fma_f32 v90, v46, s90, -v72
    v_fma_f32 v94, -v46, s90, -v73
    v_fma_f32 v91, v47, s90, -v72
    v_fma_f32 v95, -v47, s90, -v73
    v_fma_f32 v96, v48, s90, -v74
    v_fma_f32 v100, -v48, s90, -v75
    v_fma_f32 v97, v49, s90, -v74
    v_fma_f32 v101, -v49, s90, -v75
    v_fma_f32 v98, v50, s90, -v74
    v_fma_f32 v102, -v50, s90, -v75
    v_fma_f32 v99, v51, s90, -v74
    v_fma_f32 v103, -v51, s90, -v75
    v_fma_f32 v104, v52, s90, -v76
    v_fma_f32 v108, -v52, s90, -v77
    v_fma_f32 v105, v53, s90, -v76
    v_fma_f32 v109, -v53, s90, -v77
    v_fma_f32 v106, v54, s90, -v76
    v_fma_f32 v110, -v54, s90, -v77
    v_fma_f32 v107, v55, s90, -v76
    v_fma_f32 v111, -v55, s90, -v77
    v_fma_f32 v112, v56, s90, -v78
    v_fma_f32 v116, -v56, s90, -v79
    v_fma_f32 v113, v57, s90, -v78
    v_fma_f32 v117, -v57, s90, -v79
    v_fma_f32 v114, v58, s90, -v78
    v_fma_f32 v118, -v58, s90, -v79
    v_fma_f32 v115, v59, s90, -v78
    v_fma_f32 v119, -v59, s90, -v79
    s_cmp_ge_u32 s3, 4
    s_cbranch_scc1 rs_17
    s_cmp_lt_u32 s5, 2
    s_cbranch_scc0 se_16
    s_add_u32 s99, s66, 0
    buffer_store_dwordx4 v[204:207], v15, s[8:11], s99 offen offset:3072 sc1
se_16:
    s_branch re_18
rs_17:
    v_add_u32 v236, 0x20002000, v236
    v_add_u32 v237, 0x20002000, v237
    v_add_u32 v238, 0x20002000, v238
    v_add_u32 v239, 0x20002000, v239
    s_add_u32 s99, s66, 16384
    buffer_store_dwordx4 v[236:239], v15, s[8:11], s99 offen offset:3072 sc1
re_18:
    v_exp_f32 v88, v88
    v_exp_f32 v89, v89
    v_exp_f32 v90, v90
    v_exp_f32 v91, v91
    v_exp_f32 v92, v92
    v_exp_f32 v93, v93
    v_exp_f32 v94, v94
    v_exp_f32 v95, v95
    v_exp_f32 v96, v96
    v_exp_f32 v97, v97
    v_exp_f32 v98, v98
    v_exp_f32 v99, v99
    v_exp_f32 v100, v100
    v_exp_f32 v101, v101
    v_exp_f32 v102, v102
    v_exp_f32 v103, v103
    v_exp_f32 v104, v104
    v_exp_f32 v105, v105
    v_exp_f32 v106, v106
    v_exp_f32 v107, v107
    v_exp_f32 v108, v108
    v_exp_f32 v109, v109
    v_exp_f32 v110, v110
    v_exp_f32 v111, v111
    v_exp_f32 v112, v112
    v_exp_f32 v113, v113
    v_exp_f32 v114, v114
    v_exp_f32 v115, v115
    v_exp_f32 v116, v116
    v_exp_f32 v117, v117
    v_exp_f32 v118, v118
    v_exp_f32 v119, v119
    s_cmp_ge_u32 s3, 4
    s_cbranch_scc1 rs_21
    s_cmp_lt_u32 s5, 2
    s_cbranch_scc0 se_20
    s_add_u32 s99, s66, 8192
    buffer_store_dwordx4 v[208:211], v15, s[8:11], s99 offen offset:0 sc1
se_20:
    s_branch re_22
rs_21:
    v_add_u32 v240, 0x20002000, v240
    v_add_u32 v241, 0x20002000, v241
    v_add_u32 v242, 0x20002000, v242
    v_add_u32 v243, 0x20002000, v243
    s_add_u32 s99, s66, 24576
    buffer_store_dwordx4 v[240:243], v15, s[8:11], s99 offen offset:0 sc1
re_22:
    v_pk_add_f32 v[44:45], v[88:89], v[90:91]
    v_pk_add_f32 v[46:47], v[92:93], v[94:95]
    v_pk_add_f32 v[48:49], v[96:97], v[98:99]
    v_pk_add_f32 v[50:51], v[100:101], v[102:103]
    v_pk_add_f32 v[52:53], v[104:105], v[106:107]
    v_pk_add_f32 v[54:55], v[108:109], v[110:111]
    v_pk_add_f32 v[56:57], v[112:113], v[114:115]
    v_pk_add_f32 v[58:59], v[116:117], v[118:119]
    v_add_f32 v72, v44, v45
    v_add_f32 v73, v46, v47
    v_add_f32 v74, v48, v49
    v_add_f32 v75, v50, v51
    v_add_f32 v76, v52, v53
    v_add_f32 v77, v54, v55
    v_add_f32 v78, v56, v57
    v_add_f32 v79, v58, v59
    s_nop 1
    v_permlane32_swap_b32 v72, v73
    v_permlane32_swap_b32 v74, v75
    v_permlane32_swap_b32 v76, v77
    v_permlane32_swap_b32 v78, v79
    v_add_f32 v72, v72, v73
    v_add_f32 v74, v74, v75
    v_add_f32 v76, v76, v77
    v_add_f32 v78, v78, v79
    s_nop 1
    v_permlane16_swap_b32 v72, v74
    v_permlane16_swap_b32 v76, v78
    s_nop 0
    v_add_f32 v72, v72, v74
    v_add_f32 v76, v76, v78
    v_rcp_f32 v72, v72
    v_rcp_f32 v76, v76
    s_nop 0
    v_mov_b32 v74, v72
    v_mov_b32 v78, v76
    s_nop 1
    v_permlane16_swap_b32 v72, v74
    v_permlane16_swap_b32 v76, v78
    s_nop 0
    v_mov_b32 v73, v72
    v_mov_b32 v75, v74
    v_mov_b32 v77, v76
    v_mov_b32 v79, v78
    s_nop 1
    v_permlane32_swap_b32 v72, v73
    v_permlane32_swap_b32 v74, v75
    v_permlane32_swap_b32 v76, v77
    v_permlane32_swap_b32 v78, v79
    s_nop 0
    s_cmp_ge_u32 s3, 4
    s_cbranch_scc1 rs_25
    s_cmp_lt_u32 s5, 2
    s_cbranch_scc0 se_24
    s_add_u32 s99, s66, 8192
    buffer_store_dwordx4 v[212:215], v15, s[8:11], s99 offen offset:1024 sc1
se_24:
    s_branch re_26
rs_25:
    v_add_u32 v244, 0x20002000, v244
    v_add_u32 v245, 0x20002000, v245
    v_add_u32 v246, 0x20002000, v246
    v_add_u32 v247, 0x20002000, v247
    s_add_u32 s99, s66, 24576
    buffer_store_dwordx4 v[244:247], v15, s[8:11], s99 offen offset:1024 sc1
re_26:
    v_mul_f32 v104, v104, v76
    v_mul_f32 v105, v105, v76
    v_mul_f32 v106, v106, v76
    v_mul_f32 v107, v107, v76
    v_mul_f32 v108, v108, v77
    v_mul_f32 v109, v109, v77
    v_mul_f32 v110, v110, v77
    v_mul_f32 v111, v111, v77
    v_mul_f32 v112, v112, v78
    v_mul_f32 v113, v113, v78
    v_mul_f32 v114, v114, v78
    v_mul_f32 v115, v115, v78
    v_mul_f32 v116, v116, v79
    v_mul_f32 v117, v117, v79
    v_mul_f32 v118, v118, v79
    v_mul_f32 v119, v119, v79
    v_cvt_pk_bf16_f32 v44, v104, v105
    v_cvt_pk_bf16_f32 v45, v106, v107
    v_cvt_pk_bf16_f32 v46, v108, v109
    v_cvt_pk_bf16_f32 v47, v110, v111
    v_cvt_pk_bf16_f32 v48, v112, v113
    v_cvt_pk_bf16_f32 v49, v114, v115
    v_cvt_pk_bf16_f32 v50, v116, v117
    v_cvt_pk_bf16_f32 v51, v118, v119
    s_nop 1
    v_mfma_f32_16x16x32_bf16 v[104:107], v[44:47], v[176:179], 0
    v_mfma_f32_16x16x32_bf16 v[108:111], v[48:51], v[176:179], 0
    v_mfma_f32_16x16x32_bf16 v[112:115], v[44:47], v[180:183], 0
    v_mfma_f32_16x16x32_bf16 v[116:119], v[48:51], v[180:183], 0
    v_mul_f32 v88, v88, v72
    v_mul_f32 v89, v89, v72
    v_mul_f32 v90, v90, v72
    v_mul_f32 v91, v91, v72
    v_mul_f32 v92, v92, v73
    v_mul_f32 v93, v93, v73
    v_mul_f32 v94, v94, v73
    v_mul_f32 v95, v95, v73
    v_mul_f32 v96, v96, v74
    v_mul_f32 v97, v97, v74
    v_mul_f32 v98, v98, v74
    v_mul_f32 v99, v99, v74
    v_mul_f32 v100, v100, v75
    v_mul_f32 v101, v101, v75
    v_mul_f32 v102, v102, v75
    v_mul_f32 v103, v103, v75
    v_cvt_pk_bf16_f32 v52, v104, v105
    v_cvt_pk_bf16_f32 v53, v106, v107
    v_cvt_pk_bf16_f32 v54, v108, v109
    v_cvt_pk_bf16_f32 v55, v110, v111
    v_cvt_pk_bf16_f32 v56, v112, v113
    v_cvt_pk_bf16_f32 v57, v114, v115
    v_cvt_pk_bf16_f32 v58, v116, v117
    v_cvt_pk_bf16_f32 v59, v118, v119
    s_nop 1
    v_mfma_f32_16x16x32_bf16 v[128:131], v[52:55], v[40:43], 0
    v_mfma_f32_16x16x32_bf16 v[136:139], v[52:55], v[184:187], 0
    v_mfma_f32_16x16x32_bf16 v[132:135], v[56:59], v[40:43], 0
    v_mfma_f32_16x16x32_bf16 v[140:143], v[56:59], v[184:187], 0
    v_cvt_pk_bf16_f32 v24, v88, v89
    v_cvt_pk_bf16_f32 v25, v90, v91
    v_cvt_pk_bf16_f32 v26, v92, v93
    v_cvt_pk_bf16_f32 v27, v94, v95
    v_cvt_pk_bf16_f32 v28, v96, v97
    v_cvt_pk_bf16_f32 v29, v98, v99
    v_cvt_pk_bf16_f32 v30, v100, v101
    v_cvt_pk_bf16_f32 v31, v102, v103
    s_lshl_b32 s56, s6, 2
    s_add_u32 s56, s56, s65
    s_lshl_b32 s56, s56, 5
    s_add_u32 s56, s56, s7
    s_lshl_b32 s56, s56, 1
    s_lshr_b32 s57, s3, 2
    s_add_u32 s56, s56, s57
    s_lshl_b32 s56, s56, 10
    s_add_u32 s56, s56, 87031808
    s_add_u32 s57, s56, 32768
    buffer_store_dwordx4 v[24:27], v15, s[8:11], s56 offen sc1
    buffer_store_dwordx4 v[28:31], v15, s[8:11], s57 offen sc1
    s_cmp_ge_u32 s3, 4
    s_cbranch_scc1 rs_29
    s_cmp_lt_u32 s5, 2
    s_cbranch_scc0 se_28
    s_add_u32 s99, s66, 8192
    buffer_store_dwordx4 v[216:219], v15, s[8:11], s99 offen offset:2048 sc1
se_28:
    s_branch re_30
rs_29:
    v_add_u32 v248, 0x20002000, v248
    v_add_u32 v249, 0x20002000, v249
    v_add_u32 v250, 0x20002000, v250
    v_add_u32 v251, 0x20002000, v251
    s_add_u32 s99, s66, 24576
    buffer_store_dwordx4 v[248:251], v15, s[8:11], s99 offen offset:2048 sc1
re_30:
    s_lshl_b32 s56, s3, 12
    s_add_u32 s56, s56, 131072
    v_add_u32 v16, s56, v15
    ds_write_b128 v16, v[128:131] offset:0
    ds_write_b128 v16, v[132:135] offset:1024
    ds_write_b128 v16, v[136:139] offset:2048
    ds_write_b128 v16, v[140:143] offset:3072
    s_lshr_b32 s56, s3, 2
    s_lshl_b32 s56, s56, 14
    s_lshl_b32 s57, s65, 10
    s_add_u32 s56, s56, s57
    s_add_u32 s56, s56, 131072
    v_add_u32 v16, s56, v15
    s_lshl_b32 s56, s7, 1
    s_lshr_b32 s58, s3, 2
    s_add_u32 s56, s56, s58
    s_lshl_b32 s56, s56, 4
    s_add_u32 s56, s56, s6
    s_lshl_b32 s56, s56, 12
    s_add_u32 s56, s56, s57
    s_add_u32 s56, s56, 65011712
    s_cmp_ge_u32 s3, 4
    s_cbranch_scc1 rs_33
    s_cmp_lt_u32 s5, 2
    s_cbranch_scc0 se_32
    s_add_u32 s99, s66, 8192
    buffer_store_dwordx4 v[220:223], v15, s[8:11], s99 offen offset:3072 sc1
se_32:
    s_branch re_34
rs_33:
    v_add_u32 v252, 0x20002000, v252
    v_add_u32 v253, 0x20002000, v253
    v_add_u32 v254, 0x20002000, v254
    v_add_u32 v255, 0x20002000, v255
    s_add_u32 s99, s66, 24576
    buffer_store_dwordx4 v[252:255], v15, s[8:11], s99 offen offset:3072 sc1
re_34:
    s_waitcnt lgkmcnt(0)
    s_barrier
    ds_read_b128 v[128:131], v16 offset:0
    ds_read_b128 v[132:135], v16 offset:4096
    ds_read_b128 v[136:139], v16 offset:8192
    ds_read_b128 v[140:143], v16 offset:12288
    v_xor_b32 v21, 0, v1
    ds_read_b128 v[64:67], v21
    ds_read_b128 v[68:71], v21 offset:2048
    ds_read_b64_tr_b16 v[32:33], v2 offset:0
    ds_read_b64_tr_b16 v[34:35], v2 offset:1024
    ds_read_b64_tr_b16 v[36:37], v3 offset:0
    ds_read_b64_tr_b16 v[38:39], v3 offset:1024
    ds_read_b64_tr_b16 v[40:41], v4 offset:0
    ds_read_b64_tr_b16 v[42:43], v4 offset:1024
    ds_read_b64_tr_b16 v[44:45], v5 offset:0
    ds_read_b64_tr_b16 v[46:47], v5 offset:1024
    s_waitcnt lgkmcnt(10)
    ds_read_b64_tr_b16 v[48:49], v6 offset:0
    ds_read_b64_tr_b16 v[50:51], v6 offset:1024
    ds_read_b64_tr_b16 v[52:53], v7 offset:0
    ds_read_b64_tr_b16 v[54:55], v7 offset:1024
    ds_read_b64_tr_b16 v[56:57], v8 offset:0
    ds_read_b64_tr_b16 v[58:59], v8 offset:1024
    ds_read_b64_tr_b16 v[60:61], v9 offset:0
    ds_read_b64_tr_b16 v[62:63], v9 offset:1024
    v_pk_add_f32 v[128:129], v[128:129], v[132:133]
    v_pk_add_f32 v[136:137], v[136:137], v[140:141]
    v_pk_add_f32 v[130:131], v[130:131], v[134:135]
    v_pk_add_f32 v[138:139], v[138:139], v[142:143]
    v_pk_add_f32 v[72:73], v[128:129], v[136:137]
    v_pk_add_f32 v[74:75], v[130:131], v[138:139]
    buffer_store_dwordx4 v[72:75], v15, s[8:11], s56 offen sc1
    s_load_dwordx2 s[20:21], s[0:1], 72
    s_lshl_b32 s79, s98, 17
    s_and_b32 s56, s4, 3
    s_lshl_b32 s56, s56, 8
    s_add_u32 s79, s79, s56
    s_sub_u32 s78, s76, 8
    s_min_u32 s78, s78, 13
    s_cmp_ge_u32 s3, 4
    s_cbranch_scc1 p2_s
    s_waitcnt lgkmcnt(0)
    s_barrier
    v_mfma_f32_16x16x32_bf16 v[128:131], v[32:35], v[64:67], 0
    v_xor_b32 v21, 64, v1
    ds_read_b128 v[112:115], v21
    ds_read_b128 v[116:119], v21 offset:2048
    v_mfma_f32_16x16x32_bf16 v[136:139], v[32:35], v[68:71], 0
    ds_read_b64_tr_b16 v[80:81], v2 offset:8192
    v_mfma_f32_16x16x32_bf16 v[132:135], v[36:39], v[64:67], 0
    ds_read_b64_tr_b16 v[82:83], v2 offset:9216
    ds_read_b64_tr_b16 v[84:85], v3 offset:8192
    v_mfma_f32_16x16x32_bf16 v[140:143], v[36:39], v[68:71], 0
    ds_read_b64_tr_b16 v[86:87], v3 offset:9216
    v_mfma_f32_16x16x32_bf16 v[144:147], v[40:43], v[64:67], 0
    ds_read_b64_tr_b16 v[88:89], v4 offset:8192
    v_mfma_f32_16x16x32_bf16 v[152:155], v[40:43], v[68:71], 0
    ds_read_b64_tr_b16 v[90:91], v4 offset:9216
    ds_read_b64_tr_b16 v[92:93], v5 offset:8192
    v_mfma_f32_16x16x32_bf16 v[148:151], v[44:47], v[64:67], 0
    ds_read_b64_tr_b16 v[94:95], v5 offset:9216
    v_mfma_f32_16x16x32_bf16 v[156:159], v[44:47], v[68:71], 0
    ds_read_b64_tr_b16 v[96:97], v6 offset:8192
    ds_read_b64_tr_b16 v[98:99], v6 offset:9216
    v_mfma_f32_16x16x32_bf16 v[160:163], v[48:51], v[64:67], 0
    ds_read_b64_tr_b16 v[100:101], v7 offset:8192
    s_cmp_lt_u32 s5, 2
    s_cbranch_scc1 ss_35
    s_add_u32 s99, s66, 0
    buffer_store_dwordx4 v[192:195], v15, s[8:11], s99 offen offset:0 sc1
    s_add_u32 s99, s66, 0
    buffer_store_dwordx4 v[196:199], v15, s[8:11], s99 offen offset:1024 sc1
    s_branch se_36
ss_35:
    s_add_u32 s99, s66, 16384
    buffer_store_dwordx4 v[224:227], v15, s[8:11], s99 offen offset:0 sc1
    s_add_u32 s99, s66, 16384
    buffer_store_dwordx4 v[228:231], v15, s[8:11], s99 offen offset:1024 sc1
    s_add_u32 s99, s66, 16384
    buffer_store_dwordx4 v[232:235], v15, s[8:11], s99 offen offset:2048 sc1
se_36:
    v_mfma_f32_16x16x32_bf16 v[168:171], v[48:51], v[68:71], 0
    ds_read_b64_tr_b16 v[102:103], v7 offset:9216
    v_mfma_f32_16x16x32_bf16 v[164:167], v[52:55], v[64:67], 0
    ds_read_b64_tr_b16 v[104:105], v8 offset:8192
    ds_read_b64_tr_b16 v[106:107], v8 offset:9216
    v_mfma_f32_16x16x32_bf16 v[172:175], v[52:55], v[68:71], 0
    ds_read_b64_tr_b16 v[108:109], v9 offset:8192
    v_mfma_f32_16x16x32_bf16 v[176:179], v[56:59], v[64:67], 0
    ds_read_b64_tr_b16 v[110:111], v9 offset:9216
    v_mfma_f32_16x16x32_bf16 v[184:187], v[56:59], v[68:71], 0
    v_mfma_f32_16x16x32_bf16 v[180:183], v[60:63], v[64:67], 0
    v_mfma_f32_16x16x32_bf16 v[188:191], v[60:63], v[68:71], 0
    s_waitcnt lgkmcnt(0)
    s_barrier
    v_mfma_f32_16x16x32_bf16 v[128:131], v[80:83], v[112:115], v[128:131]
    v_xor_b32 v21, 32768, v1
    ds_read_b128 v[64:67], v21
    ds_read_b128 v[68:71], v21 offset:2048
    v_mfma_f32_16x16x32_bf16 v[136:139], v[80:83], v[116:119], v[136:139]
    ds_read_b64_tr_b16 v[32:33], v2 offset:16384
    v_mfma_f32_16x16x32_bf16 v[132:135], v[84:87], v[112:115], v[132:135]
    ds_read_b64_tr_b16 v[34:35], v2 offset:17408
    ds_read_b64_tr_b16 v[36:37], v3 offset:16384
    v_mfma_f32_16x16x32_bf16 v[140:143], v[84:87], v[116:119], v[140:143]
    ds_read_b64_tr_b16 v[38:39], v3 offset:17408
    v_mfma_f32_16x16x32_bf16 v[144:147], v[88:91], v[112:115], v[144:147]
    ds_read_b64_tr_b16 v[40:41], v4 offset:16384
    v_mfma_f32_16x16x32_bf16 v[152:155], v[88:91], v[116:119], v[152:155]
    ds_read_b64_tr_b16 v[42:43], v4 offset:17408
    ds_read_b64_tr_b16 v[44:45], v5 offset:16384
    v_mfma_f32_16x16x32_bf16 v[148:151], v[92:95], v[112:115], v[148:151]
    ds_read_b64_tr_b16 v[46:47], v5 offset:17408
    v_mfma_f32_16x16x32_bf16 v[156:159], v[92:95], v[116:119], v[156:159]
    ds_read_b64_tr_b16 v[48:49], v6 offset:16384
    ds_read_b64_tr_b16 v[50:51], v6 offset:17408
    v_mfma_f32_16x16x32_bf16 v[160:163], v[96:99], v[112:115], v[160:163]
    ds_read_b64_tr_b16 v[52:53], v7 offset:16384
    s_cmp_lt_u32 s5, 2
    s_cbranch_scc1 ss_37
    s_add_u32 s99, s66, 0
    buffer_store_dwordx4 v[200:203], v15, s[8:11], s99 offen offset:2048 sc1
    s_branch se_38
ss_37:
    s_add_u32 s99, s66, 16384
    buffer_store_dwordx4 v[236:239], v15, s[8:11], s99 offen offset:3072 sc1
    s_add_u32 s99, s66, 24576
    buffer_store_dwordx4 v[240:243], v15, s[8:11], s99 offen offset:0 sc1
    s_add_u32 s99, s66, 24576
    buffer_store_dwordx4 v[244:247], v15, s[8:11], s99 offen offset:1024 sc1
se_38:
    v_mfma_f32_16x16x32_bf16 v[168:171], v[96:99], v[116:119], v[168:171]
    ds_read_b64_tr_b16 v[54:55], v7 offset:17408
    v_mfma_f32_16x16x32_bf16 v[164:167], v[100:103], v[112:115], v[164:167]
    ds_read_b64_tr_b16 v[56:57], v8 offset:16384
    ds_read_b64_tr_b16 v[58:59], v8 offset:17408
    v_mfma_f32_16x16x32_bf16 v[172:175], v[100:103], v[116:119], v[172:175]
    ds_read_b64_tr_b16 v[60:61], v9 offset:16384
    v_mfma_f32_16x16x32_bf16 v[176:179], v[104:107], v[112:115], v[176:179]
    ds_read_b64_tr_b16 v[62:63], v9 offset:17408
    v_mfma_f32_16x16x32_bf16 v[184:187], v[104:107], v[116:119], v[184:187]
    v_mfma_f32_16x16x32_bf16 v[180:183], v[108:111], v[112:115], v[180:183]
    v_mfma_f32_16x16x32_bf16 v[188:191], v[108:111], v[116:119], v[188:191]
    s_waitcnt lgkmcnt(0)
    s_barrier
    v_mfma_f32_16x16x32_bf16 v[128:131], v[32:35], v[64:67], v[128:131]
    v_xor_b32 v21, 32832, v1
    ds_read_b128 v[112:115], v21
    ds_read_b128 v[116:119], v21 offset:2048
    v_mfma_f32_16x16x32_bf16 v[136:139], v[32:35], v[68:71], v[136:139]
    ds_read_b64_tr_b16 v[80:81], v2 offset:24576
    v_mfma_f32_16x16x32_bf16 v[132:135], v[36:39], v[64:67], v[132:135]
    ds_read_b64_tr_b16 v[82:83], v2 offset:25600
    ds_read_b64_tr_b16 v[84:85], v3 offset:24576
    v_mfma_f32_16x16x32_bf16 v[140:143], v[36:39], v[68:71], v[140:143]
    ds_read_b64_tr_b16 v[86:87], v3 offset:25600
    v_mfma_f32_16x16x32_bf16 v[144:147], v[40:43], v[64:67], v[144:147]
    ds_read_b64_tr_b16 v[88:89], v4 offset:24576
    v_mfma_f32_16x16x32_bf16 v[152:155], v[40:43], v[68:71], v[152:155]
    ds_read_b64_tr_b16 v[90:91], v4 offset:25600
    ds_read_b64_tr_b16 v[92:93], v5 offset:24576
    v_mfma_f32_16x16x32_bf16 v[148:151], v[44:47], v[64:67], v[148:151]
    ds_read_b64_tr_b16 v[94:95], v5 offset:25600
    v_mfma_f32_16x16x32_bf16 v[156:159], v[44:47], v[68:71], v[156:159]
    ds_read_b64_tr_b16 v[96:97], v6 offset:24576
    ds_read_b64_tr_b16 v[98:99], v6 offset:25600
    v_mfma_f32_16x16x32_bf16 v[160:163], v[48:51], v[64:67], v[160:163]
    ds_read_b64_tr_b16 v[100:101], v7 offset:24576
    s_cmp_lt_u32 s5, 2
    s_cbranch_scc1 ss_39
    s_add_u32 s99, s66, 0
    buffer_store_dwordx4 v[204:207], v15, s[8:11], s99 offen offset:3072 sc1
    s_add_u32 s99, s66, 8192
    buffer_store_dwordx4 v[208:211], v15, s[8:11], s99 offen offset:0 sc1
    s_branch se_40
ss_39:
    s_add_u32 s99, s66, 24576
    buffer_store_dwordx4 v[248:251], v15, s[8:11], s99 offen offset:2048 sc1
    s_add_u32 s99, s66, 24576
    buffer_store_dwordx4 v[252:255], v15, s[8:11], s99 offen offset:3072 sc1
se_40:
    v_mfma_f32_16x16x32_bf16 v[168:171], v[48:51], v[68:71], v[168:171]
    ds_read_b64_tr_b16 v[102:103], v7 offset:25600
    v_mfma_f32_16x16x32_bf16 v[164:167], v[52:55], v[64:67], v[164:167]
    ds_read_b64_tr_b16 v[104:105], v8 offset:24576
    ds_read_b64_tr_b16 v[106:107], v8 offset:25600
    v_mfma_f32_16x16x32_bf16 v[172:175], v[52:55], v[68:71], v[172:175]
    ds_read_b64_tr_b16 v[108:109], v9 offset:24576
    v_mfma_f32_16x16x32_bf16 v[176:179], v[56:59], v[64:67], v[176:179]
    ds_read_b64_tr_b16 v[110:111], v9 offset:25600
    v_mfma_f32_16x16x32_bf16 v[184:187], v[56:59], v[68:71], v[184:187]
    v_mfma_f32_16x16x32_bf16 v[180:183], v[60:63], v[64:67], v[180:183]
    v_mfma_f32_16x16x32_bf16 v[188:191], v[60:63], v[68:71], v[188:191]
    s_waitcnt lgkmcnt(0)
    s_barrier
    v_mfma_f32_16x16x32_bf16 v[128:131], v[80:83], v[112:115], v[128:131]
    v_xor_b32 v21, 98304, v1
    ds_read_b128 v[64:67], v21
    ds_read_b128 v[68:71], v21 offset:2048
    v_mfma_f32_16x16x32_bf16 v[136:139], v[80:83], v[116:119], v[136:139]
    ds_read_b64_tr_b16 v[32:33], v2 offset:0
    v_mfma_f32_16x16x32_bf16 v[132:135], v[84:87], v[112:115], v[132:135]
    ds_read_b64_tr_b16 v[34:35], v2 offset:1024
    ds_read_b64_tr_b16 v[36:37], v3 offset:0
    v_mfma_f32_16x16x32_bf16 v[140:143], v[84:87], v[116:119], v[140:143]
    ds_read_b64_tr_b16 v[38:39], v3 offset:1024
    v_mfma_f32_16x16x32_bf16 v[144:147], v[88:91], v[112:115], v[144:147]
    ds_read_b64_tr_b16 v[40:41], v4 offset:0
    v_mfma_f32_16x16x32_bf16 v[152:155], v[88:91], v[116:119], v[152:155]
    ds_read_b64_tr_b16 v[42:43], v4 offset:1024
    ds_read_b64_tr_b16 v[44:45], v5 offset:0
    v_mfma_f32_16x16x32_bf16 v[148:151], v[92:95], v[112:115], v[148:151]
    ds_read_b64_tr_b16 v[46:47], v5 offset:1024
    v_mfma_f32_16x16x32_bf16 v[156:159], v[92:95], v[116:119], v[156:159]
    ds_read_b64_tr_b16 v[48:49], v6 offset:0
    ds_read_b64_tr_b16 v[50:51], v6 offset:1024
    v_mfma_f32_16x16x32_bf16 v[160:163], v[96:99], v[112:115], v[160:163]
    ds_read_b64_tr_b16 v[52:53], v7 offset:0
    s_cmp_lt_u32 s5, 2
    s_cbranch_scc1 se_42
    s_add_u32 s99, s66, 8192
    buffer_store_dwordx4 v[212:215], v15, s[8:11], s99 offen offset:1024 sc1
se_42:
    v_mfma_f32_16x16x32_bf16 v[168:171], v[96:99], v[116:119], v[168:171]
    ds_read_b64_tr_b16 v[54:55], v7 offset:1024
    v_mfma_f32_16x16x32_bf16 v[164:167], v[100:103], v[112:115], v[164:167]
    ds_read_b64_tr_b16 v[56:57], v8 offset:0
    ds_read_b64_tr_b16 v[58:59], v8 offset:1024
    v_mfma_f32_16x16x32_bf16 v[172:175], v[100:103], v[116:119], v[172:175]
    ds_read_b64_tr_b16 v[60:61], v9 offset:0
    v_mfma_f32_16x16x32_bf16 v[176:179], v[104:107], v[112:115], v[176:179]
    ds_read_b64_tr_b16 v[62:63], v9 offset:1024
    v_mfma_f32_16x16x32_bf16 v[184:187], v[104:107], v[116:119], v[184:187]
    v_mfma_f32_16x16x32_bf16 v[180:183], v[108:111], v[112:115], v[180:183]
    v_mfma_f32_16x16x32_bf16 v[188:191], v[108:111], v[116:119], v[188:191]
    s_waitcnt lgkmcnt(0)
    s_barrier
    v_mfma_f32_16x16x32_bf16 v[128:131], v[32:35], v[64:67], v[128:131]
    v_xor_b32 v21, 98368, v1
    ds_read_b128 v[112:115], v21
    ds_read_b128 v[116:119], v21 offset:2048
    v_mfma_f32_16x16x32_bf16 v[136:139], v[32:35], v[68:71], v[136:139]
    ds_read_b64_tr_b16 v[80:81], v2 offset:8192
    v_mfma_f32_16x16x32_bf16 v[132:135], v[36:39], v[64:67], v[132:135]
    ds_read_b64_tr_b16 v[82:83], v2 offset:9216
    ds_read_b64_tr_b16 v[84:85], v3 offset:8192
    v_mfma_f32_16x16x32_bf16 v[140:143], v[36:39], v[68:71], v[140:143]
    ds_read_b64_tr_b16 v[86:87], v3 offset:9216
    v_mfma_f32_16x16x32_bf16 v[144:147], v[40:43], v[64:67], v[144:147]
    ds_read_b64_tr_b16 v[88:89], v4 offset:8192
    v_mfma_f32_16x16x32_bf16 v[152:155], v[40:43], v[68:71], v[152:155]
    ds_read_b64_tr_b16 v[90:91], v4 offset:9216
    ds_read_b64_tr_b16 v[92:93], v5 offset:8192
    v_mfma_f32_16x16x32_bf16 v[148:151], v[44:47], v[64:67], v[148:151]
    ds_read_b64_tr_b16 v[94:95], v5 offset:9216
    v_mfma_f32_16x16x32_bf16 v[156:159], v[44:47], v[68:71], v[156:159]
    ds_read_b64_tr_b16 v[96:97], v6 offset:8192
    ds_read_b64_tr_b16 v[98:99], v6 offset:9216
    v_mfma_f32_16x16x32_bf16 v[160:163], v[48:51], v[64:67], v[160:163]
    ds_read_b64_tr_b16 v[100:101], v7 offset:8192
    s_cmp_lt_u32 s5, 2
    s_cbranch_scc1 se_44
    s_add_u32 s99, s66, 8192
    buffer_store_dwordx4 v[216:219], v15, s[8:11], s99 offen offset:2048 sc1
    s_add_u32 s99, s66, 8192
    buffer_store_dwordx4 v[220:223], v15, s[8:11], s99 offen offset:3072 sc1
se_44:
    v_mfma_f32_16x16x32_bf16 v[168:171], v[48:51], v[68:71], v[168:171]
    ds_read_b64_tr_b16 v[102:103], v7 offset:9216
    v_mfma_f32_16x16x32_bf16 v[164:167], v[52:55], v[64:67], v[164:167]
    ds_read_b64_tr_b16 v[104:105], v8 offset:8192
    ds_read_b64_tr_b16 v[106:107], v8 offset:9216
    v_mfma_f32_16x16x32_bf16 v[172:175], v[52:55], v[68:71], v[172:175]
    ds_read_b64_tr_b16 v[108:109], v9 offset:8192
    v_mfma_f32_16x16x32_bf16 v[176:179], v[56:59], v[64:67], v[176:179]
    ds_read_b64_tr_b16 v[110:111], v9 offset:9216
    v_mfma_f32_16x16x32_bf16 v[184:187], v[56:59], v[68:71], v[184:187]
    v_mfma_f32_16x16x32_bf16 v[180:183], v[60:63], v[64:67], v[180:183]
    v_mfma_f32_16x16x32_bf16 v[188:191], v[60:63], v[68:71], v[188:191]
    s_cmp_lt_u32 s5, 2
    s_cbranch_scc0 cov_45
    s_waitcnt vmcnt(0)
cov_45:
    s_waitcnt lgkmcnt(0)
    s_barrier
    s_cmp_eq_u32 s3, 0
    s_cbranch_scc1 pub_46
pubr_47:
    v_mfma_f32_16x16x32_bf16 v[128:131], v[80:83], v[112:115], v[128:131]
    v_xor_b32 v21, 0, v1
    ds_read_b128 v[64:67], v21
    ds_read_b128 v[68:71], v21 offset:2048
    v_mfma_f32_16x16x32_bf16 v[136:139], v[80:83], v[116:119], v[136:139]
    ds_read_b64_tr_b16 v[32:33], v2 offset:16384
    v_mfma_f32_16x16x32_bf16 v[132:135], v[84:87], v[112:115], v[132:135]
    ds_read_b64_tr_b16 v[34:35], v2 offset:17408
    ds_read_b64_tr_b16 v[36:37], v3 offset:16384
    v_mfma_f32_16x16x32_bf16 v[140:143], v[84:87], v[116:119], v[140:143]
    ds_read_b64_tr_b16 v[38:39], v3 offset:17408
    v_mfma_f32_16x16x32_bf16 v[144:147], v[88:91], v[112:115], v[144:147]
    ds_read_b64_tr_b16 v[40:41], v4 offset:16384
    v_mfma_f32_16x16x32_bf16 v[152:155], v[88:91], v[116:119], v[152:155]
    ds_read_b64_tr_b16 v[42:43], v4 offset:17408
    ds_read_b64_tr_b16 v[44:45], v5 offset:16384
    v_mfma_f32_16x16x32_bf16 v[148:151], v[92:95], v[112:115], v[148:151]
    ds_read_b64_tr_b16 v[46:47], v5 offset:17408
    v_mfma_f32_16x16x32_bf16 v[156:159], v[92:95], v[116:119], v[156:159]
    ds_read_b64_tr_b16 v[48:49], v6 offset:16384
    ds_read_b64_tr_b16 v[50:51], v6 offset:17408
    v_mfma_f32_16x16x32_bf16 v[160:163], v[96:99], v[112:115], v[160:163]
    ds_read_b64_tr_b16 v[52:53], v7 offset:16384
    s_cmp_lt_u32 s5, 2
    s_cbranch_scc1 se_49
    s_add_u32 s99, s66, 16384
    buffer_store_dwordx4 v[224:227], v15, s[8:11], s99 offen offset:0 sc1
se_49:
    v_mfma_f32_16x16x32_bf16 v[168:171], v[96:99], v[116:119], v[168:171]
    ds_read_b64_tr_b16 v[54:55], v7 offset:17408
    v_mfma_f32_16x16x32_bf16 v[164:167], v[100:103], v[112:115], v[164:167]
    ds_read_b64_tr_b16 v[56:57], v8 offset:16384
    ds_read_b64_tr_b16 v[58:59], v8 offset:17408
    v_mfma_f32_16x16x32_bf16 v[172:175], v[100:103], v[116:119], v[172:175]
    ds_read_b64_tr_b16 v[60:61], v9 offset:16384
    v_mfma_f32_16x16x32_bf16 v[176:179], v[104:107], v[112:115], v[176:179]
    ds_read_b64_tr_b16 v[62:63], v9 offset:17408
    v_mfma_f32_16x16x32_bf16 v[184:187], v[104:107], v[116:119], v[184:187]
    v_mfma_f32_16x16x32_bf16 v[180:183], v[108:111], v[112:115], v[180:183]
    v_mfma_f32_16x16x32_bf16 v[188:191], v[108:111], v[116:119], v[188:191]
    s_waitcnt lgkmcnt(0)
    s_barrier
    v_mfma_f32_16x16x32_bf16 v[128:131], v[32:35], v[64:67], v[128:131]
    v_xor_b32 v21, 64, v1
    ds_read_b128 v[112:115], v21
    ds_read_b128 v[116:119], v21 offset:2048
    v_mfma_f32_16x16x32_bf16 v[136:139], v[32:35], v[68:71], v[136:139]
    ds_read_b64_tr_b16 v[80:81], v2 offset:24576
    v_mfma_f32_16x16x32_bf16 v[132:135], v[36:39], v[64:67], v[132:135]
    ds_read_b64_tr_b16 v[82:83], v2 offset:25600
    ds_read_b64_tr_b16 v[84:85], v3 offset:24576
    v_mfma_f32_16x16x32_bf16 v[140:143], v[36:39], v[68:71], v[140:143]
    ds_read_b64_tr_b16 v[86:87], v3 offset:25600
    v_mfma_f32_16x16x32_bf16 v[144:147], v[40:43], v[64:67], v[144:147]
    ds_read_b64_tr_b16 v[88:89], v4 offset:24576
    v_mfma_f32_16x16x32_bf16 v[152:155], v[40:43], v[68:71], v[152:155]
    ds_read_b64_tr_b16 v[90:91], v4 offset:25600
    ds_read_b64_tr_b16 v[92:93], v5 offset:24576
    v_mfma_f32_16x16x32_bf16 v[148:151], v[44:47], v[64:67], v[148:151]
    ds_read_b64_tr_b16 v[94:95], v5 offset:25600
    v_mfma_f32_16x16x32_bf16 v[156:159], v[44:47], v[68:71], v[156:159]
    ds_read_b64_tr_b16 v[96:97], v6 offset:24576
    ds_read_b64_tr_b16 v[98:99], v6 offset:25600
    v_mfma_f32_16x16x32_bf16 v[160:163], v[48:51], v[64:67], v[160:163]
    ds_read_b64_tr_b16 v[100:101], v7 offset:24576
    s_cmp_lt_u32 s5, 2
    s_cbranch_scc1 se_51
    s_add_u32 s99, s66, 16384
    buffer_store_dwordx4 v[228:231], v15, s[8:11], s99 offen offset:1024 sc1
se_51:
    v_mfma_f32_16x16x32_bf16 v[168:171], v[48:51], v[68:71], v[168:171]
    ds_read_b64_tr_b16 v[102:103], v7 offset:25600
    v_mfma_f32_16x16x32_bf16 v[164:167], v[52:55], v[64:67], v[164:167]
    ds_read_b64_tr_b16 v[104:105], v8 offset:24576
    ds_read_b64_tr_b16 v[106:107], v8 offset:25600
    v_mfma_f32_16x16x32_bf16 v[172:175], v[52:55], v[68:71], v[172:175]
    ds_read_b64_tr_b16 v[108:109], v9 offset:24576
    v_mfma_f32_16x16x32_bf16 v[176:179], v[56:59], v[64:67], v[176:179]
    ds_read_b64_tr_b16 v[110:111], v9 offset:25600
    v_mfma_f32_16x16x32_bf16 v[184:187], v[56:59], v[68:71], v[184:187]
    v_mfma_f32_16x16x32_bf16 v[180:183], v[60:63], v[64:67], v[180:183]
    v_mfma_f32_16x16x32_bf16 v[188:191], v[60:63], v[68:71], v[188:191]
    s_waitcnt lgkmcnt(0)
    s_barrier
    v_mfma_f32_16x16x32_bf16 v[128:131], v[80:83], v[112:115], v[128:131]
    v_xor_b32 v21, 32768, v1
    ds_read_b128 v[64:67], v21
    ds_read_b128 v[68:71], v21 offset:2048
    v_mfma_f32_16x16x32_bf16 v[136:139], v[80:83], v[116:119], v[136:139]
    ds_read_b64_tr_b16 v[32:33], v2 offset:0
    v_mfma_f32_16x16x32_bf16 v[132:135], v[84:87], v[112:115], v[132:135]
    ds_read_b64_tr_b16 v[34:35], v2 offset:1024
    ds_read_b64_tr_b16 v[36:37], v3 offset:0
    v_mfma_f32_16x16x32_bf16 v[140:143], v[84:87], v[116:119], v[140:143]
    ds_read_b64_tr_b16 v[38:39], v3 offset:1024
    v_mfma_f32_16x16x32_bf16 v[144:147], v[88:91], v[112:115], v[144:147]
    ds_read_b64_tr_b16 v[40:41], v4 offset:0
    v_mfma_f32_16x16x32_bf16 v[152:155], v[88:91], v[116:119], v[152:155]
    ds_read_b64_tr_b16 v[42:43], v4 offset:1024
    ds_read_b64_tr_b16 v[44:45], v5 offset:0
    v_mfma_f32_16x16x32_bf16 v[148:151], v[92:95], v[112:115], v[148:151]
    ds_read_b64_tr_b16 v[46:47], v5 offset:1024
    v_mfma_f32_16x16x32_bf16 v[156:159], v[92:95], v[116:119], v[156:159]
    ds_read_b64_tr_b16 v[48:49], v6 offset:0
    ds_read_b64_tr_b16 v[50:51], v6 offset:1024
    v_mfma_f32_16x16x32_bf16 v[160:163], v[96:99], v[112:115], v[160:163]
    ds_read_b64_tr_b16 v[52:53], v7 offset:0
    s_cmp_lt_u32 s5, 2
    s_cbranch_scc1 se_53
    s_add_u32 s99, s66, 16384
    buffer_store_dwordx4 v[232:235], v15, s[8:11], s99 offen offset:2048 sc1
se_53:
    v_mfma_f32_16x16x32_bf16 v[168:171], v[96:99], v[116:119], v[168:171]
    ds_read_b64_tr_b16 v[54:55], v7 offset:1024
    v_mfma_f32_16x16x32_bf16 v[164:167], v[100:103], v[112:115], v[164:167]
    ds_read_b64_tr_b16 v[56:57], v8 offset:0
    ds_read_b64_tr_b16 v[58:59], v8 offset:1024
    v_mfma_f32_16x16x32_bf16 v[172:175], v[100:103], v[116:119], v[172:175]
    ds_read_b64_tr_b16 v[60:61], v9 offset:0
    v_mfma_f32_16x16x32_bf16 v[176:179], v[104:107], v[112:115], v[176:179]
    ds_read_b64_tr_b16 v[62:63], v9 offset:1024
    v_mfma_f32_16x16x32_bf16 v[184:187], v[104:107], v[116:119], v[184:187]
    v_mfma_f32_16x16x32_bf16 v[180:183], v[108:111], v[112:115], v[180:183]
    v_mfma_f32_16x16x32_bf16 v[188:191], v[108:111], v[116:119], v[188:191]
    s_waitcnt lgkmcnt(0)
    s_barrier
    v_mfma_f32_16x16x32_bf16 v[128:131], v[32:35], v[64:67], v[128:131]
    v_xor_b32 v21, 32832, v1
    ds_read_b128 v[112:115], v21
    ds_read_b128 v[116:119], v21 offset:2048
    v_mfma_f32_16x16x32_bf16 v[136:139], v[32:35], v[68:71], v[136:139]
    ds_read_b64_tr_b16 v[80:81], v2 offset:8192
    v_mfma_f32_16x16x32_bf16 v[132:135], v[36:39], v[64:67], v[132:135]
    ds_read_b64_tr_b16 v[82:83], v2 offset:9216
    ds_read_b64_tr_b16 v[84:85], v3 offset:8192
    v_mfma_f32_16x16x32_bf16 v[140:143], v[36:39], v[68:71], v[140:143]
    ds_read_b64_tr_b16 v[86:87], v3 offset:9216
    v_mfma_f32_16x16x32_bf16 v[144:147], v[40:43], v[64:67], v[144:147]
    ds_read_b64_tr_b16 v[88:89], v4 offset:8192
    v_mfma_f32_16x16x32_bf16 v[152:155], v[40:43], v[68:71], v[152:155]
    ds_read_b64_tr_b16 v[90:91], v4 offset:9216
    ds_read_b64_tr_b16 v[92:93], v5 offset:8192
    v_mfma_f32_16x16x32_bf16 v[148:151], v[44:47], v[64:67], v[148:151]
    ds_read_b64_tr_b16 v[94:95], v5 offset:9216
    v_mfma_f32_16x16x32_bf16 v[156:159], v[44:47], v[68:71], v[156:159]
    ds_read_b64_tr_b16 v[96:97], v6 offset:8192
    ds_read_b64_tr_b16 v[98:99], v6 offset:9216
    v_mfma_f32_16x16x32_bf16 v[160:163], v[48:51], v[64:67], v[160:163]
    ds_read_b64_tr_b16 v[100:101], v7 offset:8192
    s_cmp_lt_u32 s5, 2
    s_cbranch_scc1 se_55
    s_add_u32 s99, s66, 16384
    buffer_store_dwordx4 v[236:239], v15, s[8:11], s99 offen offset:3072 sc1
se_55:
    v_mfma_f32_16x16x32_bf16 v[168:171], v[48:51], v[68:71], v[168:171]
    ds_read_b64_tr_b16 v[102:103], v7 offset:9216
    v_mfma_f32_16x16x32_bf16 v[164:167], v[52:55], v[64:67], v[164:167]
    ds_read_b64_tr_b16 v[104:105], v8 offset:8192
    ds_read_b64_tr_b16 v[106:107], v8 offset:9216
    v_mfma_f32_16x16x32_bf16 v[172:175], v[52:55], v[68:71], v[172:175]
    ds_read_b64_tr_b16 v[108:109], v9 offset:8192
    v_mfma_f32_16x16x32_bf16 v[176:179], v[56:59], v[64:67], v[176:179]
    ds_read_b64_tr_b16 v[110:111], v9 offset:9216
    v_mfma_f32_16x16x32_bf16 v[184:187], v[56:59], v[68:71], v[184:187]
    v_mfma_f32_16x16x32_bf16 v[180:183], v[60:63], v[64:67], v[180:183]
    v_mfma_f32_16x16x32_bf16 v[188:191], v[60:63], v[68:71], v[188:191]
    s_waitcnt lgkmcnt(0)
    s_barrier
    s_cmp_eq_u32 s3, 0
    s_cbranch_scc1 fl_56
flr_57:
    v_mfma_f32_16x16x32_bf16 v[128:131], v[80:83], v[112:115], v[128:131]
    v_xor_b32 v21, 98304, v1
    ds_read_b128 v[64:67], v21
    ds_read_b128 v[68:71], v21 offset:2048
    v_mfma_f32_16x16x32_bf16 v[136:139], v[80:83], v[116:119], v[136:139]
    ds_read_b64_tr_b16 v[32:33], v2 offset:16384
    v_mfma_f32_16x16x32_bf16 v[132:135], v[84:87], v[112:115], v[132:135]
    ds_read_b64_tr_b16 v[34:35], v2 offset:17408
    ds_read_b64_tr_b16 v[36:37], v3 offset:16384
    v_mfma_f32_16x16x32_bf16 v[140:143], v[84:87], v[116:119], v[140:143]
    ds_read_b64_tr_b16 v[38:39], v3 offset:17408
    v_mfma_f32_16x16x32_bf16 v[144:147], v[88:91], v[112:115], v[144:147]
    ds_read_b64_tr_b16 v[40:41], v4 offset:16384
    v_mfma_f32_16x16x32_bf16 v[152:155], v[88:91], v[116:119], v[152:155]
    ds_read_b64_tr_b16 v[42:43], v4 offset:17408
    ds_read_b64_tr_b16 v[44:45], v5 offset:16384
    v_mfma_f32_16x16x32_bf16 v[148:151], v[92:95], v[112:115], v[148:151]
    ds_read_b64_tr_b16 v[46:47], v5 offset:17408
    v_mfma_f32_16x16x32_bf16 v[156:159], v[92:95], v[116:119], v[156:159]
    ds_read_b64_tr_b16 v[48:49], v6 offset:16384
    ds_read_b64_tr_b16 v[50:51], v6 offset:17408
    v_mfma_f32_16x16x32_bf16 v[160:163], v[96:99], v[112:115], v[160:163]
    ds_read_b64_tr_b16 v[52:53], v7 offset:16384
    s_cmp_lt_u32 s5, 2
    s_cbranch_scc1 se_59
    s_add_u32 s99, s66, 24576
    buffer_store_dwordx4 v[240:243], v15, s[8:11], s99 offen offset:0 sc1
se_59:
    v_mfma_f32_16x16x32_bf16 v[168:171], v[96:99], v[116:119], v[168:171]
    ds_read_b64_tr_b16 v[54:55], v7 offset:17408
    v_mfma_f32_16x16x32_bf16 v[164:167], v[100:103], v[112:115], v[164:167]
    ds_read_b64_tr_b16 v[56:57], v8 offset:16384
    ds_read_b64_tr_b16 v[58:59], v8 offset:17408
    v_mfma_f32_16x16x32_bf16 v[172:175], v[100:103], v[116:119], v[172:175]
    ds_read_b64_tr_b16 v[60:61], v9 offset:16384
    v_mfma_f32_16x16x32_bf16 v[176:179], v[104:107], v[112:115], v[176:179]
    ds_read_b64_tr_b16 v[62:63], v9 offset:17408
    v_mfma_f32_16x16x32_bf16 v[184:187], v[104:107], v[116:119], v[184:187]
    v_mfma_f32_16x16x32_bf16 v[180:183], v[108:111], v[112:115], v[180:183]
    v_mfma_f32_16x16x32_bf16 v[188:191], v[108:111], v[116:119], v[188:191]
    s_waitcnt lgkmcnt(0)
    s_barrier
    v_mfma_f32_16x16x32_bf16 v[128:131], v[32:35], v[64:67], v[128:131]
    v_xor_b32 v21, 98368, v1
    ds_read_b128 v[112:115], v21
    ds_read_b128 v[116:119], v21 offset:2048
    v_mfma_f32_16x16x32_bf16 v[136:139], v[32:35], v[68:71], v[136:139]
    ds_read_b64_tr_b16 v[80:81], v2 offset:24576
    v_mfma_f32_16x16x32_bf16 v[132:135], v[36:39], v[64:67], v[132:135]
    ds_read_b64_tr_b16 v[82:83], v2 offset:25600
    ds_read_b64_tr_b16 v[84:85], v3 offset:24576
    v_mfma_f32_16x16x32_bf16 v[140:143], v[36:39], v[68:71], v[140:143]
    ds_read_b64_tr_b16 v[86:87], v3 offset:25600
    v_mfma_f32_16x16x32_bf16 v[144:147], v[40:43], v[64:67], v[144:147]
    ds_read_b64_tr_b16 v[88:89], v4 offset:24576
    v_mfma_f32_16x16x32_bf16 v[152:155], v[40:43], v[68:71], v[152:155]
    ds_read_b64_tr_b16 v[90:91], v4 offset:25600
    ds_read_b64_tr_b16 v[92:93], v5 offset:24576
    v_mfma_f32_16x16x32_bf16 v[148:151], v[44:47], v[64:67], v[148:151]
    ds_read_b64_tr_b16 v[94:95], v5 offset:25600
    v_mfma_f32_16x16x32_bf16 v[156:159], v[44:47], v[68:71], v[156:159]
    ds_read_b64_tr_b16 v[96:97], v6 offset:24576
    ds_read_b64_tr_b16 v[98:99], v6 offset:25600
    v_mfma_f32_16x16x32_bf16 v[160:163], v[48:51], v[64:67], v[160:163]
    ds_read_b64_tr_b16 v[100:101], v7 offset:24576
    s_cmp_lt_u32 s5, 2
    s_cbranch_scc1 se_61
    s_add_u32 s99, s66, 24576
    buffer_store_dwordx4 v[244:247], v15, s[8:11], s99 offen offset:1024 sc1
se_61:
    v_mfma_f32_16x16x32_bf16 v[168:171], v[48:51], v[68:71], v[168:171]
    ds_read_b64_tr_b16 v[102:103], v7 offset:25600
    v_mfma_f32_16x16x32_bf16 v[164:167], v[52:55], v[64:67], v[164:167]
    ds_read_b64_tr_b16 v[104:105], v8 offset:24576
    ds_read_b64_tr_b16 v[106:107], v8 offset:25600
    v_mfma_f32_16x16x32_bf16 v[172:175], v[52:55], v[68:71], v[172:175]
    ds_read_b64_tr_b16 v[108:109], v9 offset:24576
    v_mfma_f32_16x16x32_bf16 v[176:179], v[56:59], v[64:67], v[176:179]
    ds_read_b64_tr_b16 v[110:111], v9 offset:25600
    v_mfma_f32_16x16x32_bf16 v[184:187], v[56:59], v[68:71], v[184:187]
    v_mfma_f32_16x16x32_bf16 v[180:183], v[60:63], v[64:67], v[180:183]
    v_mfma_f32_16x16x32_bf16 v[188:191], v[60:63], v[68:71], v[188:191]
    s_waitcnt lgkmcnt(0)
    s_barrier
    v_mfma_f32_16x16x32_bf16 v[128:131], v[80:83], v[112:115], v[128:131]
    v_xor_b32 v21, 0, v1
    ds_read_b128 v[64:67], v21
    ds_read_b128 v[68:71], v21 offset:2048
    v_mfma_f32_16x16x32_bf16 v[136:139], v[80:83], v[116:119], v[136:139]
    ds_read_b64_tr_b16 v[32:33], v2 offset:0
    v_mfma_f32_16x16x32_bf16 v[132:135], v[84:87], v[112:115], v[132:135]
    ds_read_b64_tr_b16 v[34:35], v2 offset:1024
    ds_read_b64_tr_b16 v[36:37], v3 offset:0
    v_mfma_f32_16x16x32_bf16 v[140:143], v[84:87], v[116:119], v[140:143]
    ds_read_b64_tr_b16 v[38:39], v3 offset:1024
    v_mfma_f32_16x16x32_bf16 v[144:147], v[88:91], v[112:115], v[144:147]
    ds_read_b64_tr_b16 v[40:41], v4 offset:0
    v_mfma_f32_16x16x32_bf16 v[152:155], v[88:91], v[116:119], v[152:155]
    ds_read_b64_tr_b16 v[42:43], v4 offset:1024
    ds_read_b64_tr_b16 v[44:45], v5 offset:0
    v_mfma_f32_16x16x32_bf16 v[148:151], v[92:95], v[112:115], v[148:151]
    ds_read_b64_tr_b16 v[46:47], v5 offset:1024
    v_mfma_f32_16x16x32_bf16 v[156:159], v[92:95], v[116:119], v[156:159]
    ds_read_b64_tr_b16 v[48:49], v6 offset:0
    ds_read_b64_tr_b16 v[50:51], v6 offset:1024
    v_mfma_f32_16x16x32_bf16 v[160:163], v[96:99], v[112:115], v[160:163]
    ds_read_b64_tr_b16 v[52:53], v7 offset:0
    s_cmp_lt_u32 s5, 2
    s_cbranch_scc1 se_63
    s_add_u32 s99, s66, 24576
    buffer_store_dwordx4 v[248:251], v15, s[8:11], s99 offen offset:2048 sc1
se_63:
    v_mfma_f32_16x16x32_bf16 v[168:171], v[96:99], v[116:119], v[168:171]
    ds_read_b64_tr_b16 v[54:55], v7 offset:1024
    v_mfma_f32_16x16x32_bf16 v[164:167], v[100:103], v[112:115], v[164:167]
    ds_read_b64_tr_b16 v[56:57], v8 offset:0
    ds_read_b64_tr_b16 v[58:59], v8 offset:1024
    v_mfma_f32_16x16x32_bf16 v[172:175], v[100:103], v[116:119], v[172:175]
    ds_read_b64_tr_b16 v[60:61], v9 offset:0
    v_mfma_f32_16x16x32_bf16 v[176:179], v[104:107], v[112:115], v[176:179]
    ds_read_b64_tr_b16 v[62:63], v9 offset:1024
    v_mfma_f32_16x16x32_bf16 v[184:187], v[104:107], v[116:119], v[184:187]
    v_mfma_f32_16x16x32_bf16 v[180:183], v[108:111], v[112:115], v[180:183]
    v_mfma_f32_16x16x32_bf16 v[188:191], v[108:111], v[116:119], v[188:191]
    s_cmp_eq_u32 s3, 0
    s_cbranch_scc1 chk_64
chkr_65:
    s_waitcnt lgkmcnt(0)
    s_barrier
    v_mfma_f32_16x16x32_bf16 v[128:131], v[32:35], v[64:67], v[128:131]
    v_xor_b32 v21, 64, v1
    ds_read_b128 v[112:115], v21
    ds_read_b128 v[116:119], v21 offset:2048
    s_cmp_lt_u32 s5, 2
    s_cbranch_scc1 se_70
    s_add_u32 s99, s66, 24576
    buffer_store_dwordx4 v[252:255], v15, s[8:11], s99 offen offset:3072 sc1
se_70:
    v_mfma_f32_16x16x32_bf16 v[136:139], v[32:35], v[68:71], v[136:139]
    ds_read_b64_tr_b16 v[80:81], v2 offset:8192
    v_mfma_f32_16x16x32_bf16 v[132:135], v[36:39], v[64:67], v[132:135]
    ds_read_b64_tr_b16 v[82:83], v2 offset:9216
    ds_read_b64_tr_b16 v[84:85], v3 offset:8192
    s_mov_b32 s24, 0xf0000
    s_mov_b32 s25, 0xfff00ff
    v_mfma_f32_16x16x32_bf16 v[140:143], v[36:39], v[68:71], v[140:143]
    ds_read_b64_tr_b16 v[86:87], v3 offset:9216
    v_mfma_f32_16x16x32_bf16 v[144:147], v[40:43], v[64:67], v[144:147]
    ds_read_b64_tr_b16 v[88:89], v4 offset:8192
    s_mov_b32 s26, 0x1f0001
    s_mov_b32 s27, 0x1fff01ff
    v_mfma_f32_16x16x32_bf16 v[152:155], v[40:43], v[68:71], v[152:155]
    ds_read_b64_tr_b16 v[90:91], v4 offset:9216
    ds_read_b64_tr_b16 v[92:93], v5 offset:8192
    v_mfma_f32_16x16x32_bf16 v[148:151], v[44:47], v[64:67], v[148:151]
    ds_read_b64_tr_b16 v[94:95], v5 offset:9216
    s_mov_b32 s28, 0x3f0003
    s_mov_b32 s29, 0x3fff03ff
    v_mfma_f32_16x16x32_bf16 v[156:159], v[44:47], v[68:71], v[156:159]
    ds_read_b64_tr_b16 v[96:97], v6 offset:8192
    ds_read_b64_tr_b16 v[98:99], v6 offset:9216
    v_mfma_f32_16x16x32_bf16 v[160:163], v[48:51], v[64:67], v[160:163]
    ds_read_b64_tr_b16 v[100:101], v7 offset:8192
    s_mov_b32 s30, 0x7f0007
    s_mov_b32 s31, 0x7fff07ff
    v_mfma_f32_16x16x32_bf16 v[168:171], v[48:51], v[68:71], v[168:171]
    ds_read_b64_tr_b16 v[102:103], v7 offset:9216
    s_mov_b32 s32, 0xffffffff
    s_mov_b32 s33, 0xffffffff
    v_mfma_f32_16x16x32_bf16 v[164:167], v[52:55], v[64:67], v[164:167]
    ds_read_b64_tr_b16 v[104:105], v8 offset:8192
    ds_read_b64_tr_b16 v[106:107], v8 offset:9216
    v_mfma_f32_16x16x32_bf16 v[172:175], v[52:55], v[68:71], v[172:175]
    ds_read_b64_tr_b16 v[108:109], v9 offset:8192
    s_mov_b32 s34, 0xffffffff
    s_mov_b32 s35, 0xffffffff
    v_mfma_f32_16x16x32_bf16 v[176:179], v[56:59], v[64:67], v[176:179]
    ds_read_b64_tr_b16 v[110:111], v9 offset:9216
    v_mfma_f32_16x16x32_bf16 v[184:187], v[56:59], v[68:71], v[184:187]
    s_mov_b32 s36, 0xffffffff
    s_mov_b32 s37, 0xffffffff
    v_mfma_f32_16x16x32_bf16 v[180:183], v[60:63], v[64:67], v[180:183]
    v_mfma_f32_16x16x32_bf16 v[188:191], v[60:63], v[68:71], v[188:191]
    s_mov_b32 s38, 0xffffffff
    s_mov_b32 s39, 0xffffffff
    s_waitcnt lgkmcnt(0)
    s_barrier
    v_mfma_f32_16x16x32_bf16 v[128:131], v[80:83], v[112:115], v[128:131]
    v_xor_b32 v21, 32768, v1
    ds_read_b128 v[64:67], v21
    ds_read_b128 v[68:71], v21 offset:2048
    v_mfma_f32_16x16x32_bf16 v[136:139], v[80:83], v[116:119], v[136:139]
    ds_read_b64_tr_b16 v[32:33], v2 offset:16384
    v_mfma_f32_16x16x32_bf16 v[132:135], v[84:87], v[112:115], v[132:135]
    ds_read_b64_tr_b16 v[34:35], v2 offset:17408
    ds_read_b64_tr_b16 v[36:37], v3 offset:16384
    v_mfma_f32_16x16x32_bf16 v[140:143], v[84:87], v[116:119], v[140:143]
    ds_read_b64_tr_b16 v[38:39], v3 offset:17408
    v_mfma_f32_16x16x32_bf16 v[144:147], v[88:91], v[112:115], v[144:147]
    ds_read_b64_tr_b16 v[40:41], v4 offset:16384
    v_mfma_f32_16x16x32_bf16 v[152:155], v[88:91], v[116:119], v[152:155]
    ds_read_b64_tr_b16 v[42:43], v4 offset:17408
    ds_read_b64_tr_b16 v[44:45], v5 offset:16384
    v_mfma_f32_16x16x32_bf16 v[148:151], v[92:95], v[112:115], v[148:151]
    ds_read_b64_tr_b16 v[46:47], v5 offset:17408
    v_mfma_f32_16x16x32_bf16 v[156:159], v[92:95], v[116:119], v[156:159]
    ds_read_b64_tr_b16 v[48:49], v6 offset:16384
    ds_read_b64_tr_b16 v[50:51], v6 offset:17408
    v_mfma_f32_16x16x32_bf16 v[160:163], v[96:99], v[112:115], v[160:163]
    ds_read_b64_tr_b16 v[52:53], v7 offset:16384
    v_mfma_f32_16x16x32_bf16 v[168:171], v[96:99], v[116:119], v[168:171]
    ds_read_b64_tr_b16 v[54:55], v7 offset:17408
    v_mfma_f32_16x16x32_bf16 v[164:167], v[100:103], v[112:115], v[164:167]
    ds_read_b64_tr_b16 v[56:57], v8 offset:16384
    ds_read_b64_tr_b16 v[58:59], v8 offset:17408
    v_mfma_f32_16x16x32_bf16 v[172:175], v[100:103], v[116:119], v[172:175]
    ds_read_b64_tr_b16 v[60:61], v9 offset:16384
    v_mfma_f32_16x16x32_bf16 v[176:179], v[104:107], v[112:115], v[176:179]
    ds_read_b64_tr_b16 v[62:63], v9 offset:17408
    v_mfma_f32_16x16x32_bf16 v[184:187], v[104:107], v[116:119], v[184:187]
    v_mfma_f32_16x16x32_bf16 v[180:183], v[108:111], v[112:115], v[180:183]
    v_mfma_f32_16x16x32_bf16 v[188:191], v[108:111], v[116:119], v[188:191]
    s_waitcnt lgkmcnt(0)
    s_barrier
    v_mfma_f32_16x16x32_bf16 v[128:131], v[32:35], v[64:67], v[128:131]
    v_xor_b32 v21, 32832, v1
    ds_read_b128 v[112:115], v21
    ds_read_b128 v[116:119], v21 offset:2048
    v_mfma_f32_16x16x32_bf16 v[136:139], v[32:35], v[68:71], v[136:139]
    ds_read_b64_tr_b16 v[80:81], v2 offset:24576
    s_mov_b32 s40, 0x0
    s_mov_b32 s41, 0x0
    v_mfma_f32_16x16x32_bf16 v[132:135], v[36:39], v[64:67], v[132:135]
    ds_read_b64_tr_b16 v[82:83], v2 offset:25600
    ds_read_b64_tr_b16 v[84:85], v3 offset:24576
    v_mfma_f32_16x16x32_bf16 v[140:143], v[36:39], v[68:71], v[140:143]
    ds_read_b64_tr_b16 v[86:87], v3 offset:25600
    s_mov_b32 s42, 0x0
    s_mov_b32 s43, 0x0
    v_mfma_f32_16x16x32_bf16 v[144:147], v[40:43], v[64:67], v[144:147]
    ds_read_b64_tr_b16 v[88:89], v4 offset:24576
    v_mfma_f32_16x16x32_bf16 v[152:155], v[40:43], v[68:71], v[152:155]
    ds_read_b64_tr_b16 v[90:91], v4 offset:25600
    ds_read_b64_tr_b16 v[92:93], v5 offset:24576
    s_mov_b32 s44, 0x0
    s_mov_b32 s45, 0x0
    v_mfma_f32_16x16x32_bf16 v[148:151], v[44:47], v[64:67], v[148:151]
    ds_read_b64_tr_b16 v[94:95], v5 offset:25600
    v_mfma_f32_16x16x32_bf16 v[156:159], v[44:47], v[68:71], v[156:159]
    ds_read_b64_tr_b16 v[96:97], v6 offset:24576
    ds_read_b64_tr_b16 v[98:99], v6 offset:25600
    s_mov_b32 s46, 0x0
    s_mov_b32 s47, 0x0
    v_mfma_f32_16x16x32_bf16 v[160:163], v[48:51], v[64:67], v[160:163]
    ds_read_b64_tr_b16 v[100:101], v7 offset:24576
    v_mfma_f32_16x16x32_bf16 v[168:171], v[48:51], v[68:71], v[168:171]
    ds_read_b64_tr_b16 v[102:103], v7 offset:25600
    s_mov_b32 s48, 0xf0000
    s_mov_b32 s49, 0xfff00ff
    v_mfma_f32_16x16x32_bf16 v[164:167], v[52:55], v[64:67], v[164:167]
    ds_read_b64_tr_b16 v[104:105], v8 offset:24576
    ds_read_b64_tr_b16 v[106:107], v8 offset:25600
    v_mfma_f32_16x16x32_bf16 v[172:175], v[52:55], v[68:71], v[172:175]
    ds_read_b64_tr_b16 v[108:109], v9 offset:24576
    s_mov_b32 s50, 0x1f0001
    s_mov_b32 s51, 0x1fff01ff
    v_mfma_f32_16x16x32_bf16 v[176:179], v[56:59], v[64:67], v[176:179]
    ds_read_b64_tr_b16 v[110:111], v9 offset:25600
    v_mfma_f32_16x16x32_bf16 v[184:187], v[56:59], v[68:71], v[184:187]
    s_mov_b32 s52, 0x3f0003
    s_mov_b32 s53, 0x3fff03ff
    v_mfma_f32_16x16x32_bf16 v[180:183], v[60:63], v[64:67], v[180:183]
    v_mfma_f32_16x16x32_bf16 v[188:191], v[60:63], v[68:71], v[188:191]
    s_mov_b32 s54, 0x7f0007
    s_mov_b32 s55, 0x7fff07ff
    s_waitcnt vmcnt(0) lgkmcnt(0)
    s_barrier
    s_cmp_eq_u32 s3, 0
    s_cbranch_scc1 pub_71
pubr_72:
    v_mfma_f32_16x16x32_bf16 v[128:131], v[80:83], v[112:115], v[128:131]
    v_mov_b32 v64, 0
    v_mov_b32 v65, 0
    v_mfma_f32_16x16x32_bf16 v[136:139], v[80:83], v[116:119], v[136:139]
    v_mov_b32 v66, 0
    v_mov_b32 v67, 0
    v_mfma_f32_16x16x32_bf16 v[132:135], v[84:87], v[112:115], v[132:135]
    v_mov_b32 v68, 0
    v_mov_b32 v69, 0
    v_mfma_f32_16x16x32_bf16 v[140:143], v[84:87], v[116:119], v[140:143]
    v_mov_b32 v70, 0
    v_mov_b32 v71, 0
    v_mfma_f32_16x16x32_bf16 v[144:147], v[88:91], v[112:115], v[144:147]
    v_mov_b32 v72, 0
    v_mov_b32 v73, 0
    v_mfma_f32_16x16x32_bf16 v[152:155], v[88:91], v[116:119], v[152:155]
    v_mov_b32 v74, 0
    v_mov_b32 v75, 0
    v_mfma_f32_16x16x32_bf16 v[148:151], v[92:95], v[112:115], v[148:151]
    v_mov_b32 v76, 0
    v_mfma_f32_16x16x32_bf16 v[156:159], v[92:95], v[116:119], v[156:159]
    v_mov_b32 v77, 0
    v_mov_b32 v78, 0
    v_mfma_f32_16x16x32_bf16 v[160:163], v[96:99], v[112:115], v[160:163]
    v_mov_b32 v79, 0
    v_mov_b32 v120, 0
    v_mfma_f32_16x16x32_bf16 v[168:171], v[96:99], v[116:119], v[168:171]
    v_mov_b32 v121, 0
    v_mov_b32 v122, 0
    v_mfma_f32_16x16x32_bf16 v[164:167], v[100:103], v[112:115], v[164:167]
    v_mov_b32 v123, 0
    v_mov_b32 v124, 0
    v_mfma_f32_16x16x32_bf16 v[172:175], v[100:103], v[116:119], v[172:175]
    v_mov_b32 v125, 0
    v_mov_b32 v126, 0
    v_mfma_f32_16x16x32_bf16 v[176:179], v[104:107], v[112:115], v[176:179]
    v_mov_b32 v127, 0
    v_mfma_f32_16x16x32_bf16 v[184:187], v[104:107], v[116:119], v[184:187]
    v_mfma_f32_16x16x32_bf16 v[180:183], v[108:111], v[112:115], v[180:183]
    v_mfma_f32_16x16x32_bf16 v[188:191], v[108:111], v[116:119], v[188:191]
    s_branch q_epi
p2_s:
    s_setprio 1
    s_waitcnt lgkmcnt(0)
    s_barrier
    v_mfma_f32_16x16x32_bf16 v[128:131], v[32:35], v[64:67], 0
    v_xor_b32 v21, 64, v1
    ds_read_b128 v[112:115], v21
    ds_read_b128 v[116:119], v21 offset:2048
    v_mfma_f32_16x16x32_bf16 v[136:139], v[32:35], v[68:71], 0
    ds_read_b64_tr_b16 v[80:81], v2 offset:8192
    s_add_u32 m0, s77, 98304
    s_add_u32 s64, s80, 256
    buffer_load_dwordx4 v10, s[36:39], s64 offen lds
    v_mfma_f32_16x16x32_bf16 v[132:135], v[36:39], v[64:67], 0
    ds_read_b64_tr_b16 v[82:83], v2 offset:9216
    ds_read_b64_tr_b16 v[84:85], v3 offset:8192
    v_mfma_f32_16x16x32_bf16 v[140:143], v[36:39], v[68:71], 0
    ds_read_b64_tr_b16 v[86:87], v3 offset:9216
    v_mfma_f32_16x16x32_bf16 v[144:147], v[40:43], v[64:67], 0
    ds_read_b64_tr_b16 v[88:89], v4 offset:8192
    s_add_u32 m0, s77, 99328
    s_add_u32 s64, s80, 8448
    buffer_load_dwordx4 v23, s[36:39], s64 offen lds
    v_mfma_f32_16x16x32_bf16 v[152:155], v[40:43], v[68:71], 0
    ds_read_b64_tr_b16 v[90:91], v4 offset:9216
    ds_read_b64_tr_b16 v[92:93], v5 offset:8192
    v_mfma_f32_16x16x32_bf16 v[148:151], v[44:47], v[64:67], 0
    ds_read_b64_tr_b16 v[94:95], v5 offset:9216
    s_add_u32 m0, s77, 100352
    s_add_u32 s64, s80, 16640
    buffer_load_dwordx4 v10, s[36:39], s64 offen lds
    v_mfma_f32_16x16x32_bf16 v[156:159], v[44:47], v[68:71], 0
    ds_read_b64_tr_b16 v[96:97], v6 offset:8192
    ds_read_b64_tr_b16 v[98:99], v6 offset:9216
    v_mfma_f32_16x16x32_bf16 v[160:163], v[48:51], v[64:67], 0
    ds_read_b64_tr_b16 v[100:101], v7 offset:8192
    v_mfma_f32_16x16x32_bf16 v[168:171], v[48:51], v[68:71], 0
    ds_read_b64_tr_b16 v[102:103], v7 offset:9216
    s_add_u32 m0, s77, 101376
    s_add_u32 s64, s80, 24832
    buffer_load_dwordx4 v23, s[36:39], s64 offen lds
    v_mfma_f32_16x16x32_bf16 v[164:167], v[52:55], v[64:67], 0
    ds_read_b64_tr_b16 v[104:105], v8 offset:8192
    ds_read_b64_tr_b16 v[106:107], v8 offset:9216
    v_mfma_f32_16x16x32_bf16 v[172:175], v[52:55], v[68:71], 0
    ds_read_b64_tr_b16 v[108:109], v9 offset:8192
    v_mfma_f32_16x16x32_bf16 v[176:179], v[56:59], v[64:67], 0
    ds_read_b64_tr_b16 v[110:111], v9 offset:9216
    s_add_u32 m0, s61, 65536
    s_add_u32 s64, s82, 1048576
    buffer_load_dwordx4 v11, s[40:43], s64 offen lds
    v_mfma_f32_16x16x32_bf16 v[184:187], v[56:59], v[68:71], 0
    v_mfma_f32_16x16x32_bf16 v[180:183], v[60:63], v[64:67], 0
    s_add_u32 m0, s61, 69632
    s_add_u32 s64, s82, 1179648
    buffer_load_dwordx4 v11, s[40:43], s64 offen lds
    v_mfma_f32_16x16x32_bf16 v[188:191], v[60:63], v[68:71], 0
    s_waitcnt vmcnt(18) lgkmcnt(0)
    s_barrier
    v_mfma_f32_16x16x32_bf16 v[128:131], v[80:83], v[112:115], v[128:131]
    v_xor_b32 v21, 32768, v1
    ds_read_b128 v[64:67], v21
    ds_read_b128 v[68:71], v21 offset:2048
    v_mfma_f32_16x16x32_bf16 v[136:139], v[80:83], v[116:119], v[136:139]
    ds_read_b64_tr_b16 v[32:33], v2 offset:16384
    s_add_u32 m0, s77, 114688
    s_add_u32 s64, s81, 256
    buffer_load_dwordx4 v10, s[36:39], s64 offen lds
    v_mfma_f32_16x16x32_bf16 v[132:135], v[84:87], v[112:115], v[132:135]
    ds_read_b64_tr_b16 v[34:35], v2 offset:17408
    ds_read_b64_tr_b16 v[36:37], v3 offset:16384
    v_mfma_f32_16x16x32_bf16 v[140:143], v[84:87], v[116:119], v[140:143]
    ds_read_b64_tr_b16 v[38:39], v3 offset:17408
    v_mfma_f32_16x16x32_bf16 v[144:147], v[88:91], v[112:115], v[144:147]
    ds_read_b64_tr_b16 v[40:41], v4 offset:16384
    s_add_u32 m0, s77, 115712
    s_add_u32 s64, s81, 8448
    buffer_load_dwordx4 v23, s[36:39], s64 offen lds
    v_mfma_f32_16x16x32_bf16 v[152:155], v[88:91], v[116:119], v[152:155]
    ds_read_b64_tr_b16 v[42:43], v4 offset:17408
    ds_read_b64_tr_b16 v[44:45], v5 offset:16384
    v_mfma_f32_16x16x32_bf16 v[148:151], v[92:95], v[112:115], v[148:151]
    ds_read_b64_tr_b16 v[46:47], v5 offset:17408
    s_add_u32 m0, s77, 116736
    s_add_u32 s64, s81, 16640
    buffer_load_dwordx4 v10, s[36:39], s64 offen lds
    v_mfma_f32_16x16x32_bf16 v[156:159], v[92:95], v[116:119], v[156:159]
    ds_read_b64_tr_b16 v[48:49], v6 offset:16384
    ds_read_b64_tr_b16 v[50:51], v6 offset:17408
    v_mfma_f32_16x16x32_bf16 v[160:163], v[96:99], v[112:115], v[160:163]
    ds_read_b64_tr_b16 v[52:53], v7 offset:16384
    v_mfma_f32_16x16x32_bf16 v[168:171], v[96:99], v[116:119], v[168:171]
    ds_read_b64_tr_b16 v[54:55], v7 offset:17408
    s_add_u32 m0, s77, 117760
    s_add_u32 s64, s81, 24832
    buffer_load_dwordx4 v23, s[36:39], s64 offen lds
    v_mfma_f32_16x16x32_bf16 v[164:167], v[100:103], v[112:115], v[164:167]
    ds_read_b64_tr_b16 v[56:57], v8 offset:16384
    ds_read_b64_tr_b16 v[58:59], v8 offset:17408
    v_mfma_f32_16x16x32_bf16 v[172:175], v[100:103], v[116:119], v[172:175]
    ds_read_b64_tr_b16 v[60:61], v9 offset:16384
    v_mfma_f32_16x16x32_bf16 v[176:179], v[104:107], v[112:115], v[176:179]
    ds_read_b64_tr_b16 v[62:63], v9 offset:17408
    s_add_u32 m0, s61, 73728
    s_add_u32 s64, s82, 1310720
    buffer_load_dwordx4 v11, s[40:43], s64 offen lds
    v_mfma_f32_16x16x32_bf16 v[184:187], v[104:107], v[116:119], v[184:187]
    v_mfma_f32_16x16x32_bf16 v[180:183], v[108:111], v[112:115], v[180:183]
    s_add_u32 m0, s61, 77824
    s_add_u32 s64, s82, 1441792
    buffer_load_dwordx4 v11, s[40:43], s64 offen lds
    v_mfma_f32_16x16x32_bf16 v[188:191], v[108:111], v[116:119], v[188:191]
    s_waitcnt vmcnt(24) lgkmcnt(0)
    s_barrier
    v_mfma_f32_16x16x32_bf16 v[128:131], v[32:35], v[64:67], v[128:131]
    v_xor_b32 v21, 32832, v1
    ds_read_b128 v[112:115], v21
    ds_read_b128 v[116:119], v21 offset:2048
    v_mfma_f32_16x16x32_bf16 v[136:139], v[32:35], v[68:71], v[136:139]
    ds_read_b64_tr_b16 v[80:81], v2 offset:24576
    s_add_u32 m0, s77, 0
    s_add_u32 s64, s80, 384
    buffer_load_dwordx4 v10, s[36:39], s64 offen lds
    v_mfma_f32_16x16x32_bf16 v[132:135], v[36:39], v[64:67], v[132:135]
    ds_read_b64_tr_b16 v[82:83], v2 offset:25600
    ds_read_b64_tr_b16 v[84:85], v3 offset:24576
    v_mfma_f32_16x16x32_bf16 v[140:143], v[36:39], v[68:71], v[140:143]
    ds_read_b64_tr_b16 v[86:87], v3 offset:25600
    v_mfma_f32_16x16x32_bf16 v[144:147], v[40:43], v[64:67], v[144:147]
    ds_read_b64_tr_b16 v[88:89], v4 offset:24576
    s_add_u32 m0, s77, 1024
    s_add_u32 s64, s80, 8576
    buffer_load_dwordx4 v23, s[36:39], s64 offen lds
    v_mfma_f32_16x16x32_bf16 v[152:155], v[40:43], v[68:71], v[152:155]
    ds_read_b64_tr_b16 v[90:91], v4 offset:25600
    ds_read_b64_tr_b16 v[92:93], v5 offset:24576
    v_mfma_f32_16x16x32_bf16 v[148:151], v[44:47], v[64:67], v[148:151]
    ds_read_b64_tr_b16 v[94:95], v5 offset:25600
    s_add_u32 m0, s77, 2048
    s_add_u32 s64, s80, 16768
    buffer_load_dwordx4 v10, s[36:39], s64 offen lds
    v_mfma_f32_16x16x32_bf16 v[156:159], v[44:47], v[68:71], v[156:159]
    ds_read_b64_tr_b16 v[96:97], v6 offset:24576
    ds_read_b64_tr_b16 v[98:99], v6 offset:25600
    v_mfma_f32_16x16x32_bf16 v[160:163], v[48:51], v[64:67], v[160:163]
    ds_read_b64_tr_b16 v[100:101], v7 offset:24576
    v_mfma_f32_16x16x32_bf16 v[168:171], v[48:51], v[68:71], v[168:171]
    ds_read_b64_tr_b16 v[102:103], v7 offset:25600
    s_add_u32 m0, s77, 3072
    s_add_u32 s64, s80, 24960
    buffer_load_dwordx4 v23, s[36:39], s64 offen lds
    v_mfma_f32_16x16x32_bf16 v[164:167], v[52:55], v[64:67], v[164:167]
    ds_read_b64_tr_b16 v[104:105], v8 offset:24576
    ds_read_b64_tr_b16 v[106:107], v8 offset:25600
    v_mfma_f32_16x16x32_bf16 v[172:175], v[52:55], v[68:71], v[172:175]
    ds_read_b64_tr_b16 v[108:109], v9 offset:24576
    v_mfma_f32_16x16x32_bf16 v[176:179], v[56:59], v[64:67], v[176:179]
    ds_read_b64_tr_b16 v[110:111], v9 offset:25600
    s_add_u32 m0, s61, 81920
    s_add_u32 s64, s82, 1572864
    buffer_load_dwordx4 v11, s[40:43], s64 offen lds
    v_mfma_f32_16x16x32_bf16 v[184:187], v[56:59], v[68:71], v[184:187]
    v_mfma_f32_16x16x32_bf16 v[180:183], v[60:63], v[64:67], v[180:183]
    s_add_u32 m0, s61, 86016
    s_add_u32 s64, s82, 1703936
    buffer_load_dwordx4 v11, s[40:43], s64 offen lds
    v_mfma_f32_16x16x32_bf16 v[188:191], v[60:63], v[68:71], v[188:191]
    s_waitcnt vmcnt(6) lgkmcnt(0)
    s_barrier
    v_mfma_f32_16x16x32_bf16 v[128:131], v[80:83], v[112:115], v[128:131]
    v_xor_b32 v21, 98304, v1
    ds_read_b128 v[64:67], v21
    ds_read_b128 v[68:71], v21 offset:2048
    v_mfma_f32_16x16x32_bf16 v[136:139], v[80:83], v[116:119], v[136:139]
    ds_read_b64_tr_b16 v[32:33], v2 offset:0
    s_add_u32 m0, s77, 16384
    s_add_u32 s64, s81, 384
    buffer_load_dwordx4 v10, s[36:39], s64 offen lds
    v_mfma_f32_16x16x32_bf16 v[132:135], v[84:87], v[112:115], v[132:135]
    ds_read_b64_tr_b16 v[34:35], v2 offset:1024
    ds_read_b64_tr_b16 v[36:37], v3 offset:0
    v_mfma_f32_16x16x32_bf16 v[140:143], v[84:87], v[116:119], v[140:143]
    ds_read_b64_tr_b16 v[38:39], v3 offset:1024
    v_mfma_f32_16x16x32_bf16 v[144:147], v[88:91], v[112:115], v[144:147]
    ds_read_b64_tr_b16 v[40:41], v4 offset:0
    s_add_u32 m0, s77, 17408
    s_add_u32 s64, s81, 8576
    buffer_load_dwordx4 v23, s[36:39], s64 offen lds
    v_mfma_f32_16x16x32_bf16 v[152:155], v[88:91], v[116:119], v[152:155]
    ds_read_b64_tr_b16 v[42:43], v4 offset:1024
    ds_read_b64_tr_b16 v[44:45], v5 offset:0
    v_mfma_f32_16x16x32_bf16 v[148:151], v[92:95], v[112:115], v[148:151]
    ds_read_b64_tr_b16 v[46:47], v5 offset:1024
    s_add_u32 m0, s77, 18432
    s_add_u32 s64, s81, 16768
    buffer_load_dwordx4 v10, s[36:39], s64 offen lds
    v_mfma_f32_16x16x32_bf16 v[156:159], v[92:95], v[116:119], v[156:159]
    ds_read_b64_tr_b16 v[48:49], v6 offset:0
    ds_read_b64_tr_b16 v[50:51], v6 offset:1024
    v_mfma_f32_16x16x32_bf16 v[160:163], v[96:99], v[112:115], v[160:163]
    ds_read_b64_tr_b16 v[52:53], v7 offset:0
    v_mfma_f32_16x16x32_bf16 v[168:171], v[96:99], v[116:119], v[168:171]
    ds_read_b64_tr_b16 v[54:55], v7 offset:1024
    s_add_u32 m0, s77, 19456
    s_add_u32 s64, s81, 24960
    buffer_load_dwordx4 v23, s[36:39], s64 offen lds
    v_mfma_f32_16x16x32_bf16 v[164:167], v[100:103], v[112:115], v[164:167]
    ds_read_b64_tr_b16 v[56:57], v8 offset:0
    ds_read_b64_tr_b16 v[58:59], v8 offset:1024
    v_mfma_f32_16x16x32_bf16 v[172:175], v[100:103], v[116:119], v[172:175]
    ds_read_b64_tr_b16 v[60:61], v9 offset:0
    v_mfma_f32_16x16x32_bf16 v[176:179], v[104:107], v[112:115], v[176:179]
    ds_read_b64_tr_b16 v[62:63], v9 offset:1024
    s_add_u32 m0, s61, 90112
    s_add_u32 s64, s82, 1835008
    buffer_load_dwordx4 v11, s[40:43], s64 offen lds
    v_mfma_f32_16x16x32_bf16 v[184:187], v[104:107], v[116:119], v[184:187]
    v_mfma_f32_16x16x32_bf16 v[180:183], v[108:111], v[112:115], v[180:183]
    s_add_u32 m0, s61, 94208
    s_add_u32 s64, s82, 1966080
    buffer_load_dwordx4 v11, s[40:43], s64 offen lds
    v_mfma_f32_16x16x32_bf16 v[188:191], v[108:111], v[116:119], v[188:191]
    s_waitcnt vmcnt(12) lgkmcnt(0)
    s_barrier
    v_mfma_f32_16x16x32_bf16 v[128:131], v[32:35], v[64:67], v[128:131]
    v_xor_b32 v21, 98368, v1
    ds_read_b128 v[112:115], v21
    ds_read_b128 v[116:119], v21 offset:2048
    v_mfma_f32_16x16x32_bf16 v[136:139], v[32:35], v[68:71], v[136:139]
    ds_read_b64_tr_b16 v[80:81], v2 offset:8192
    s_add_u32 m0, s77, 32768
    s_add_u32 s64, s80, 512
    buffer_load_dwordx4 v10, s[36:39], s64 offen lds
    v_mfma_f32_16x16x32_bf16 v[132:135], v[36:39], v[64:67], v[132:135]
    ds_read_b64_tr_b16 v[82:83], v2 offset:9216
    ds_read_b64_tr_b16 v[84:85], v3 offset:8192
    v_mfma_f32_16x16x32_bf16 v[140:143], v[36:39], v[68:71], v[140:143]
    ds_read_b64_tr_b16 v[86:87], v3 offset:9216
    v_mfma_f32_16x16x32_bf16 v[144:147], v[40:43], v[64:67], v[144:147]
    ds_read_b64_tr_b16 v[88:89], v4 offset:8192
    s_add_u32 m0, s77, 33792
    s_add_u32 s64, s80, 8704
    buffer_load_dwordx4 v23, s[36:39], s64 offen lds
    v_mfma_f32_16x16x32_bf16 v[152:155], v[40:43], v[68:71], v[152:155]
    ds_read_b64_tr_b16 v[90:91], v4 offset:9216
    ds_read_b64_tr_b16 v[92:93], v5 offset:8192
    v_mfma_f32_16x16x32_bf16 v[148:151], v[44:47], v[64:67], v[148:151]
    ds_read_b64_tr_b16 v[94:95], v5 offset:9216
    s_add_u32 m0, s77, 34816
    s_add_u32 s64, s80, 16896
    buffer_load_dwordx4 v10, s[36:39], s64 offen lds
    v_mfma_f32_16x16x32_bf16 v[156:159], v[44:47], v[68:71], v[156:159]
    ds_read_b64_tr_b16 v[96:97], v6 offset:8192
    ds_read_b64_tr_b16 v[98:99], v6 offset:9216
    v_mfma_f32_16x16x32_bf16 v[160:163], v[48:51], v[64:67], v[160:163]
    ds_read_b64_tr_b16 v[100:101], v7 offset:8192
    v_mfma_f32_16x16x32_bf16 v[168:171], v[48:51], v[68:71], v[168:171]
    ds_read_b64_tr_b16 v[102:103], v7 offset:9216
    s_add_u32 m0, s77, 35840
    s_add_u32 s64, s80, 25088
    buffer_load_dwordx4 v23, s[36:39], s64 offen lds
    v_mfma_f32_16x16x32_bf16 v[164:167], v[52:55], v[64:67], v[164:167]
    ds_read_b64_tr_b16 v[104:105], v8 offset:8192
    ds_read_b64_tr_b16 v[106:107], v8 offset:9216
    v_mfma_f32_16x16x32_bf16 v[172:175], v[52:55], v[68:71], v[172:175]
    ds_read_b64_tr_b16 v[108:109], v9 offset:8192
    v_mfma_f32_16x16x32_bf16 v[176:179], v[56:59], v[64:67], v[176:179]
    ds_read_b64_tr_b16 v[110:111], v9 offset:9216
    s_add_u32 m0, s61, 65536
    s_add_u32 s64, s82, 2097152
    buffer_load_dwordx4 v11, s[40:43], s64 offen lds
    v_mfma_f32_16x16x32_bf16 v[184:187], v[56:59], v[68:71], v[184:187]
    v_mfma_f32_16x16x32_bf16 v[180:183], v[60:63], v[64:67], v[180:183]
    s_add_u32 m0, s61, 69632
    s_add_u32 s64, s82, 2228224
    buffer_load_dwordx4 v11, s[40:43], s64 offen lds
    v_mfma_f32_16x16x32_bf16 v[188:191], v[60:63], v[68:71], v[188:191]
    s_cmp_lt_u32 s5, 2
    s_cbranch_scc0 cov_73
    s_waitcnt vmcnt(31)
cov_73:
    s_waitcnt vmcnt(6) lgkmcnt(0)
    s_barrier
    v_mfma_f32_16x16x32_bf16 v[128:131], v[80:83], v[112:115], v[128:131]
    v_xor_b32 v21, 0, v1
    ds_read_b128 v[64:67], v21
    ds_read_b128 v[68:71], v21 offset:2048
    v_mfma_f32_16x16x32_bf16 v[136:139], v[80:83], v[116:119], v[136:139]
    ds_read_b64_tr_b16 v[32:33], v2 offset:16384
    s_add_u32 m0, s77, 49152
    s_add_u32 s64, s81, 512
    buffer_load_dwordx4 v10, s[36:39], s64 offen lds
    v_mfma_f32_16x16x32_bf16 v[132:135], v[84:87], v[112:115], v[132:135]
    ds_read_b64_tr_b16 v[34:35], v2 offset:17408
    ds_read_b64_tr_b16 v[36:37], v3 offset:16384
    v_mfma_f32_16x16x32_bf16 v[140:143], v[84:87], v[116:119], v[140:143]
    ds_read_b64_tr_b16 v[38:39], v3 offset:17408
    v_mfma_f32_16x16x32_bf16 v[144:147], v[88:91], v[112:115], v[144:147]
    ds_read_b64_tr_b16 v[40:41], v4 offset:16384
    s_add_u32 m0, s77, 50176
    s_add_u32 s64, s81, 8704
    buffer_load_dwordx4 v23, s[36:39], s64 offen lds
    v_mfma_f32_16x16x32_bf16 v[152:155], v[88:91], v[116:119], v[152:155]
    ds_read_b64_tr_b16 v[42:43], v4 offset:17408
    ds_read_b64_tr_b16 v[44:45], v5 offset:16384
    v_mfma_f32_16x16x32_bf16 v[148:151], v[92:95], v[112:115], v[148:151]
    ds_read_b64_tr_b16 v[46:47], v5 offset:17408
    s_add_u32 m0, s77, 51200
    s_add_u32 s64, s81, 16896
    buffer_load_dwordx4 v10, s[36:39], s64 offen lds
    v_mfma_f32_16x16x32_bf16 v[156:159], v[92:95], v[116:119], v[156:159]
    ds_read_b64_tr_b16 v[48:49], v6 offset:16384
    ds_read_b64_tr_b16 v[50:51], v6 offset:17408
    v_mfma_f32_16x16x32_bf16 v[160:163], v[96:99], v[112:115], v[160:163]
    ds_read_b64_tr_b16 v[52:53], v7 offset:16384
    v_mfma_f32_16x16x32_bf16 v[168:171], v[96:99], v[116:119], v[168:171]
    ds_read_b64_tr_b16 v[54:55], v7 offset:17408
    s_add_u32 m0, s77, 52224
    s_add_u32 s64, s81, 25088
    buffer_load_dwordx4 v23, s[36:39], s64 offen lds
    v_mfma_f32_16x16x32_bf16 v[164:167], v[100:103], v[112:115], v[164:167]
    ds_read_b64_tr_b16 v[56:57], v8 offset:16384
    ds_read_b64_tr_b16 v[58:59], v8 offset:17408
    v_mfma_f32_16x16x32_bf16 v[172:175], v[100:103], v[116:119], v[172:175]
    ds_read_b64_tr_b16 v[60:61], v9 offset:16384
    v_mfma_f32_16x16x32_bf16 v[176:179], v[104:107], v[112:115], v[176:179]
    ds_read_b64_tr_b16 v[62:63], v9 offset:17408
    s_add_u32 m0, s61, 73728
    s_add_u32 s64, s82, 2359296
    buffer_load_dwordx4 v11, s[40:43], s64 offen lds
    v_mfma_f32_16x16x32_bf16 v[184:187], v[104:107], v[116:119], v[184:187]
    v_mfma_f32_16x16x32_bf16 v[180:183], v[108:111], v[112:115], v[180:183]
    s_add_u32 m0, s61, 77824
    s_add_u32 s64, s82, 2490368
    buffer_load_dwordx4 v11, s[40:43], s64 offen lds
    v_mfma_f32_16x16x32_bf16 v[188:191], v[108:111], v[116:119], v[188:191]
    s_waitcnt vmcnt(12) lgkmcnt(0)
    s_barrier
    v_mfma_f32_16x16x32_bf16 v[128:131], v[32:35], v[64:67], v[128:131]
    v_xor_b32 v21, 64, v1
    ds_read_b128 v[112:115], v21
    ds_read_b128 v[116:119], v21 offset:2048
    v_mfma_f32_16x16x32_bf16 v[136:139], v[32:35], v[68:71], v[136:139]
    ds_read_b64_tr_b16 v[80:81], v2 offset:24576
    s_add_u32 m0, s77, 98304
    s_add_u32 s64, s80, 640
    buffer_load_dwordx4 v10, s[36:39], s64 offen lds
    v_mfma_f32_16x16x32_bf16 v[132:135], v[36:39], v[64:67], v[132:135]
    ds_read_b64_tr_b16 v[82:83], v2 offset:25600
    ds_read_b64_tr_b16 v[84:85], v3 offset:24576
    v_mfma_f32_16x16x32_bf16 v[140:143], v[36:39], v[68:71], v[140:143]
    ds_read_b64_tr_b16 v[86:87], v3 offset:25600
    v_mfma_f32_16x16x32_bf16 v[144:147], v[40:43], v[64:67], v[144:147]
    ds_read_b64_tr_b16 v[88:89], v4 offset:24576
    s_add_u32 m0, s77, 99328
    s_add_u32 s64, s80, 8832
    buffer_load_dwordx4 v23, s[36:39], s64 offen lds
    v_mfma_f32_16x16x32_bf16 v[152:155], v[40:43], v[68:71], v[152:155]
    ds_read_b64_tr_b16 v[90:91], v4 offset:25600
    ds_read_b64_tr_b16 v[92:93], v5 offset:24576
    v_mfma_f32_16x16x32_bf16 v[148:151], v[44:47], v[64:67], v[148:151]
    ds_read_b64_tr_b16 v[94:95], v5 offset:25600
    s_add_u32 m0, s77, 100352
    s_add_u32 s64, s80, 17024
    buffer_load_dwordx4 v10, s[36:39], s64 offen lds
    v_mfma_f32_16x16x32_bf16 v[156:159], v[44:47], v[68:71], v[156:159]
    ds_read_b64_tr_b16 v[96:97], v6 offset:24576
    ds_read_b64_tr_b16 v[98:99], v6 offset:25600
    v_mfma_f32_16x16x32_bf16 v[160:163], v[48:51], v[64:67], v[160:163]
    ds_read_b64_tr_b16 v[100:101], v7 offset:24576
    v_mfma_f32_16x16x32_bf16 v[168:171], v[48:51], v[68:71], v[168:171]
    ds_read_b64_tr_b16 v[102:103], v7 offset:25600
    s_add_u32 m0, s77, 101376
    s_add_u32 s64, s80, 25216
    buffer_load_dwordx4 v23, s[36:39], s64 offen lds
    v_mfma_f32_16x16x32_bf16 v[164:167], v[52:55], v[64:67], v[164:167]
    ds_read_b64_tr_b16 v[104:105], v8 offset:24576
    ds_read_b64_tr_b16 v[106:107], v8 offset:25600
    v_mfma_f32_16x16x32_bf16 v[172:175], v[52:55], v[68:71], v[172:175]
    ds_read_b64_tr_b16 v[108:109], v9 offset:24576
    v_mfma_f32_16x16x32_bf16 v[176:179], v[56:59], v[64:67], v[176:179]
    ds_read_b64_tr_b16 v[110:111], v9 offset:25600
    s_add_u32 m0, s61, 81920
    s_add_u32 s64, s82, 2621440
    buffer_load_dwordx4 v11, s[40:43], s64 offen lds
    v_mfma_f32_16x16x32_bf16 v[184:187], v[56:59], v[68:71], v[184:187]
    v_mfma_f32_16x16x32_bf16 v[180:183], v[60:63], v[64:67], v[180:183]
    s_add_u32 m0, s61, 86016
    s_add_u32 s64, s82, 2752512
    buffer_load_dwordx4 v11, s[40:43], s64 offen lds
    v_mfma_f32_16x16x32_bf16 v[188:191], v[60:63], v[68:71], v[188:191]
    s_waitcnt vmcnt(6) lgkmcnt(0)
    s_barrier
    v_mfma_f32_16x16x32_bf16 v[128:131], v[80:83], v[112:115], v[128:131]
    v_xor_b32 v21, 32768, v1
    ds_read_b128 v[64:67], v21
    ds_read_b128 v[68:71], v21 offset:2048
    v_mfma_f32_16x16x32_bf16 v[136:139], v[80:83], v[116:119], v[136:139]
    ds_read_b64_tr_b16 v[32:33], v2 offset:0
    s_add_u32 m0, s77, 114688
    s_add_u32 s64, s81, 640
    buffer_load_dwordx4 v10, s[36:39], s64 offen lds
    v_mfma_f32_16x16x32_bf16 v[132:135], v[84:87], v[112:115], v[132:135]
    ds_read_b64_tr_b16 v[34:35], v2 offset:1024
    ds_read_b64_tr_b16 v[36:37], v3 offset:0
    v_mfma_f32_16x16x32_bf16 v[140:143], v[84:87], v[116:119], v[140:143]
    ds_read_b64_tr_b16 v[38:39], v3 offset:1024
    v_mfma_f32_16x16x32_bf16 v[144:147], v[88:91], v[112:115], v[144:147]
    ds_read_b64_tr_b16 v[40:41], v4 offset:0
    s_add_u32 m0, s77, 115712
    s_add_u32 s64, s81, 8832
    buffer_load_dwordx4 v23, s[36:39], s64 offen lds
    v_mfma_f32_16x16x32_bf16 v[152:155], v[88:91], v[116:119], v[152:155]
    ds_read_b64_tr_b16 v[42:43], v4 offset:1024
    ds_read_b64_tr_b16 v[44:45], v5 offset:0
    v_mfma_f32_16x16x32_bf16 v[148:151], v[92:95], v[112:115], v[148:151]
    ds_read_b64_tr_b16 v[46:47], v5 offset:1024
    s_add_u32 m0, s77, 116736
    s_add_u32 s64, s81, 17024
    buffer_load_dwordx4 v10, s[36:39], s64 offen lds
    v_mfma_f32_16x16x32_bf16 v[156:159], v[92:95], v[116:119], v[156:159]
    ds_read_b64_tr_b16 v[48:49], v6 offset:0
    ds_read_b64_tr_b16 v[50:51], v6 offset:1024
    v_mfma_f32_16x16x32_bf16 v[160:163], v[96:99], v[112:115], v[160:163]
    ds_read_b64_tr_b16 v[52:53], v7 offset:0
    v_mfma_f32_16x16x32_bf16 v[168:171], v[96:99], v[116:119], v[168:171]
    ds_read_b64_tr_b16 v[54:55], v7 offset:1024
    s_add_u32 m0, s77, 117760
    s_add_u32 s64, s81, 25216
    buffer_load_dwordx4 v23, s[36:39], s64 offen lds
    v_mfma_f32_16x16x32_bf16 v[164:167], v[100:103], v[112:115], v[164:167]
    ds_read_b64_tr_b16 v[56:57], v8 offset:0
    ds_read_b64_tr_b16 v[58:59], v8 offset:1024
    v_mfma_f32_16x16x32_bf16 v[172:175], v[100:103], v[116:119], v[172:175]
    ds_read_b64_tr_b16 v[60:61], v9 offset:0
    v_mfma_f32_16x16x32_bf16 v[176:179], v[104:107], v[112:115], v[176:179]
    ds_read_b64_tr_b16 v[62:63], v9 offset:1024
    s_add_u32 m0, s61, 90112
    s_add_u32 s64, s82, 2883584
    buffer_load_dwordx4 v11, s[40:43], s64 offen lds
    v_mfma_f32_16x16x32_bf16 v[184:187], v[104:107], v[116:119], v[184:187]
    v_mfma_f32_16x16x32_bf16 v[180:183], v[108:111], v[112:115], v[180:183]
    s_add_u32 m0, s61, 94208
    s_add_u32 s64, s82, 3014656
    buffer_load_dwordx4 v11, s[40:43], s64 offen lds
    v_mfma_f32_16x16x32_bf16 v[188:191], v[108:111], v[116:119], v[188:191]
    s_waitcnt vmcnt(12) lgkmcnt(0)
    s_barrier
    v_mfma_f32_16x16x32_bf16 v[128:131], v[32:35], v[64:67], v[128:131]
    v_xor_b32 v21, 32832, v1
    ds_read_b128 v[112:115], v21
    ds_read_b128 v[116:119], v21 offset:2048
    v_mfma_f32_16x16x32_bf16 v[136:139], v[32:35], v[68:71], v[136:139]
    ds_read_b64_tr_b16 v[80:81], v2 offset:8192
    s_add_u32 m0, s77, 0
    s_add_u32 s64, s80, 768
    buffer_load_dwordx4 v10, s[36:39], s64 offen lds
    v_mfma_f32_16x16x32_bf16 v[132:135], v[36:39], v[64:67], v[132:135]
    ds_read_b64_tr_b16 v[82:83], v2 offset:9216
    ds_read_b64_tr_b16 v[84:85], v3 offset:8192
    v_mfma_f32_16x16x32_bf16 v[140:143], v[36:39], v[68:71], v[140:143]
    ds_read_b64_tr_b16 v[86:87], v3 offset:9216
    v_mfma_f32_16x16x32_bf16 v[144:147], v[40:43], v[64:67], v[144:147]
    ds_read_b64_tr_b16 v[88:89], v4 offset:8192
    s_add_u32 m0, s77, 1024
    s_add_u32 s64, s80, 8960
    buffer_load_dwordx4 v23, s[36:39], s64 offen lds
    v_mfma_f32_16x16x32_bf16 v[152:155], v[40:43], v[68:71], v[152:155]
    ds_read_b64_tr_b16 v[90:91], v4 offset:9216
    ds_read_b64_tr_b16 v[92:93], v5 offset:8192
    v_mfma_f32_16x16x32_bf16 v[148:151], v[44:47], v[64:67], v[148:151]
    ds_read_b64_tr_b16 v[94:95], v5 offset:9216
    s_add_u32 m0, s77, 2048
    s_add_u32 s64, s80, 17152
    buffer_load_dwordx4 v10, s[36:39], s64 offen lds
    v_mfma_f32_16x16x32_bf16 v[156:159], v[44:47], v[68:71], v[156:159]
    ds_read_b64_tr_b16 v[96:97], v6 offset:8192
    ds_read_b64_tr_b16 v[98:99], v6 offset:9216
    v_mfma_f32_16x16x32_bf16 v[160:163], v[48:51], v[64:67], v[160:163]
    ds_read_b64_tr_b16 v[100:101], v7 offset:8192
    v_mfma_f32_16x16x32_bf16 v[168:171], v[48:51], v[68:71], v[168:171]
    ds_read_b64_tr_b16 v[102:103], v7 offset:9216
    s_add_u32 m0, s77, 3072
    s_add_u32 s64, s80, 25344
    buffer_load_dwordx4 v23, s[36:39], s64 offen lds
    v_mfma_f32_16x16x32_bf16 v[164:167], v[52:55], v[64:67], v[164:167]
    ds_read_b64_tr_b16 v[104:105], v8 offset:8192
    ds_read_b64_tr_b16 v[106:107], v8 offset:9216
    v_mfma_f32_16x16x32_bf16 v[172:175], v[52:55], v[68:71], v[172:175]
    ds_read_b64_tr_b16 v[108:109], v9 offset:8192
    v_mfma_f32_16x16x32_bf16 v[176:179], v[56:59], v[64:67], v[176:179]
    ds_read_b64_tr_b16 v[110:111], v9 offset:9216
    s_add_u32 m0, s61, 65536
    s_add_u32 s64, s82, 3145728
    buffer_load_dwordx4 v11, s[40:43], s64 offen lds
    v_mfma_f32_16x16x32_bf16 v[184:187], v[56:59], v[68:71], v[184:187]
    v_mfma_f32_16x16x32_bf16 v[180:183], v[60:63], v[64:67], v[180:183]
    s_add_u32 m0, s61, 69632
    s_add_u32 s64, s82, 3276800
    buffer_load_dwordx4 v11, s[40:43], s64 offen lds
    v_mfma_f32_16x16x32_bf16 v[188:191], v[60:63], v[68:71], v[188:191]
    s_waitcnt vmcnt(6) lgkmcnt(0)
    s_barrier
    v_mfma_f32_16x16x32_bf16 v[128:131], v[80:83], v[112:115], v[128:131]
    v_xor_b32 v21, 98304, v1
    ds_read_b128 v[64:67], v21
    ds_read_b128 v[68:71], v21 offset:2048
    v_mfma_f32_16x16x32_bf16 v[136:139], v[80:83], v[116:119], v[136:139]
    ds_read_b64_tr_b16 v[32:33], v2 offset:16384
    s_add_u32 m0, s77, 16384
    s_add_u32 s64, s81, 768
    buffer_load_dwordx4 v10, s[36:39], s64 offen lds
    v_mfma_f32_16x16x32_bf16 v[132:135], v[84:87], v[112:115], v[132:135]
    ds_read_b64_tr_b16 v[34:35], v2 offset:17408
    ds_read_b64_tr_b16 v[36:37], v3 offset:16384
    v_mfma_f32_16x16x32_bf16 v[140:143], v[84:87], v[116:119], v[140:143]
    ds_read_b64_tr_b16 v[38:39], v3 offset:17408
    v_mfma_f32_16x16x32_bf16 v[144:147], v[88:91], v[112:115], v[144:147]
    ds_read_b64_tr_b16 v[40:41], v4 offset:16384
    s_add_u32 m0, s77, 17408
    s_add_u32 s64, s81, 8960
    buffer_load_dwordx4 v23, s[36:39], s64 offen lds
    v_mfma_f32_16x16x32_bf16 v[152:155], v[88:91], v[116:119], v[152:155]
    ds_read_b64_tr_b16 v[42:43], v4 offset:17408
    ds_read_b64_tr_b16 v[44:45], v5 offset:16384
    v_mfma_f32_16x16x32_bf16 v[148:151], v[92:95], v[112:115], v[148:151]
    ds_read_b64_tr_b16 v[46:47], v5 offset:17408
    s_add_u32 m0, s77, 18432
    s_add_u32 s64, s81, 17152
    buffer_load_dwordx4 v10, s[36:39], s64 offen lds
    v_mfma_f32_16x16x32_bf16 v[156:159], v[92:95], v[116:119], v[156:159]
    ds_read_b64_tr_b16 v[48:49], v6 offset:16384
    ds_read_b64_tr_b16 v[50:51], v6 offset:17408
    v_mfma_f32_16x16x32_bf16 v[160:163], v[96:99], v[112:115], v[160:163]
    ds_read_b64_tr_b16 v[52:53], v7 offset:16384
    v_mfma_f32_16x16x32_bf16 v[168:171], v[96:99], v[116:119], v[168:171]
    ds_read_b64_tr_b16 v[54:55], v7 offset:17408
    s_add_u32 m0, s77, 19456
    s_add_u32 s64, s81, 25344
    buffer_load_dwordx4 v23, s[36:39], s64 offen lds
    v_mfma_f32_16x16x32_bf16 v[164:167], v[100:103], v[112:115], v[164:167]
    ds_read_b64_tr_b16 v[56:57], v8 offset:16384
    ds_read_b64_tr_b16 v[58:59], v8 offset:17408
    v_mfma_f32_16x16x32_bf16 v[172:175], v[100:103], v[116:119], v[172:175]
    ds_read_b64_tr_b16 v[60:61], v9 offset:16384
    v_mfma_f32_16x16x32_bf16 v[176:179], v[104:107], v[112:115], v[176:179]
    ds_read_b64_tr_b16 v[62:63], v9 offset:17408
    s_add_u32 m0, s61, 73728
    s_add_u32 s64, s82, 3407872
    buffer_load_dwordx4 v11, s[40:43], s64 offen lds
    v_mfma_f32_16x16x32_bf16 v[184:187], v[104:107], v[116:119], v[184:187]
    v_mfma_f32_16x16x32_bf16 v[180:183], v[108:111], v[112:115], v[180:183]
    s_add_u32 m0, s61, 77824
    s_add_u32 s64, s82, 3538944
    buffer_load_dwordx4 v11, s[40:43], s64 offen lds
    v_mfma_f32_16x16x32_bf16 v[188:191], v[108:111], v[116:119], v[188:191]
    s_waitcnt vmcnt(12) lgkmcnt(0)
    s_barrier
    v_mfma_f32_16x16x32_bf16 v[128:131], v[32:35], v[64:67], v[128:131]
    v_xor_b32 v21, 98368, v1
    ds_read_b128 v[112:115], v21
    ds_read_b128 v[116:119], v21 offset:2048
    v_mfma_f32_16x16x32_bf16 v[136:139], v[32:35], v[68:71], v[136:139]
    ds_read_b64_tr_b16 v[80:81], v2 offset:24576
    s_add_u32 m0, s77, 32768
    s_add_u32 s64, s80, 896
    buffer_load_dwordx4 v10, s[36:39], s64 offen lds
    v_mfma_f32_16x16x32_bf16 v[132:135], v[36:39], v[64:67], v[132:135]
    ds_read_b64_tr_b16 v[82:83], v2 offset:25600
    ds_read_b64_tr_b16 v[84:85], v3 offset:24576
    v_mfma_f32_16x16x32_bf16 v[140:143], v[36:39], v[68:71], v[140:143]
    ds_read_b64_tr_b16 v[86:87], v3 offset:25600
    v_mfma_f32_16x16x32_bf16 v[144:147], v[40:43], v[64:67], v[144:147]
    ds_read_b64_tr_b16 v[88:89], v4 offset:24576
    s_add_u32 m0, s77, 33792
    s_add_u32 s64, s80, 9088
    buffer_load_dwordx4 v23, s[36:39], s64 offen lds
    v_mfma_f32_16x16x32_bf16 v[152:155], v[40:43], v[68:71], v[152:155]
    ds_read_b64_tr_b16 v[90:91], v4 offset:25600
    ds_read_b64_tr_b16 v[92:93], v5 offset:24576
    v_mfma_f32_16x16x32_bf16 v[148:151], v[44:47], v[64:67], v[148:151]
    ds_read_b64_tr_b16 v[94:95], v5 offset:25600
    s_add_u32 m0, s77, 34816
    s_add_u32 s64, s80, 17280
    buffer_load_dwordx4 v10, s[36:39], s64 offen lds
    v_mfma_f32_16x16x32_bf16 v[156:159], v[44:47], v[68:71], v[156:159]
    ds_read_b64_tr_b16 v[96:97], v6 offset:24576
    ds_read_b64_tr_b16 v[98:99], v6 offset:25600
    v_mfma_f32_16x16x32_bf16 v[160:163], v[48:51], v[64:67], v[160:163]
    ds_read_b64_tr_b16 v[100:101], v7 offset:24576
    v_mfma_f32_16x16x32_bf16 v[168:171], v[48:51], v[68:71], v[168:171]
    ds_read_b64_tr_b16 v[102:103], v7 offset:25600
    s_add_u32 m0, s77, 35840
    s_add_u32 s64, s80, 25472
    buffer_load_dwordx4 v23, s[36:39], s64 offen lds
    v_mfma_f32_16x16x32_bf16 v[164:167], v[52:55], v[64:67], v[164:167]
    ds_read_b64_tr_b16 v[104:105], v8 offset:24576
    ds_read_b64_tr_b16 v[106:107], v8 offset:25600
    v_mfma_f32_16x16x32_bf16 v[172:175], v[52:55], v[68:71], v[172:175]
    ds_read_b64_tr_b16 v[108:109], v9 offset:24576
    v_mfma_f32_16x16x32_bf16 v[176:179], v[56:59], v[64:67], v[176:179]
    ds_read_b64_tr_b16 v[110:111], v9 offset:25600
    s_add_u32 m0, s61, 81920
    s_add_u32 s64, s82, 3670016
    buffer_load_dwordx4 v11, s[40:43], s64 offen lds
    v_mfma_f32_16x16x32_bf16 v[184:187], v[56:59], v[68:71], v[184:187]
    v_mfma_f32_16x16x32_bf16 v[180:183], v[60:63], v[64:67], v[180:183]
    s_add_u32 m0, s61, 86016
    s_add_u32 s64, s82, 3801088
    buffer_load_dwordx4 v11, s[40:43], s64 offen lds
    v_mfma_f32_16x16x32_bf16 v[188:191], v[60:63], v[68:71], v[188:191]
    s_waitcnt vmcnt(6) lgkmcnt(0)
    s_barrier
    v_mfma_f32_16x16x32_bf16 v[128:131], v[80:83], v[112:115], v[128:131]
    v_xor_b32 v21, 0, v1
    ds_read_b128 v[64:67], v21
    ds_read_b128 v[68:71], v21 offset:2048
    v_mfma_f32_16x16x32_bf16 v[136:139], v[80:83], v[116:119], v[136:139]
    ds_read_b64_tr_b16 v[32:33], v2 offset:0
    s_add_u32 m0, s77, 49152
    s_add_u32 s64, s81, 896
    buffer_load_dwordx4 v10, s[36:39], s64 offen lds
    v_mfma_f32_16x16x32_bf16 v[132:135], v[84:87], v[112:115], v[132:135]
    ds_read_b64_tr_b16 v[34:35], v2 offset:1024
    ds_read_b64_tr_b16 v[36:37], v3 offset:0
    v_mfma_f32_16x16x32_bf16 v[140:143], v[84:87], v[116:119], v[140:143]
    ds_read_b64_tr_b16 v[38:39], v3 offset:1024
    v_mfma_f32_16x16x32_bf16 v[144:147], v[88:91], v[112:115], v[144:147]
    ds_read_b64_tr_b16 v[40:41], v4 offset:0
    s_add_u32 m0, s77, 50176
    s_add_u32 s64, s81, 9088
    buffer_load_dwordx4 v23, s[36:39], s64 offen lds
    v_mfma_f32_16x16x32_bf16 v[152:155], v[88:91], v[116:119], v[152:155]
    ds_read_b64_tr_b16 v[42:43], v4 offset:1024
    ds_read_b64_tr_b16 v[44:45], v5 offset:0
    v_mfma_f32_16x16x32_bf16 v[148:151], v[92:95], v[112:115], v[148:151]
    ds_read_b64_tr_b16 v[46:47], v5 offset:1024
    s_add_u32 m0, s77, 51200
    s_add_u32 s64, s81, 17280
    buffer_load_dwordx4 v10, s[36:39], s64 offen lds
    v_mfma_f32_16x16x32_bf16 v[156:159], v[92:95], v[116:119], v[156:159]
    ds_read_b64_tr_b16 v[48:49], v6 offset:0
    ds_read_b64_tr_b16 v[50:51], v6 offset:1024
    v_mfma_f32_16x16x32_bf16 v[160:163], v[96:99], v[112:115], v[160:163]
    ds_read_b64_tr_b16 v[52:53], v7 offset:0
    v_mfma_f32_16x16x32_bf16 v[168:171], v[96:99], v[116:119], v[168:171]
    ds_read_b64_tr_b16 v[54:55], v7 offset:1024
    s_add_u32 m0, s77, 52224
    s_add_u32 s64, s81, 25472
    buffer_load_dwordx4 v23, s[36:39], s64 offen lds
    v_mfma_f32_16x16x32_bf16 v[164:167], v[100:103], v[112:115], v[164:167]
    ds_read_b64_tr_b16 v[56:57], v8 offset:0
    ds_read_b64_tr_b16 v[58:59], v8 offset:1024
    v_mfma_f32_16x16x32_bf16 v[172:175], v[100:103], v[116:119], v[172:175]
    ds_read_b64_tr_b16 v[60:61], v9 offset:0
    v_mfma_f32_16x16x32_bf16 v[176:179], v[104:107], v[112:115], v[176:179]
    ds_read_b64_tr_b16 v[62:63], v9 offset:1024
    s_add_u32 m0, s61, 90112
    s_add_u32 s64, s82, 3932160
    buffer_load_dwordx4 v11, s[40:43], s64 offen lds
    v_mfma_f32_16x16x32_bf16 v[184:187], v[104:107], v[116:119], v[184:187]
    v_mfma_f32_16x16x32_bf16 v[180:183], v[108:111], v[112:115], v[180:183]
    s_add_u32 m0, s61, 94208
    s_add_u32 s64, s82, 4063232
    buffer_load_dwordx4 v11, s[40:43], s64 offen lds
    v_mfma_f32_16x16x32_bf16 v[188:191], v[108:111], v[116:119], v[188:191]
    s_waitcnt vmcnt(12) lgkmcnt(0)
    s_barrier
    v_mfma_f32_16x16x32_bf16 v[128:131], v[32:35], v[64:67], v[128:131]
    v_xor_b32 v21, 64, v1
    ds_read_b128 v[112:115], v21
    ds_read_b128 v[116:119], v21 offset:2048
    s_mov_b32 s24, 0xf0000
    s_mov_b32 s25, 0xfff00ff
    v_mfma_f32_16x16x32_bf16 v[136:139], v[32:35], v[68:71], v[136:139]
    ds_read_b64_tr_b16 v[80:81], v2 offset:8192
    s_mov_b32 s26, 0x1f0001
    s_mov_b32 s27, 0x1fff01ff
    v_mfma_f32_16x16x32_bf16 v[132:135], v[36:39], v[64:67], v[132:135]
    ds_read_b64_tr_b16 v[82:83], v2 offset:9216
    ds_read_b64_tr_b16 v[84:85], v3 offset:8192
    s_mov_b32 s28, 0x3f0003
    s_mov_b32 s29, 0x3fff03ff
    v_mfma_f32_16x16x32_bf16 v[140:143], v[36:39], v[68:71], v[140:143]
    ds_read_b64_tr_b16 v[86:87], v3 offset:9216
    s_mov_b32 s30, 0x7f0007
    s_mov_b32 s31, 0x7fff07ff
    v_mfma_f32_16x16x32_bf16 v[144:147], v[40:43], v[64:67], v[144:147]
    ds_read_b64_tr_b16 v[88:89], v4 offset:8192
    s_mov_b32 s32, 0xffffffff
    s_mov_b32 s33, 0xffffffff
    s_mov_b32 s34, 0xffffffff
    s_mov_b32 s35, 0xffffffff
    v_mfma_f32_16x16x32_bf16 v[152:155], v[40:43], v[68:71], v[152:155]
    ds_read_b64_tr_b16 v[90:91], v4 offset:9216
    ds_read_b64_tr_b16 v[92:93], v5 offset:8192
    s_mov_b32 s36, 0xffffffff
    s_mov_b32 s37, 0xffffffff
    v_mfma_f32_16x16x32_bf16 v[148:151], v[44:47], v[64:67], v[148:151]
    ds_read_b64_tr_b16 v[94:95], v5 offset:9216
    s_mov_b32 s38, 0xffffffff
    s_mov_b32 s39, 0xffffffff
    v_mfma_f32_16x16x32_bf16 v[156:159], v[44:47], v[68:71], v[156:159]
    ds_read_b64_tr_b16 v[96:97], v6 offset:8192
    ds_read_b64_tr_b16 v[98:99], v6 offset:9216
    s_cmp_lt_u32 s75, s76
    s_cselect_b32 s84, s73, 1073741824
    s_mov_b32 s85, 1073741824
    s_mov_b32 m0, s91
    s_add_u32 s73, s73, 16384
    v_mfma_f32_16x16x32_bf16 v[160:163], v[48:51], v[64:67], v[160:163]
    ds_read_b64_tr_b16 v[100:101], v7 offset:8192
    buffer_load_dwordx4 v15, s[8:11], s84 offen offset:0 sc1 lds
    v_mfma_f32_16x16x32_bf16 v[168:171], v[48:51], v[68:71], v[168:171]
    ds_read_b64_tr_b16 v[102:103], v7 offset:9216
    buffer_load_dwordx4 v15, s[8:11], s84 offen offset:1024 sc1 lds
    v_mfma_f32_16x16x32_bf16 v[164:167], v[52:55], v[64:67], v[164:167]
    ds_read_b64_tr_b16 v[104:105], v8 offset:8192
    ds_read_b64_tr_b16 v[106:107], v8 offset:9216
    buffer_load_dwordx4 v15, s[8:11], s84 offen offset:2048 sc1 lds
    v_mfma_f32_16x16x32_bf16 v[172:175], v[52:55], v[68:71], v[172:175]
    ds_read_b64_tr_b16 v[108:109], v9 offset:8192
    buffer_load_dwordx4 v15, s[8:11], s84 offen offset:3072 sc1 lds
    v_mfma_f32_16x16x32_bf16 v[176:179], v[56:59], v[64:67], v[176:179]
    ds_read_b64_tr_b16 v[110:111], v9 offset:9216
    s_add_u32 m0, s91, 16384
    s_add_u32 s74, s74, 16384
    buffer_load_dwordx4 v15, s[8:11], s85 offen offset:0 sc1 lds
    buffer_load_dwordx4 v15, s[8:11], s85 offen offset:1024 sc1 lds
    v_mfma_f32_16x16x32_bf16 v[184:187], v[56:59], v[68:71], v[184:187]
    buffer_load_dwordx4 v15, s[8:11], s85 offen offset:2048 sc1 lds
    v_mfma_f32_16x16x32_bf16 v[180:183], v[60:63], v[64:67], v[180:183]
    buffer_load_dwordx4 v15, s[8:11], s85 offen offset:3072 sc1 lds
    v_mfma_f32_16x16x32_bf16 v[188:191], v[60:63], v[68:71], v[188:191]
    s_add_u32 s75, s75, 1
    s_add_u32 s91, s91, 32768
    s_cmp_ge_u32 s91, 163840
    s_cselect_b32 s91, s77, s91
    s_waitcnt vmcnt(8) lgkmcnt(0)
    s_barrier
    v_mfma_f32_16x16x32_bf16 v[128:131], v[80:83], v[112:115], v[128:131]
    v_xor_b32 v21, 32768, v1
    ds_read_b128 v[64:67], v21
    ds_read_b128 v[68:71], v21 offset:2048
    s_cmp_lt_u32 s75, s76
    s_cselect_b32 s84, s73, 1073741824
    s_mov_b32 s85, s74
    s_mov_b32 m0, s91
    s_add_u32 s73, s73, 16384
    v_mfma_f32_16x16x32_bf16 v[136:139], v[80:83], v[116:119], v[136:139]
    ds_read_b64_tr_b16 v[32:33], v2 offset:16384
    v_mfma_f32_16x16x32_bf16 v[132:135], v[84:87], v[112:115], v[132:135]
    ds_read_b64_tr_b16 v[34:35], v2 offset:17408
    ds_read_b64_tr_b16 v[36:37], v3 offset:16384
    buffer_load_dwordx4 v15, s[8:11], s84 offen offset:0 sc1 lds
    v_mfma_f32_16x16x32_bf16 v[140:143], v[84:87], v[116:119], v[140:143]
    ds_read_b64_tr_b16 v[38:39], v3 offset:17408
    v_mfma_f32_16x16x32_bf16 v[144:147], v[88:91], v[112:115], v[144:147]
    ds_read_b64_tr_b16 v[40:41], v4 offset:16384
    buffer_load_dwordx4 v15, s[8:11], s84 offen offset:1024 sc1 lds
    v_mfma_f32_16x16x32_bf16 v[152:155], v[88:91], v[116:119], v[152:155]
    ds_read_b64_tr_b16 v[42:43], v4 offset:17408
    ds_read_b64_tr_b16 v[44:45], v5 offset:16384
    buffer_load_dwordx4 v15, s[8:11], s84 offen offset:2048 sc1 lds
    v_mfma_f32_16x16x32_bf16 v[148:151], v[92:95], v[112:115], v[148:151]
    ds_read_b64_tr_b16 v[46:47], v5 offset:17408
    v_mfma_f32_16x16x32_bf16 v[156:159], v[92:95], v[116:119], v[156:159]
    ds_read_b64_tr_b16 v[48:49], v6 offset:16384
    ds_read_b64_tr_b16 v[50:51], v6 offset:17408
    buffer_load_dwordx4 v15, s[8:11], s84 offen offset:3072 sc1 lds
    v_mfma_f32_16x16x32_bf16 v[160:163], v[96:99], v[112:115], v[160:163]
    ds_read_b64_tr_b16 v[52:53], v7 offset:16384
    s_add_u32 m0, s91, 16384
    s_add_u32 s74, s74, 16384
    buffer_load_dwordx4 v15, s[8:11], s85 offen offset:0 sc1 lds
    v_mfma_f32_16x16x32_bf16 v[168:171], v[96:99], v[116:119], v[168:171]
    ds_read_b64_tr_b16 v[54:55], v7 offset:17408
    v_mfma_f32_16x16x32_bf16 v[164:167], v[100:103], v[112:115], v[164:167]
    ds_read_b64_tr_b16 v[56:57], v8 offset:16384
    ds_read_b64_tr_b16 v[58:59], v8 offset:17408
    buffer_load_dwordx4 v15, s[8:11], s85 offen offset:1024 sc1 lds
    v_mfma_f32_16x16x32_bf16 v[172:175], v[100:103], v[116:119], v[172:175]
    ds_read_b64_tr_b16 v[60:61], v9 offset:16384
    v_mfma_f32_16x16x32_bf16 v[176:179], v[104:107], v[112:115], v[176:179]
    ds_read_b64_tr_b16 v[62:63], v9 offset:17408
    buffer_load_dwordx4 v15, s[8:11], s85 offen offset:2048 sc1 lds
    v_mfma_f32_16x16x32_bf16 v[184:187], v[104:107], v[116:119], v[184:187]
    buffer_load_dwordx4 v15, s[8:11], s85 offen offset:3072 sc1 lds
    v_mfma_f32_16x16x32_bf16 v[180:183], v[108:111], v[112:115], v[180:183]
    v_mfma_f32_16x16x32_bf16 v[188:191], v[108:111], v[116:119], v[188:191]
    s_add_u32 s75, s75, 1
    s_add_u32 s91, s91, 32768
    s_cmp_ge_u32 s91, 163840
    s_cselect_b32 s91, s77, s91
    s_waitcnt vmcnt(16) lgkmcnt(0)
    s_barrier
    v_mfma_f32_16x16x32_bf16 v[128:131], v[32:35], v[64:67], v[128:131]
    v_xor_b32 v21, 32832, v1
    ds_read_b128 v[112:115], v21
    ds_read_b128 v[116:119], v21 offset:2048
    v_mfma_f32_16x16x32_bf16 v[136:139], v[32:35], v[68:71], v[136:139]
    ds_read_b64_tr_b16 v[80:81], v2 offset:24576
    s_mov_b32 s40, 0x0
    s_mov_b32 s41, 0x0
    v_mfma_f32_16x16x32_bf16 v[132:135], v[36:39], v[64:67], v[132:135]
    ds_read_b64_tr_b16 v[82:83], v2 offset:25600
    ds_read_b64_tr_b16 v[84:85], v3 offset:24576
    v_mfma_f32_16x16x32_bf16 v[140:143], v[36:39], v[68:71], v[140:143]
    ds_read_b64_tr_b16 v[86:87], v3 offset:25600
    s_mov_b32 s42, 0x0
    s_mov_b32 s43, 0x0
    v_mfma_f32_16x16x32_bf16 v[144:147], v[40:43], v[64:67], v[144:147]
    ds_read_b64_tr_b16 v[88:89], v4 offset:24576
    v_mfma_f32_16x16x32_bf16 v[152:155], v[40:43], v[68:71], v[152:155]
    ds_read_b64_tr_b16 v[90:91], v4 offset:25600
    ds_read_b64_tr_b16 v[92:93], v5 offset:24576
    s_mov_b32 s44, 0x0
    s_mov_b32 s45, 0x0
    v_mfma_f32_16x16x32_bf16 v[148:151], v[44:47], v[64:67], v[148:151]
    ds_read_b64_tr_b16 v[94:95], v5 offset:25600
    v_mfma_f32_16x16x32_bf16 v[156:159], v[44:47], v[68:71], v[156:159]
    ds_read_b64_tr_b16 v[96:97], v6 offset:24576
    ds_read_b64_tr_b16 v[98:99], v6 offset:25600
    s_mov_b32 s46, 0x0
    s_mov_b32 s47, 0x0
    v_mfma_f32_16x16x32_bf16 v[160:163], v[48:51], v[64:67], v[160:163]
    ds_read_b64_tr_b16 v[100:101], v7 offset:24576
    v_mfma_f32_16x16x32_bf16 v[168:171], v[48:51], v[68:71], v[168:171]
    ds_read_b64_tr_b16 v[102:103], v7 offset:25600
    s_mov_b32 s48, 0xf0000
    s_mov_b32 s49, 0xfff00ff
    v_mfma_f32_16x16x32_bf16 v[164:167], v[52:55], v[64:67], v[164:167]
    ds_read_b64_tr_b16 v[104:105], v8 offset:24576
    ds_read_b64_tr_b16 v[106:107], v8 offset:25600
    v_mfma_f32_16x16x32_bf16 v[172:175], v[52:55], v[68:71], v[172:175]
    ds_read_b64_tr_b16 v[108:109], v9 offset:24576
    s_mov_b32 s50, 0x1f0001
    s_mov_b32 s51, 0x1fff01ff
    v_mfma_f32_16x16x32_bf16 v[176:179], v[56:59], v[64:67], v[176:179]
    ds_read_b64_tr_b16 v[110:111], v9 offset:25600
    v_mfma_f32_16x16x32_bf16 v[184:187], v[56:59], v[68:71], v[184:187]
    s_mov_b32 s52, 0x3f0003
    s_mov_b32 s53, 0x3fff03ff
    v_mfma_f32_16x16x32_bf16 v[180:183], v[60:63], v[64:67], v[180:183]
    v_mfma_f32_16x16x32_bf16 v[188:191], v[60:63], v[68:71], v[188:191]
    s_mov_b32 s54, 0x7f0007
    s_mov_b32 s55, 0x7fff07ff
    s_waitcnt vmcnt(8) lgkmcnt(0)
    s_barrier
    v_mfma_f32_16x16x32_bf16 v[128:131], v[80:83], v[112:115], v[128:131]
    v_mov_b32 v64, 0
    v_mov_b32 v65, 0
    s_cmp_lt_u32 s75, s76
    s_cselect_b32 s84, s73, 1073741824
    s_mov_b32 s85, s74
    s_mov_b32 m0, s91
    s_add_u32 s73, s73, 16384
    v_mfma_f32_16x16x32_bf16 v[136:139], v[80:83], v[116:119], v[136:139]
    v_mov_b32 v66, 0
    v_mov_b32 v67, 0
    buffer_load_dwordx4 v15, s[8:11], s84 offen offset:0 sc1 lds
    v_mfma_f32_16x16x32_bf16 v[132:135], v[84:87], v[112:115], v[132:135]
    v_mov_b32 v68, 0
    v_mov_b32 v69, 0
    buffer_load_dwordx4 v15, s[8:11], s84 offen offset:1024 sc1 lds
    buffer_load_dwordx4 v15, s[8:11], s84 offen offset:2048 sc1 lds
    v_mfma_f32_16x16x32_bf16 v[140:143], v[84:87], v[116:119], v[140:143]
    v_mov_b32 v70, 0
    v_mov_b32 v71, 0
    buffer_load_dwordx4 v15, s[8:11], s84 offen offset:3072 sc1 lds
    v_mfma_f32_16x16x32_bf16 v[144:147], v[88:91], v[112:115], v[144:147]
    v_mov_b32 v72, 0
    v_mov_b32 v73, 0
    s_add_u32 m0, s91, 16384
    s_add_u32 s74, s74, 16384
    buffer_load_dwordx4 v15, s[8:11], s85 offen offset:0 sc1 lds
    v_mfma_f32_16x16x32_bf16 v[152:155], v[88:91], v[116:119], v[152:155]
    v_mov_b32 v74, 0
    v_mov_b32 v75, 0
    buffer_load_dwordx4 v15, s[8:11], s85 offen offset:1024 sc1 lds
    v_mfma_f32_16x16x32_bf16 v[148:151], v[92:95], v[112:115], v[148:151]
    v_mov_b32 v76, 0
    buffer_load_dwordx4 v15, s[8:11], s85 offen offset:2048 sc1 lds
    buffer_load_dwordx4 v15, s[8:11], s85 offen offset:3072 sc1 lds
    v_mfma_f32_16x16x32_bf16 v[156:159], v[92:95], v[116:119], v[156:159]
    v_mov_b32 v77, 0
    v_mov_b32 v78, 0
    s_add_u32 s75, s75, 1
    s_add_u32 s91, s91, 32768
    s_cmp_ge_u32 s91, 163840
    s_cselect_b32 s91, s77, s91
    v_mfma_f32_16x16x32_bf16 v[160:163], v[96:99], v[112:115], v[160:163]
    v_mov_b32 v79, 0
    v_mov_b32 v120, 0
    s_cmp_lt_u32 s75, s76
    s_cselect_b32 s84, s73, 1073741824
    s_mov_b32 s85, s74
    s_mov_b32 m0, s91
    s_add_u32 s73, s73, 16384
    v_mfma_f32_16x16x32_bf16 v[168:171], v[96:99], v[116:119], v[168:171]
    v_mov_b32 v121, 0
    v_mov_b32 v122, 0
    buffer_load_dwordx4 v15, s[8:11], s84 offen offset:0 sc1 lds
    v_mfma_f32_16x16x32_bf16 v[164:167], v[100:103], v[112:115], v[164:167]
    v_mov_b32 v123, 0
    v_mov_b32 v124, 0
    buffer_load_dwordx4 v15, s[8:11], s84 offen offset:1024 sc1 lds
    buffer_load_dwordx4 v15, s[8:11], s84 offen offset:2048 sc1 lds
    v_mfma_f32_16x16x32_bf16 v[172:175], v[100:103], v[116:119], v[172:175]
    v_mov_b32 v125, 0
    v_mov_b32 v126, 0
    buffer_load_dwordx4 v15, s[8:11], s84 offen offset:3072 sc1 lds
    v_mfma_f32_16x16x32_bf16 v[176:179], v[104:107], v[112:115], v[176:179]
    v_mov_b32 v127, 0
    s_add_u32 m0, s91, 16384
    s_add_u32 s74, s74, 16384
    buffer_load_dwordx4 v15, s[8:11], s85 offen offset:0 sc1 lds
    v_mfma_f32_16x16x32_bf16 v[184:187], v[104:107], v[116:119], v[184:187]
    buffer_load_dwordx4 v15, s[8:11], s85 offen offset:1024 sc1 lds
    v_mfma_f32_16x16x32_bf16 v[180:183], v[108:111], v[112:115], v[180:183]
    buffer_load_dwordx4 v15, s[8:11], s85 offen offset:2048 sc1 lds
    buffer_load_dwordx4 v15, s[8:11], s85 offen offset:3072 sc1 lds
    v_mfma_f32_16x16x32_bf16 v[188:191], v[108:111], v[116:119], v[188:191]
    s_add_u32 s75, s75, 1
    s_add_u32 s91, s91, 32768
    s_cmp_ge_u32 s91, 163840
    s_cselect_b32 s91, s77, s91
q_epi:
    s_mov_b32 s94, 8
    s_mov_b32 s95, 5
    s_max_u32 s78, s78, 12
    s_lshl_b32 s56, 5, s78
    s_or_b32 s56, s56, 616
    s_cmp_eq_u32 s3, 0
    s_cselect_b32 s63, s56, 0
    s_or_b32 s63, s63, 256
    s_sub_u32 s56, s76, 3
    s_lshl_b32 s56, -1, s56
    s_cmp_ge_u32 s3, 4
    s_cselect_b32 s63, s56, s63
    s_mov_b32 s92, 1040356334
    s_mov_b32 s93, s92
    v_add_u32 v3, 131072, v15
    ds_read_b128 v[192:195], v3 offset:0
    ds_read_b128 v[196:199], v3 offset:1024
    ds_read_b128 v[200:203], v3 offset:2048
    ds_read_b128 v[204:207], v3 offset:3072
    ds_read_b128 v[208:211], v3 offset:4096
    ds_read_b128 v[212:215], v3 offset:5120
    ds_read_b128 v[216:219], v3 offset:6144
    ds_read_b128 v[220:223], v3 offset:7168
    v_pk_mul_f32 v[128:129], v[128:129], s[92:93]
    v_pk_mul_f32 v[130:131], v[130:131], s[92:93]
    v_pk_mul_f32 v[132:133], v[132:133], s[92:93]
    v_pk_mul_f32 v[134:135], v[134:135], s[92:93]
    v_pk_mul_f32 v[136:137], v[136:137], s[92:93]
    v_pk_mul_f32 v[138:139], v[138:139], s[92:93]
    v_pk_mul_f32 v[140:141], v[140:141], s[92:93]
    v_pk_mul_f32 v[142:143], v[142:143], s[92:93]
    v_pk_mul_f32 v[144:145], v[144:145], s[92:93]
    v_pk_mul_f32 v[146:147], v[146:147], s[92:93]
    v_pk_mul_f32 v[148:149], v[148:149], s[92:93]
    v_pk_mul_f32 v[150:151], v[150:151], s[92:93]
    v_pk_mul_f32 v[152:153], v[152:153], s[92:93]
    v_pk_mul_f32 v[154:155], v[154:155], s[92:93]
    v_pk_mul_f32 v[156:157], v[156:157], s[92:93]
    v_pk_mul_f32 v[158:159], v[158:159], s[92:93]
    v_pk_mul_f32 v[160:161], v[160:161], s[92:93]
    v_pk_mul_f32 v[162:163], v[162:163], s[92:93]
    v_pk_mul_f32 v[164:165], v[164:165], s[92:93]
    v_pk_mul_f32 v[166:167], v[166:167], s[92:93]
    v_pk_mul_f32 v[168:169], v[168:169], s[92:93]
    v_pk_mul_f32 v[170:171], v[170:171], s[92:93]
    v_pk_mul_f32 v[172:173], v[172:173], s[92:93]
    v_pk_mul_f32 v[174:175], v[174:175], s[92:93]
    v_pk_mul_f32 v[176:177], v[176:177], s[92:93]
    v_pk_mul_f32 v[178:179], v[178:179], s[92:93]
    v_pk_mul_f32 v[180:181], v[180:181], s[92:93]
    v_pk_mul_f32 v[182:183], v[182:183], s[92:93]
    v_pk_mul_f32 v[184:185], v[184:185], s[92:93]
    v_pk_mul_f32 v[186:187], v[186:187], s[92:93]
    v_pk_mul_f32 v[188:189], v[188:189], s[92:93]
    v_pk_mul_f32 v[190:191], v[190:191], s[92:93]
    v_cvt_pk_bf16_f32 v32, v128, v129
    v_cvt_pk_bf16_f32 v33, v130, v131
    v_cvt_pk_bf16_f32 v34, v132, v133
    v_cvt_pk_bf16_f32 v35, v134, v135
    v_cvt_pk_bf16_f32 v36, v136, v137
    v_cvt_pk_bf16_f32 v37, v138, v139
    v_cvt_pk_bf16_f32 v38, v140, v141
    v_cvt_pk_bf16_f32 v39, v142, v143
    v_cvt_pk_bf16_f32 v40, v144, v145
    v_cvt_pk_bf16_f32 v41, v146, v147
    v_cvt_pk_bf16_f32 v42, v148, v149
    v_cvt_pk_bf16_f32 v43, v150, v151
    v_cvt_pk_bf16_f32 v44, v152, v153
    v_cvt_pk_bf16_f32 v45, v154, v155
    v_cvt_pk_bf16_f32 v46, v156, v157
    v_cvt_pk_bf16_f32 v47, v158, v159
    v_cvt_pk_bf16_f32 v48, v160, v161
    v_cvt_pk_bf16_f32 v49, v162, v163
    v_cvt_pk_bf16_f32 v50, v164, v165
    v_cvt_pk_bf16_f32 v51, v166, v167
    v_cvt_pk_bf16_f32 v52, v168, v169
    v_cvt_pk_bf16_f32 v53, v170, v171
    v_cvt_pk_bf16_f32 v54, v172, v173
    v_cvt_pk_bf16_f32 v55, v174, v175
    v_cvt_pk_bf16_f32 v56, v176, v177
    v_cvt_pk_bf16_f32 v57, v178, v179
    v_cvt_pk_bf16_f32 v58, v180, v181
    v_cvt_pk_bf16_f32 v59, v182, v183
    v_cvt_pk_bf16_f32 v60, v184, v185
    v_cvt_pk_bf16_f32 v61, v186, v187
    v_cvt_pk_bf16_f32 v62, v188, v189
    v_cvt_pk_bf16_f32 v63, v190, v191
    v_mov_b32 v14, 0xff800000
    s_waitcnt lgkmcnt(0)
    s_nop 0
    v_mfma_f32_16x16x32_bf16 v[128:131], v[192:195], v[32:35], 0
    v_mov_b32 v80, 0
    v_mov_b32 v81, 0
    v_mfma_f32_16x16x32_bf16 v[136:139], v[192:195], v[36:39], 0
    ds_read_b128 v[192:195], v3 offset:8192
    v_mov_b32 v82, 0
    v_mfma_f32_16x16x32_bf16 v[132:135], v[196:199], v[32:35], 0
    v_mov_b32 v83, 0
    v_mov_b32 v84, 0
    v_mfma_f32_16x16x32_bf16 v[140:143], v[196:199], v[36:39], 0
    ds_read_b128 v[196:199], v3 offset:9216
    v_mov_b32 v85, 0
    v_mfma_f32_16x16x32_bf16 v[128:131], v[200:203], v[40:43], v[128:131]
    v_mov_b32 v86, 0
    v_mov_b32 v87, 0
    v_mfma_f32_16x16x32_bf16 v[136:139], v[200:203], v[44:47], v[136:139]
    ds_read_b128 v[200:203], v3 offset:10240
    v_mov_b32 v88, 0
    v_mfma_f32_16x16x32_bf16 v[132:135], v[204:207], v[40:43], v[132:135]
    v_mov_b32 v89, 0
    v_mov_b32 v90, 0
    v_mfma_f32_16x16x32_bf16 v[140:143], v[204:207], v[44:47], v[140:143]
    ds_read_b128 v[204:207], v3 offset:11264
    v_mov_b32 v91, 0
    v_mfma_f32_16x16x32_bf16 v[128:131], v[208:211], v[48:51], v[128:131]
    v_mov_b32 v92, 0
    v_mov_b32 v93, 0
    v_mfma_f32_16x16x32_bf16 v[136:139], v[208:211], v[52:55], v[136:139]
    ds_read_b128 v[208:211], v3 offset:12288
    v_mov_b32 v94, 0
    v_mfma_f32_16x16x32_bf16 v[132:135], v[212:215], v[48:51], v[132:135]
    v_mov_b32 v95, 0
    v_mov_b32 v96, 0
    v_mfma_f32_16x16x32_bf16 v[140:143], v[212:215], v[52:55], v[140:143]
    ds_read_b128 v[212:215], v3 offset:13312
    v_mov_b32 v97, 0
    v_mfma_f32_16x16x32_bf16 v[128:131], v[216:219], v[56:59], v[128:131]
    v_mov_b32 v98, 0
    v_mov_b32 v99, 0
    v_mfma_f32_16x16x32_bf16 v[136:139], v[216:219], v[60:63], v[136:139]
    ds_read_b128 v[216:219], v3 offset:14336
    v_mov_b32 v100, 0
    v_mfma_f32_16x16x32_bf16 v[132:135], v[220:223], v[56:59], v[132:135]
    v_mov_b32 v101, 0
    v_mov_b32 v102, 0
    v_mfma_f32_16x16x32_bf16 v[140:143], v[220:223], v[60:63], v[140:143]
    ds_read_b128 v[220:223], v3 offset:15360
    v_mov_b32 v103, 0
    v_mov_b32 v104, 0
    v_mov_b32 v105, 0
    v_mov_b32 v106, 0
    v_mov_b32 v107, 0
    v_mov_b32 v108, 0
    v_mov_b32 v109, 0
    v_mov_b32 v110, 0
    v_mov_b32 v111, 0
    v_mov_b32 v112, 0
    v_mov_b32 v113, 0
    v_mov_b32 v114, 0
    v_mov_b32 v115, 0
    v_mov_b32 v116, 0
    v_mov_b32 v117, 0
    v_mov_b32 v118, 0
    v_mov_b32 v119, 0
    v_and_b32 v172, 3, v0
    v_add_u32 v172, -1, v172
    v_ashrrev_i32 v172, 31, v172
    v_and_b32 v28, 0x3f803f80, v172
    v_and_b32 v29, 0x3f803f80, v172
    v_and_b32 v30, 0x3f803f80, v172
    v_and_b32 v31, 0x3f803f80, v172
    v_mov_b32 v170, 0
    v_mov_b32 v171, 0
    s_cmp_lg_u32 s68, 0
    s_cbranch_scc1 nomask0_74
    v_cndmask_b32 v128, v128, v14, s[24:25]
    v_cndmask_b32 v129, v129, v14, s[26:27]
    v_cndmask_b32 v130, v130, v14, s[28:29]
    v_cndmask_b32 v131, v131, v14, s[30:31]
    v_cndmask_b32 v132, v132, v14, s[32:33]
    v_cndmask_b32 v133, v133, v14, s[34:35]
    v_cndmask_b32 v134, v134, v14, s[36:37]
    v_cndmask_b32 v135, v135, v14, s[38:39]
    v_cndmask_b32 v136, v136, v14, s[40:41]
    v_cndmask_b32 v137, v137, v14, s[42:43]
    v_cndmask_b32 v138, v138, v14, s[44:45]
    v_cndmask_b32 v139, v139, v14, s[46:47]
    v_cndmask_b32 v140, v140, v14, s[48:49]
    v_cndmask_b32 v141, v141, v14, s[50:51]
    v_cndmask_b32 v142, v142, v14, s[52:53]
    v_cndmask_b32 v143, v143, v14, s[54:55]
nomask0_74:
    v_max3_f32 v172, v128, v129, v130
    v_max3_f32 v172, v172, v131, v132
    v_max3_f32 v172, v172, v133, v134
    v_max_f32 v172, v172, v135
    v_max3_f32 v174, v136, v137, v138
    v_max3_f32 v174, v174, v139, v140
    v_max3_f32 v174, v174, v141, v142
    v_max_f32 v174, v174, v143
    v_mov_b32 v173, v172
    v_mov_b32 v175, v174
    s_nop 0
    v_permlane32_swap_b32 v172, v173
    v_permlane32_swap_b32 v174, v175
    v_max_f32 v172, v172, v173
    v_max_f32 v174, v174, v175
    v_mov_b32 v173, v172
    v_mov_b32 v175, v174
    s_nop 0
    v_permlane16_swap_b32 v172, v173
    v_permlane16_swap_b32 v174, v175
    v_max_f32 v172, v172, v173
    v_max_f32 v174, v174, v175
    v_sub_f32 v160, 3268149248, v172
    v_sub_f32 v161, 3268149248, v172
    v_sub_f32 v162, 3268149248, v172
    v_sub_f32 v163, 3268149248, v172
    v_sub_f32 v164, 3268149248, v174
    v_sub_f32 v165, 3268149248, v174
    v_sub_f32 v166, 3268149248, v174
    v_sub_f32 v167, 3268149248, v174
    v_pk_add_f32 v[128:129], v[128:129], v[160:161]
    v_pk_add_f32 v[130:131], v[130:131], v[160:161]
    v_pk_add_f32 v[132:133], v[132:133], v[160:161]
    v_pk_add_f32 v[134:135], v[134:135], v[160:161]
    v_pk_add_f32 v[136:137], v[136:137], v[164:165]
    v_pk_add_f32 v[138:139], v[138:139], v[164:165]
    v_pk_add_f32 v[140:141], v[140:141], v[164:165]
    v_pk_add_f32 v[142:143], v[142:143], v[164:165]
    s_mov_b32 s70, 131072
    s_mov_b32 s69, s68
    s_mov_b32 s83, 0
    s_waitcnt lgkmcnt(0)
    s_add_u32 s70, s70, 32768
    s_cmp_ge_u32 s70, 163840
    s_cselect_b32 s70, 0, s70
    s_add_u32 s83, s83, 1
    v_add_u32 v2, s70, v15
    s_waitcnt vmcnt(16)
    s_barrier
    s_cmp_lt_u32 s3, 4
    s_cbranch_scc1 nold_75
    s_mov_b32 s99, 0
    s_cmp_gt_u32 s75, s76
    s_cbranch_scc1 wo_dma
    s_cmp_lt_u32 s75, s76
    s_cselect_b32 s84, s73, 1073741824
    s_mov_b32 s85, s74
    s_mov_b32 m0, s91
    s_add_u32 s73, s73, 16384
    buffer_load_dwordx4 v15, s[8:11], s84 offen offset:0 sc1 lds
    buffer_load_dwordx4 v15, s[8:11], s84 offen offset:1024 sc1 lds
    buffer_load_dwordx4 v15, s[8:11], s84 offen offset:2048 sc1 lds
    buffer_load_dwordx4 v15, s[8:11], s84 offen offset:3072 sc1 lds
    s_add_u32 m0, s91, 16384
    s_add_u32 s74, s74, 16384
    buffer_load_dwordx4 v15, s[8:11], s85 offen offset:0 sc1 lds
    buffer_load_dwordx4 v15, s[8:11], s85 offen offset:1024 sc1 lds
    buffer_load_dwordx4 v15, s[8:11], s85 offen offset:2048 sc1 lds
    buffer_load_dwordx4 v15, s[8:11], s85 offen offset:3072 sc1 lds
wor_76:
    s_add_u32 s75, s75, 1
    s_add_u32 s91, s91, 32768
    s_cmp_ge_u32 s91, 163840
    s_cselect_b32 s91, s77, s91
nold_75:
    s_cmp_eq_u32 s68, 0
    s_cbranch_scc1 att_g0
    s_waitcnt lgkmcnt(8)
    v_mfma_f32_16x16x32_bf16 v[144:147], v[192:195], v[32:35], v[160:163]
    v_exp_f32 v12, v128
    v_mfma_f32_16x16x32_bf16 v[152:155], v[192:195], v[36:39], v[164:167]
    ds_read_b128 v[192:195], v2 offset:0
    v_exp_f32 v13, v129
    v_mfma_f32_16x16x32_bf16 v[148:151], v[196:199], v[32:35], v[160:163]
    v_exp_f32 v1, v130
    v_mfma_f32_16x16x32_bf16 v[156:159], v[196:199], v[36:39], v[164:167]
    ds_read_b128 v[196:199], v2 offset:1024
    v_cvt_pk_bf16_f32 v176, v12, v13
    v_mfma_f32_16x16x32_bf16 v[144:147], v[200:203], v[40:43], v[144:147]
    v_exp_f32 v21, v131
    v_mfma_f32_16x16x32_bf16 v[152:155], v[200:203], v[44:47], v[152:155]
    ds_read_b128 v[200:203], v2 offset:2048
    v_exp_f32 v22, v132
    v_mfma_f32_16x16x32_bf16 v[148:151], v[204:207], v[40:43], v[148:151]
    v_exp_f32 v23, v133
    v_mfma_f32_16x16x32_bf16 v[156:159], v[204:207], v[44:47], v[156:159]
    ds_read_b128 v[204:207], v2 offset:3072
    v_cvt_pk_bf16_f32 v177, v1, v21
    v_mfma_f32_16x16x32_bf16 v[144:147], v[208:211], v[48:51], v[144:147]
    v_exp_f32 v12, v134
    v_mfma_f32_16x16x32_bf16 v[152:155], v[208:211], v[52:55], v[152:155]
    ds_read_b128 v[208:211], v2 offset:4096
    v_exp_f32 v13, v135
    v_cvt_pk_bf16_f32 v178, v22, v23
    v_mfma_f32_16x16x32_bf16 v[148:151], v[212:215], v[48:51], v[148:151]
    v_exp_f32 v1, v136
    v_mfma_f32_16x16x32_bf16 v[156:159], v[212:215], v[52:55], v[156:159]
    ds_read_b128 v[212:215], v2 offset:5120
    v_cvt_pk_bf16_f32 v179, v12, v13
    v_mfma_f32_16x16x32_bf16 v[144:147], v[216:219], v[56:59], v[144:147]
    v_exp_f32 v21, v137
    v_mfma_f32_16x16x32_bf16 v[152:155], v[216:219], v[60:63], v[152:155]
    ds_read_b128 v[216:219], v2 offset:6144
    v_exp_f32 v22, v138
    v_mfma_f32_16x16x32_bf16 v[148:151], v[220:223], v[56:59], v[148:151]
    v_exp_f32 v23, v139
    v_mfma_f32_16x16x32_bf16 v[156:159], v[220:223], v[60:63], v[156:159]
    ds_read_b128 v[220:223], v2 offset:7168
    v_cvt_pk_bf16_f32 v180, v1, v21
    v_mfma_f32_16x16x32_bf16 v[4:7], v[28:31], v[176:179], 0
    s_waitcnt lgkmcnt(8)
    v_exp_f32 v12, v140
    ds_read_b128 v[224:227], v2 offset:16384
    v_exp_f32 v13, v141
    v_cvt_pk_bf16_f32 v181, v22, v23
    v_exp_f32 v1, v142
    ds_read_b128 v[228:231], v2 offset:17408
    v_cvt_pk_bf16_f32 v182, v12, v13
    v_exp_f32 v21, v143
    ds_read_b128 v[232:235], v2 offset:18432
    v_cvt_pk_bf16_f32 v183, v1, v21
    ds_read_b128 v[236:239], v2 offset:19456
    s_nop 0
    v_mfma_f32_16x16x32_bf16 v[8:11], v[28:31], v[180:183], 0
    ds_read_b128 v[240:243], v2 offset:20480
    v_add_f32 v168, v170, v4
    ds_read_b128 v[244:247], v2 offset:21504
    s_nop 4
    v_add_f32 v169, v171, v8
    ds_read_b128 v[248:251], v2 offset:22528
    ds_read_b128 v[252:255], v2 offset:23552
    v_add_f32 v3, v168, v169
    v_cmp_nge_f32 vcc, s72, v3
    s_mov_b32 s71, 0
    s_cbranch_vccnz rare0
ret_77:
    s_cmp_eq_u32 s69, 1
    s_cbranch_scc1 att_last_odd
    s_setprio 0
    s_cmp_ge_u32 s3, 4
    s_cbranch_scc1 att_loop1
    s_lshl_b32 s56, s2, 2
    s_add_u32 s56, s56, s3
    s_lshl_b32 s56, s56, 12
    v_lshlrev_b32 v16, 7, v0
    s_mov_b32 exec_hi, 0
    buffer_load_dword v16, v16, s[20:23], s56 offen
    s_mov_b64 exec, -1
    v_mov_b32 v24, -1
    v_mov_b32 v25, -1
    v_mov_b32 v26, -1
    v_mov_b32 v27, -1
    s_lshl_b32 s81, s2, 2
    s_add_u32 s81, s81, s3
    s_lshl_b32 s81, s81, 15
    s_add_u32 s81, s81, 100679680
att_loop2:
    s_waitcnt lgkmcnt(8)
    v_mfma_f32_16x16x32_bf16 v[128:131], v[192:195], v[32:35], v[160:163]
    v_exp_f32 v12, v144
    v_mfma_f32_16x16x32_bf16 v[128:131], v[200:203], v[40:43], v[128:131]
    v_exp_f32 v13, v145
    v_mfma_f32_16x16x32_bf16 v[128:131], v[208:211], v[48:51], v[128:131]
    v_exp_f32 v1, v146
    v_mfma_f32_16x16x32_bf16 v[128:131], v[216:219], v[56:59], v[128:131]
    v_cvt_pk_bf16_f32 v184, v12, v13
    s_sub_u32 s69, s69, 2
    v_mfma_f32_16x16x32_bf16 v[136:139], v[216:219], v[60:63], v[164:167]
    v_exp_f32 v21, v147
    v_mfma_f32_16x16x32_bf16 v[136:139], v[208:211], v[52:55], v[136:139]
    v_exp_f32 v22, v148
    v_mfma_f32_16x16x32_bf16 v[136:139], v[200:203], v[44:47], v[136:139]
    ds_read_b128 v[216:219], v2 offset:14336
    v_cvt_pk_bf16_f32 v185, v1, v21
    v_mfma_f32_16x16x32_bf16 v[136:139], v[192:195], v[36:39], v[136:139]
    v_exp_f32 v23, v149
    v_mfma_f32_16x16x32_bf16 v[140:143], v[196:199], v[36:39], v[164:167]
    v_exp_f32 v12, v150
    v_mfma_f32_16x16x32_bf16 v[140:143], v[204:207], v[44:47], v[140:143]
    ds_read_b128 v[208:211], v2 offset:12288
    v_cvt_pk_bf16_f32 v186, v22, v23
    v_mfma_f32_16x16x32_bf16 v[140:143], v[212:215], v[52:55], v[140:143]
    v_exp_f32 v13, v151
    v_mfma_f32_16x16x32_bf16 v[140:143], v[220:223], v[60:63], v[140:143]
    v_exp_f32 v1, v152
    v_mfma_f32_16x16x32_bf16 v[132:135], v[220:223], v[56:59], v[160:163]
    ds_read_b128 v[200:203], v2 offset:10240
    v_cvt_pk_bf16_f32 v187, v12, v13
    v_mfma_f32_16x16x32_bf16 v[132:135], v[212:215], v[48:51], v[132:135]
    v_exp_f32 v21, v153
    v_mfma_f32_16x16x32_bf16 v[132:135], v[204:207], v[40:43], v[132:135]
    v_exp_f32 v22, v154
    v_mfma_f32_16x16x32_bf16 v[132:135], v[196:199], v[32:35], v[132:135]
    ds_read_b128 v[192:195], v2 offset:8192
    v_cvt_pk_bf16_f32 v188, v1, v21
    s_waitcnt lgkmcnt(4)
    v_mfma_f32_16x16x32_bf16 v[64:67], v[224:227], v[176:179], v[64:67]
    v_exp_f32 v23, v155
    v_mfma_f32_16x16x32_bf16 v[72:75], v[224:227], v[180:183], v[72:75]
    v_exp_f32 v12, v156
    v_mfma_f32_16x16x32_bf16 v[4:7], v[28:31], v[184:187], 0
    ds_read_b128 v[220:223], v2 offset:15360
    ds_read_b128 v[212:215], v2 offset:13312
    v_mfma_f32_16x16x32_bf16 v[76:79], v[228:231], v[180:183], v[76:79]
    ds_read_b128 v[204:207], v2 offset:11264
    v_cvt_pk_bf16_f32 v189, v22, v23
    v_mfma_f32_16x16x32_bf16 v[68:71], v[228:231], v[176:179], v[68:71]
    v_exp_f32 v13, v157
    v_mfma_f32_16x16x32_bf16 v[80:83], v[232:235], v[176:179], v[80:83]
    v_exp_f32 v1, v158
    v_mfma_f32_16x16x32_bf16 v[88:91], v[232:235], v[180:183], v[88:91]
    ds_read_b128 v[196:199], v2 offset:9216
    v_cvt_pk_bf16_f32 v190, v12, v13
    v_mfma_f32_16x16x32_bf16 v[92:95], v[236:239], v[180:183], v[92:95]
    v_exp_f32 v21, v159
    v_mfma_f32_16x16x32_bf16 v[84:87], v[236:239], v[176:179], v[84:87]
    ds_read_b128 v[224:227], v2 offset:24576
    ds_read_b128 v[228:231], v2 offset:25600
    v_mfma_f32_16x16x32_bf16 v[96:99], v[240:243], v[176:179], v[96:99]
    ds_read_b128 v[232:235], v2 offset:26624
    v_cvt_pk_bf16_f32 v191, v1, v21
    v_mfma_f32_16x16x32_bf16 v[104:107], v[240:243], v[180:183], v[104:107]
    ds_read_b128 v[236:239], v2 offset:27648
    ds_read_b128 v[240:243], v2 offset:28672
    v_mfma_f32_16x16x32_bf16 v[8:11], v[28:31], v[188:191], 0
    v_add_f32 v170, v168, v4
    s_add_u32 s83, s83, 1
    v_mfma_f32_16x16x32_bf16 v[108:111], v[244:247], v[180:183], v[108:111]
    s_mov_b32 s62, s72
    buffer_store_dwordx4 v[24:27], v15, s[8:11], s81 offen offset:0 sc1
    v_mfma_f32_16x16x32_bf16 v[100:103], v[244:247], v[176:179], v[100:103]
    ds_read_b128 v[244:247], v2 offset:29696
    s_bitcmp1_b32 s63, s83
    v_mfma_f32_16x16x32_bf16 v[112:115], v[248:251], v[176:179], v[112:115]
    s_cselect_b32 s62, -1.0, s62
    s_add_u32 s70, s70, 32768
    v_mfma_f32_16x16x32_bf16 v[120:123], v[248:251], v[180:183], v[120:123]
    ds_read_b128 v[248:251], v2 offset:30720
    s_cmp_ge_u32 s70, 163840
    v_mfma_f32_16x16x32_bf16 v[124:127], v[252:255], v[180:183], v[124:127]
    s_cselect_b32 s70, 0, s70
    v_add_f32 v171, v169, v8
    v_add_f32 v3, v170, v171
    v_cmp_nge_f32 vcc, s62, v3
    v_mfma_f32_16x16x32_bf16 v[116:119], v[252:255], v[176:179], v[116:119]
    ds_read_b128 v[252:255], v2 offset:31744
    v_add_u32 v2, s70, v15
    s_cbranch_vccnz att_sp2
att_cont2:
    s_waitcnt lgkmcnt(8)
    v_mfma_f32_16x16x32_bf16 v[144:147], v[192:195], v[32:35], v[160:163]
    v_exp_f32 v12, v128
    v_mfma_f32_16x16x32_bf16 v[144:147], v[200:203], v[40:43], v[144:147]
    v_exp_f32 v13, v129
    s_barrier
    v_mfma_f32_16x16x32_bf16 v[144:147], v[208:211], v[48:51], v[144:147]
    v_exp_f32 v1, v130
    v_mfma_f32_16x16x32_bf16 v[144:147], v[216:219], v[56:59], v[144:147]
    v_cvt_pk_bf16_f32 v176, v12, v13
    buffer_store_dwordx4 v[24:27], v15, s[8:11], s81 offen offset:1024 sc1
    v_mfma_f32_16x16x32_bf16 v[152:155], v[216:219], v[60:63], v[164:167]
    v_exp_f32 v21, v131
    v_mfma_f32_16x16x32_bf16 v[152:155], v[208:211], v[52:55], v[152:155]
    v_exp_f32 v22, v132
    v_mfma_f32_16x16x32_bf16 v[152:155], v[200:203], v[44:47], v[152:155]
    ds_read_b128 v[216:219], v2 offset:6144
    v_cvt_pk_bf16_f32 v177, v1, v21
    v_mfma_f32_16x16x32_bf16 v[152:155], v[192:195], v[36:39], v[152:155]
    v_exp_f32 v23, v133
    v_mfma_f32_16x16x32_bf16 v[156:159], v[196:199], v[36:39], v[164:167]
    v_exp_f32 v12, v134
    v_mfma_f32_16x16x32_bf16 v[156:159], v[204:207], v[44:47], v[156:159]
    ds_read_b128 v[208:211], v2 offset:4096
    v_cvt_pk_bf16_f32 v178, v22, v23
    v_mfma_f32_16x16x32_bf16 v[156:159], v[212:215], v[52:55], v[156:159]
    v_exp_f32 v13, v135
    v_mfma_f32_16x16x32_bf16 v[156:159], v[220:223], v[60:63], v[156:159]
    v_exp_f32 v1, v136
    v_mfma_f32_16x16x32_bf16 v[148:151], v[220:223], v[56:59], v[160:163]
    ds_read_b128 v[200:203], v2 offset:2048
    v_cvt_pk_bf16_f32 v179, v12, v13
    v_mfma_f32_16x16x32_bf16 v[148:151], v[212:215], v[48:51], v[148:151]
    v_exp_f32 v21, v137
    v_mfma_f32_16x16x32_bf16 v[148:151], v[204:207], v[40:43], v[148:151]
    v_exp_f32 v22, v138
    v_mfma_f32_16x16x32_bf16 v[148:151], v[196:199], v[32:35], v[148:151]
    ds_read_b128 v[192:195], v2 offset:0
    v_cvt_pk_bf16_f32 v180, v1, v21
    s_waitcnt lgkmcnt(4)
    v_mfma_f32_16x16x32_bf16 v[64:67], v[224:227], v[184:187], v[64:67]
    v_exp_f32 v23, v139
    v_mfma_f32_16x16x32_bf16 v[72:75], v[224:227], v[188:191], v[72:75]
    v_exp_f32 v12, v140
    v_mfma_f32_16x16x32_bf16 v[4:7], v[28:31], v[176:179], 0
    ds_read_b128 v[220:223], v2 offset:7168
    ds_read_b128 v[212:215], v2 offset:5120
    v_mfma_f32_16x16x32_bf16 v[76:79], v[228:231], v[188:191], v[76:79]
    ds_read_b128 v[204:207], v2 offset:3072
    v_cvt_pk_bf16_f32 v181, v22, v23
    v_mfma_f32_16x16x32_bf16 v[68:71], v[228:231], v[184:187], v[68:71]
    v_exp_f32 v13, v141
    v_mfma_f32_16x16x32_bf16 v[80:83], v[232:235], v[184:187], v[80:83]
    v_exp_f32 v1, v142
    v_mfma_f32_16x16x32_bf16 v[88:91], v[232:235], v[188:191], v[88:91]
    ds_read_b128 v[196:199], v2 offset:1024
    v_cvt_pk_bf16_f32 v182, v12, v13
    v_mfma_f32_16x16x32_bf16 v[92:95], v[236:239], v[188:191], v[92:95]
    v_exp_f32 v21, v143
    v_mfma_f32_16x16x32_bf16 v[84:87], v[236:239], v[184:187], v[84:87]
    ds_read_b128 v[224:227], v2 offset:16384
    ds_read_b128 v[228:231], v2 offset:17408
    v_mfma_f32_16x16x32_bf16 v[96:99], v[240:243], v[184:187], v[96:99]
    ds_read_b128 v[232:235], v2 offset:18432
    v_cvt_pk_bf16_f32 v183, v1, v21
    v_mfma_f32_16x16x32_bf16 v[104:107], v[240:243], v[188:191], v[104:107]
    ds_read_b128 v[236:239], v2 offset:19456
    ds_read_b128 v[240:243], v2 offset:20480
    v_mfma_f32_16x16x32_bf16 v[8:11], v[28:31], v[180:183], 0
    v_add_f32 v168, v170, v4
    s_add_u32 s81, s81, 2048
    v_mfma_f32_16x16x32_bf16 v[108:111], v[244:247], v[188:191], v[108:111]
    s_cmp_eq_u32 s83, 5
    s_cselect_b32 s62, -1.0, s72
    v_mfma_f32_16x16x32_bf16 v[100:103], v[244:247], v[184:187], v[100:103]
    ds_read_b128 v[244:247], v2 offset:21504
    v_mfma_f32_16x16x32_bf16 v[112:115], v[248:251], v[184:187], v[112:115]
    v_mfma_f32_16x16x32_bf16 v[120:123], v[248:251], v[188:191], v[120:123]
    ds_read_b128 v[248:251], v2 offset:22528
    v_mfma_f32_16x16x32_bf16 v[124:127], v[252:255], v[188:191], v[124:127]
    v_add_f32 v169, v171, v8
    v_add_f32 v3, v168, v169
    v_cmp_nge_f32 vcc, s62, v3
    v_mfma_f32_16x16x32_bf16 v[116:119], v[252:255], v[184:187], v[116:119]
    ds_read_b128 v[252:255], v2 offset:23552
    s_cbranch_vccz att_loop2
    v_add_f32 v3, v168, v169
    v_cmp_nge_f32 vcc, s72, v3
    s_mov_b32 s71, 1
    s_cbranch_vccnz rare0
ret_78:
    s_cmp_lg_u32 s83, 5
    s_cbranch_scc1 att_loop2
    s_branch att_loop0
att_sp2:
    v_add_f32 v3, v170, v171
    v_cmp_nge_f32 vcc, s72, v3
    s_mov_b32 s71, 2
    s_cbranch_vccnz rare1
ret_79:
    s_bitcmp1_b32 s63, s83
    s_cbranch_scc1 lvlb
    s_branch att_cont2
att_loop0:
    s_waitcnt lgkmcnt(8)
    v_mfma_f32_16x16x32_bf16 v[128:131], v[192:195], v[32:35], v[160:163]
    v_exp_f32 v12, v144
    v_mfma_f32_16x16x32_bf16 v[128:131], v[200:203], v[40:43], v[128:131]
    v_exp_f32 v13, v145
    v_mfma_f32_16x16x32_bf16 v[128:131], v[208:211], v[48:51], v[128:131]
    v_exp_f32 v1, v146
    v_mfma_f32_16x16x32_bf16 v[128:131], v[216:219], v[56:59], v[128:131]
    v_cvt_pk_bf16_f32 v184, v12, v13
    s_sub_u32 s69, s69, 2
    v_mfma_f32_16x16x32_bf16 v[136:139], v[216:219], v[60:63], v[164:167]
    v_exp_f32 v21, v147
    v_mfma_f32_16x16x32_bf16 v[136:139], v[208:211], v[52:55], v[136:139]
    v_exp_f32 v22, v148
    v_mfma_f32_16x16x32_bf16 v[136:139], v[200:203], v[44:47], v[136:139]
    ds_read_b128 v[216:219], v2 offset:14336
    v_cvt_pk_bf16_f32 v185, v1, v21
    v_mfma_f32_16x16x32_bf16 v[136:139], v[192:195], v[36:39], v[136:139]
    v_exp_f32 v23, v149
    v_mfma_f32_16x16x32_bf16 v[140:143], v[196:199], v[36:39], v[164:167]
    v_exp_f32 v12, v150
    v_mfma_f32_16x16x32_bf16 v[140:143], v[204:207], v[44:47], v[140:143]
    ds_read_b128 v[208:211], v2 offset:12288
    v_cvt_pk_bf16_f32 v186, v22, v23
    v_mfma_f32_16x16x32_bf16 v[140:143], v[212:215], v[52:55], v[140:143]
    v_exp_f32 v13, v151
    v_mfma_f32_16x16x32_bf16 v[140:143], v[220:223], v[60:63], v[140:143]
    v_exp_f32 v1, v152
    v_mfma_f32_16x16x32_bf16 v[132:135], v[220:223], v[56:59], v[160:163]
    ds_read_b128 v[200:203], v2 offset:10240
    v_cvt_pk_bf16_f32 v187, v12, v13
    v_mfma_f32_16x16x32_bf16 v[132:135], v[212:215], v[48:51], v[132:135]
    v_exp_f32 v21, v153
    v_mfma_f32_16x16x32_bf16 v[132:135], v[204:207], v[40:43], v[132:135]
    v_exp_f32 v22, v154
    v_mfma_f32_16x16x32_bf16 v[132:135], v[196:199], v[32:35], v[132:135]
    ds_read_b128 v[192:195], v2 offset:8192
    v_cvt_pk_bf16_f32 v188, v1, v21
    s_waitcnt lgkmcnt(4)
    v_mfma_f32_16x16x32_bf16 v[64:67], v[224:227], v[176:179], v[64:67]
    v_exp_f32 v23, v155
    v_mfma_f32_16x16x32_bf16 v[72:75], v[224:227], v[180:183], v[72:75]
    v_exp_f32 v12, v156
    v_mfma_f32_16x16x32_bf16 v[4:7], v[28:31], v[184:187], 0
    ds_read_b128 v[220:223], v2 offset:15360
    ds_read_b128 v[212:215], v2 offset:13312
    v_mfma_f32_16x16x32_bf16 v[76:79], v[228:231], v[180:183], v[76:79]
    ds_read_b128 v[204:207], v2 offset:11264
    v_cvt_pk_bf16_f32 v189, v22, v23
    v_mfma_f32_16x16x32_bf16 v[68:71], v[228:231], v[176:179], v[68:71]
    v_exp_f32 v13, v157
    v_mfma_f32_16x16x32_bf16 v[80:83], v[232:235], v[176:179], v[80:83]
    v_exp_f32 v1, v158
    v_mfma_f32_16x16x32_bf16 v[88:91], v[232:235], v[180:183], v[88:91]
    ds_read_b128 v[196:199], v2 offset:9216
    v_cvt_pk_bf16_f32 v190, v12, v13
    v_mfma_f32_16x16x32_bf16 v[92:95], v[236:239], v[180:183], v[92:95]
    v_exp_f32 v21, v159
    v_mfma_f32_16x16x32_bf16 v[84:87], v[236:239], v[176:179], v[84:87]
    ds_read_b128 v[224:227], v2 offset:24576
    ds_read_b128 v[228:231], v2 offset:25600
    v_mfma_f32_16x16x32_bf16 v[96:99], v[240:243], v[176:179], v[96:99]
    ds_read_b128 v[232:235], v2 offset:26624
    v_cvt_pk_bf16_f32 v191, v1, v21
    v_mfma_f32_16x16x32_bf16 v[104:107], v[240:243], v[180:183], v[104:107]
    ds_read_b128 v[236:239], v2 offset:27648
    ds_read_b128 v[240:243], v2 offset:28672
    v_mfma_f32_16x16x32_bf16 v[8:11], v[28:31], v[188:191], 0
    v_add_f32 v170, v168, v4
    s_add_u32 s83, s83, 1
    v_mfma_f32_16x16x32_bf16 v[108:111], v[244:247], v[180:183], v[108:111]
    s_cmp_eq_u32 s69, 0
    s_cselect_b32 s62, -1.0, s72
    v_mfma_f32_16x16x32_bf16 v[100:103], v[244:247], v[176:179], v[100:103]
    ds_read_b128 v[244:247], v2 offset:29696
    s_bitcmp1_b32 s63, s83
    v_mfma_f32_16x16x32_bf16 v[112:115], v[248:251], v[176:179], v[112:115]
    s_cselect_b32 s62, -1.0, s62
    s_add_u32 s70, s70, 32768
    v_mfma_f32_16x16x32_bf16 v[120:123], v[248:251], v[180:183], v[120:123]
    ds_read_b128 v[248:251], v2 offset:30720
    s_cmp_ge_u32 s70, 163840
    v_mfma_f32_16x16x32_bf16 v[124:127], v[252:255], v[180:183], v[124:127]
    s_cselect_b32 s70, 0, s70
    v_add_f32 v171, v169, v8
    v_add_f32 v3, v170, v171
    v_cmp_nge_f32 vcc, s62, v3
    v_mfma_f32_16x16x32_bf16 v[116:119], v[252:255], v[176:179], v[116:119]
    ds_read_b128 v[252:255], v2 offset:31744
    v_add_u32 v2, s70, v15
    s_cbranch_vccnz att_sp0
att_cont0:
    s_waitcnt lgkmcnt(8)
    v_mfma_f32_16x16x32_bf16 v[144:147], v[192:195], v[32:35], v[160:163]
    v_exp_f32 v12, v128
    v_mfma_f32_16x16x32_bf16 v[144:147], v[200:203], v[40:43], v[144:147]
    v_exp_f32 v13, v129
    s_barrier
    v_mfma_f32_16x16x32_bf16 v[144:147], v[208:211], v[48:51], v[144:147]
    v_exp_f32 v1, v130
    v_mfma_f32_16x16x32_bf16 v[144:147], v[216:219], v[56:59], v[144:147]
    v_cvt_pk_bf16_f32 v176, v12, v13
    s_cmp_eq_u32 s69, 1
    v_mfma_f32_16x16x32_bf16 v[152:155], v[216:219], v[60:63], v[164:167]
    v_exp_f32 v21, v131
    v_mfma_f32_16x16x32_bf16 v[152:155], v[208:211], v[52:55], v[152:155]
    v_exp_f32 v22, v132
    v_mfma_f32_16x16x32_bf16 v[152:155], v[200:203], v[44:47], v[152:155]
    ds_read_b128 v[216:219], v2 offset:6144
    v_cvt_pk_bf16_f32 v177, v1, v21
    v_mfma_f32_16x16x32_bf16 v[152:155], v[192:195], v[36:39], v[152:155]
    v_exp_f32 v23, v133
    v_mfma_f32_16x16x32_bf16 v[156:159], v[196:199], v[36:39], v[164:167]
    v_exp_f32 v12, v134
    v_mfma_f32_16x16x32_bf16 v[156:159], v[204:207], v[44:47], v[156:159]
    ds_read_b128 v[208:211], v2 offset:4096
    v_cvt_pk_bf16_f32 v178, v22, v23
    v_mfma_f32_16x16x32_bf16 v[156:159], v[212:215], v[52:55], v[156:159]
    v_exp_f32 v13, v135
    v_mfma_f32_16x16x32_bf16 v[156:159], v[220:223], v[60:63], v[156:159]
    v_exp_f32 v1, v136
    v_mfma_f32_16x16x32_bf16 v[148:151], v[220:223], v[56:59], v[160:163]
    ds_read_b128 v[200:203], v2 offset:2048
    v_cvt_pk_bf16_f32 v179, v12, v13
    v_mfma_f32_16x16x32_bf16 v[148:151], v[212:215], v[48:51], v[148:151]
    v_exp_f32 v21, v137
    v_mfma_f32_16x16x32_bf16 v[148:151], v[204:207], v[40:43], v[148:151]
    v_exp_f32 v22, v138
    v_mfma_f32_16x16x32_bf16 v[148:151], v[196:199], v[32:35], v[148:151]
    ds_read_b128 v[192:195], v2 offset:0
    v_cvt_pk_bf16_f32 v180, v1, v21
    s_waitcnt lgkmcnt(4)
    v_mfma_f32_16x16x32_bf16 v[64:67], v[224:227], v[184:187], v[64:67]
    v_exp_f32 v23, v139
    v_mfma_f32_16x16x32_bf16 v[72:75], v[224:227], v[188:191], v[72:75]
    v_exp_f32 v12, v140
    v_mfma_f32_16x16x32_bf16 v[4:7], v[28:31], v[176:179], 0
    ds_read_b128 v[220:223], v2 offset:7168
    ds_read_b128 v[212:215], v2 offset:5120
    v_mfma_f32_16x16x32_bf16 v[76:79], v[228:231], v[188:191], v[76:79]
    ds_read_b128 v[204:207], v2 offset:3072
    v_cvt_pk_bf16_f32 v181, v22, v23
    v_mfma_f32_16x16x32_bf16 v[68:71], v[228:231], v[184:187], v[68:71]
    v_exp_f32 v13, v141
    v_mfma_f32_16x16x32_bf16 v[80:83], v[232:235], v[184:187], v[80:83]
    v_exp_f32 v1, v142
    v_mfma_f32_16x16x32_bf16 v[88:91], v[232:235], v[188:191], v[88:91]
    ds_read_b128 v[196:199], v2 offset:1024
    v_cvt_pk_bf16_f32 v182, v12, v13
    v_mfma_f32_16x16x32_bf16 v[92:95], v[236:239], v[188:191], v[92:95]
    v_exp_f32 v21, v143
    v_mfma_f32_16x16x32_bf16 v[84:87], v[236:239], v[184:187], v[84:87]
    ds_read_b128 v[224:227], v2 offset:16384
    ds_read_b128 v[228:231], v2 offset:17408
    v_mfma_f32_16x16x32_bf16 v[96:99], v[240:243], v[184:187], v[96:99]
    ds_read_b128 v[232:235], v2 offset:18432
    v_cvt_pk_bf16_f32 v183, v1, v21
    v_mfma_f32_16x16x32_bf16 v[104:107], v[240:243], v[188:191], v[104:107]
    ds_read_b128 v[236:239], v2 offset:19456
    ds_read_b128 v[240:243], v2 offset:20480
    v_mfma_f32_16x16x32_bf16 v[8:11], v[28:31], v[180:183], 0
    v_add_f32 v168, v170, v4
    s_cselect_b32 s62, -1.0, s72
    v_mfma_f32_16x16x32_bf16 v[108:111], v[244:247], v[188:191], v[108:111]
    v_mfma_f32_16x16x32_bf16 v[100:103], v[244:247], v[184:187], v[100:103]
    ds_read_b128 v[244:247], v2 offset:21504
    v_mfma_f32_16x16x32_bf16 v[112:115], v[248:251], v[184:187], v[112:115]
    v_mfma_f32_16x16x32_bf16 v[120:123], v[248:251], v[188:191], v[120:123]
    ds_read_b128 v[248:251], v2 offset:22528
    v_mfma_f32_16x16x32_bf16 v[124:127], v[252:255], v[188:191], v[124:127]
    v_add_f32 v169, v171, v8
    v_add_f32 v3, v168, v169
    v_cmp_nge_f32 vcc, s62, v3
    v_mfma_f32_16x16x32_bf16 v[116:119], v[252:255], v[184:187], v[116:119]
    ds_read_b128 v[252:255], v2 offset:23552
    s_cbranch_vccz att_loop0
    v_add_f32 v3, v168, v169
    v_cmp_nge_f32 vcc, s72, v3
    s_mov_b32 s71, 3
    s_cbranch_vccnz rare0
ret_80:
    s_cmp_lg_u32 s69, 1
    s_cbranch_scc1 att_loop0
    s_branch att_last_odd
att_sp0:
    v_add_f32 v3, v170, v171
    v_cmp_nge_f32 vcc, s72, v3
    s_mov_b32 s71, 4
    s_cbranch_vccnz rare1
ret_81:
    s_bitcmp1_b32 s63, s83
    s_cbranch_scc1 lvlb
lvlb_ret:
    s_cmp_le_u32 s83, s95
    s_cbranch_scc1 att_cont2
    s_cmp_lg_u32 s69, 0
    s_cbranch_scc1 att_cont0
    s_barrier
    s_branch att_last_even0
att_loop1:
    s_waitcnt lgkmcnt(8)
    v_mfma_f32_16x16x32_bf16 v[128:131], v[192:195], v[32:35], v[160:163]
    v_exp_f32 v12, v144
    v_mfma_f32_16x16x32_bf16 v[128:131], v[200:203], v[40:43], v[128:131]
    v_exp_f32 v13, v145
    v_mfma_f32_16x16x32_bf16 v[128:131], v[208:211], v[48:51], v[128:131]
    v_exp_f32 v1, v146
    v_mfma_f32_16x16x32_bf16 v[128:131], v[216:219], v[56:59], v[128:131]
    v_cvt_pk_bf16_f32 v184, v12, v13
    s_sub_u32 s69, s69, 2
    v_mfma_f32_16x16x32_bf16 v[136:139], v[216:219], v[60:63], v[164:167]
    v_exp_f32 v21, v147
    v_mfma_f32_16x16x32_bf16 v[136:139], v[208:211], v[52:55], v[136:139]
    v_exp_f32 v22, v148
    v_mfma_f32_16x16x32_bf16 v[136:139], v[200:203], v[44:47], v[136:139]
    ds_read_b128 v[216:219], v2 offset:14336
    v_cvt_pk_bf16_f32 v185, v1, v21
    v_mfma_f32_16x16x32_bf16 v[136:139], v[192:195], v[36:39], v[136:139]
    v_exp_f32 v23, v149
    v_mfma_f32_16x16x32_bf16 v[140:143], v[196:199], v[36:39], v[164:167]
    v_exp_f32 v12, v150
    v_mfma_f32_16x16x32_bf16 v[140:143], v[204:207], v[44:47], v[140:143]
    ds_read_b128 v[208:211], v2 offset:12288
    v_cvt_pk_bf16_f32 v186, v22, v23
    v_mfma_f32_16x16x32_bf16 v[140:143], v[212:215], v[52:55], v[140:143]
    v_exp_f32 v13, v151
    v_mfma_f32_16x16x32_bf16 v[140:143], v[220:223], v[60:63], v[140:143]
    v_exp_f32 v1, v152
    v_mfma_f32_16x16x32_bf16 v[132:135], v[220:223], v[56:59], v[160:163]
    ds_read_b128 v[200:203], v2 offset:10240
    v_cvt_pk_bf16_f32 v187, v12, v13
    v_mfma_f32_16x16x32_bf16 v[132:135], v[212:215], v[48:51], v[132:135]
    v_exp_f32 v21, v153
    v_mfma_f32_16x16x32_bf16 v[132:135], v[204:207], v[40:43], v[132:135]
    v_exp_f32 v22, v154
    v_mfma_f32_16x16x32_bf16 v[132:135], v[196:199], v[32:35], v[132:135]
    ds_read_b128 v[192:195], v2 offset:8192
    v_cvt_pk_bf16_f32 v188, v1, v21
    s_waitcnt lgkmcnt(4)
    v_mfma_f32_16x16x32_bf16 v[64:67], v[224:227], v[176:179], v[64:67]
    v_exp_f32 v23, v155
    v_mfma_f32_16x16x32_bf16 v[72:75], v[224:227], v[180:183], v[72:75]
    v_exp_f32 v12, v156
    v_mfma_f32_16x16x32_bf16 v[4:7], v[28:31], v[184:187], 0
    ds_read_b128 v[220:223], v2 offset:15360
    ds_read_b128 v[212:215], v2 offset:13312
    v_mfma_f32_16x16x32_bf16 v[76:79], v[228:231], v[180:183], v[76:79]
    ds_read_b128 v[204:207], v2 offset:11264
    v_cvt_pk_bf16_f32 v189, v22, v23
    v_mfma_f32_16x16x32_bf16 v[68:71], v[228:231], v[176:179], v[68:71]
    v_exp_f32 v13, v157
    v_mfma_f32_16x16x32_bf16 v[80:83], v[232:235], v[176:179], v[80:83]
    v_exp_f32 v1, v158
    v_mfma_f32_16x16x32_bf16 v[88:91], v[232:235], v[180:183], v[88:91]
    ds_read_b128 v[196:199], v2 offset:9216
    v_cvt_pk_bf16_f32 v190, v12, v13
    v_mfma_f32_16x16x32_bf16 v[92:95], v[236:239], v[180:183], v[92:95]
    v_exp_f32 v21, v159
    v_mfma_f32_16x16x32_bf16 v[84:87], v[236:239], v[176:179], v[84:87]
    ds_read_b128 v[224:227], v2 offset:24576
    ds_read_b128 v[228:231], v2 offset:25600
    v_mfma_f32_16x16x32_bf16 v[96:99], v[240:243], v[176:179], v[96:99]
    ds_read_b128 v[232:235], v2 offset:26624
    v_cvt_pk_bf16_f32 v191, v1, v21
    v_mfma_f32_16x16x32_bf16 v[104:107], v[240:243], v[180:183], v[104:107]
    ds_read_b128 v[236:239], v2 offset:27648
    ds_read_b128 v[240:243], v2 offset:28672
    v_mfma_f32_16x16x32_bf16 v[8:11], v[28:31], v[188:191], 0
    v_add_f32 v170, v168, v4
    s_add_u32 s83, s83, 1
    v_mfma_f32_16x16x32_bf16 v[108:111], v[244:247], v[180:183], v[108:111]
    s_cmp_eq_u32 s69, 0
    s_cselect_b32 s62, -1.0, s72
    v_mfma_f32_16x16x32_bf16 v[100:103], v[244:247], v[176:179], v[100:103]
    ds_read_b128 v[244:247], v2 offset:29696
    s_bitcmp1_b32 s63, s83
    v_mfma_f32_16x16x32_bf16 v[112:115], v[248:251], v[176:179], v[112:115]
    s_cselect_b32 s62, -1.0, s62
    s_add_u32 s70, s70, 32768
    v_mfma_f32_16x16x32_bf16 v[120:123], v[248:251], v[180:183], v[120:123]
    ds_read_b128 v[248:251], v2 offset:30720
    s_cmp_ge_u32 s70, 163840
    v_mfma_f32_16x16x32_bf16 v[124:127], v[252:255], v[180:183], v[124:127]
    s_cselect_b32 s70, 0, s70
    v_add_f32 v171, v169, v8
    v_add_f32 v3, v170, v171
    v_cmp_nge_f32 vcc, s62, v3
    v_mfma_f32_16x16x32_bf16 v[116:119], v[252:255], v[176:179], v[116:119]
    ds_read_b128 v[252:255], v2 offset:31744
    v_add_u32 v2, s70, v15
    s_cbranch_vccnz att_sp1
att_cont1:
    s_waitcnt lgkmcnt(8)
    v_mfma_f32_16x16x32_bf16 v[144:147], v[192:195], v[32:35], v[160:163]
    v_exp_f32 v12, v128
    v_mfma_f32_16x16x32_bf16 v[144:147], v[200:203], v[40:43], v[144:147]
    v_exp_f32 v13, v129
    s_waitcnt vmcnt(16)
    s_barrier
    v_mfma_f32_16x16x32_bf16 v[144:147], v[208:211], v[48:51], v[144:147]
    v_exp_f32 v1, v130
    v_mfma_f32_16x16x32_bf16 v[144:147], v[216:219], v[56:59], v[144:147]
    v_cvt_pk_bf16_f32 v176, v12, v13
    s_mov_b32 m0, s91
    s_add_u32 s75, s75, 1
    v_mfma_f32_16x16x32_bf16 v[152:155], v[216:219], v[60:63], v[164:167]
    v_exp_f32 v21, v131
    v_mfma_f32_16x16x32_bf16 v[152:155], v[208:211], v[52:55], v[152:155]
    v_exp_f32 v22, v132
    v_mfma_f32_16x16x32_bf16 v[152:155], v[200:203], v[44:47], v[152:155]
    ds_read_b128 v[216:219], v2 offset:6144
    v_cvt_pk_bf16_f32 v177, v1, v21
    buffer_load_dwordx4 v15, s[8:11], s73 offen offset:0 sc1 lds
    v_mfma_f32_16x16x32_bf16 v[152:155], v[192:195], v[36:39], v[152:155]
    v_exp_f32 v23, v133
    v_mfma_f32_16x16x32_bf16 v[156:159], v[196:199], v[36:39], v[164:167]
    v_exp_f32 v12, v134
    v_mfma_f32_16x16x32_bf16 v[156:159], v[204:207], v[44:47], v[156:159]
    ds_read_b128 v[208:211], v2 offset:4096
    v_cvt_pk_bf16_f32 v178, v22, v23
    buffer_load_dwordx4 v15, s[8:11], s73 offen offset:1024 sc1 lds
    v_mfma_f32_16x16x32_bf16 v[156:159], v[212:215], v[52:55], v[156:159]
    v_exp_f32 v13, v135
    v_mfma_f32_16x16x32_bf16 v[156:159], v[220:223], v[60:63], v[156:159]
    v_exp_f32 v1, v136
    v_mfma_f32_16x16x32_bf16 v[148:151], v[220:223], v[56:59], v[160:163]
    ds_read_b128 v[200:203], v2 offset:2048
    v_cvt_pk_bf16_f32 v179, v12, v13
    buffer_load_dwordx4 v15, s[8:11], s73 offen offset:2048 sc1 lds
    v_mfma_f32_16x16x32_bf16 v[148:151], v[212:215], v[48:51], v[148:151]
    v_exp_f32 v21, v137
    v_mfma_f32_16x16x32_bf16 v[148:151], v[204:207], v[40:43], v[148:151]
    v_exp_f32 v22, v138
    v_mfma_f32_16x16x32_bf16 v[148:151], v[196:199], v[32:35], v[148:151]
    ds_read_b128 v[192:195], v2 offset:0
    v_cvt_pk_bf16_f32 v180, v1, v21
    buffer_load_dwordx4 v15, s[8:11], s73 offen offset:3072 sc1 lds
    s_waitcnt lgkmcnt(4)
    v_mfma_f32_16x16x32_bf16 v[64:67], v[224:227], v[184:187], v[64:67]
    v_exp_f32 v23, v139
    v_mfma_f32_16x16x32_bf16 v[72:75], v[224:227], v[188:191], v[72:75]
    v_exp_f32 v12, v140
    v_mfma_f32_16x16x32_bf16 v[4:7], v[28:31], v[176:179], 0
    ds_read_b128 v[220:223], v2 offset:7168
    ds_read_b128 v[212:215], v2 offset:5120
    v_mfma_f32_16x16x32_bf16 v[76:79], v[228:231], v[188:191], v[76:79]
    ds_read_b128 v[204:207], v2 offset:3072
    v_cvt_pk_bf16_f32 v181, v22, v23
    s_add_u32 m0, s91, 16384
    v_mfma_f32_16x16x32_bf16 v[68:71], v[228:231], v[184:187], v[68:71]
    v_exp_f32 v13, v141
    v_mfma_f32_16x16x32_bf16 v[80:83], v[232:235], v[184:187], v[80:83]
    v_exp_f32 v1, v142
    v_mfma_f32_16x16x32_bf16 v[88:91], v[232:235], v[188:191], v[88:91]
    ds_read_b128 v[196:199], v2 offset:1024
    v_cvt_pk_bf16_f32 v182, v12, v13
    s_add_u32 s73, s73, 16384
    v_mfma_f32_16x16x32_bf16 v[92:95], v[236:239], v[188:191], v[92:95]
    v_exp_f32 v21, v143
    v_mfma_f32_16x16x32_bf16 v[84:87], v[236:239], v[184:187], v[84:87]
    ds_read_b128 v[224:227], v2 offset:16384
    ds_read_b128 v[228:231], v2 offset:17408
    v_mfma_f32_16x16x32_bf16 v[96:99], v[240:243], v[184:187], v[96:99]
    ds_read_b128 v[232:235], v2 offset:18432
    v_cvt_pk_bf16_f32 v183, v1, v21
    v_mfma_f32_16x16x32_bf16 v[104:107], v[240:243], v[188:191], v[104:107]
    ds_read_b128 v[236:239], v2 offset:19456
    ds_read_b128 v[240:243], v2 offset:20480
    v_mfma_f32_16x16x32_bf16 v[8:11], v[28:31], v[180:183], 0
    v_add_f32 v168, v170, v4
    buffer_load_dwordx4 v15, s[8:11], s74 offen offset:0 sc1 lds
    v_mfma_f32_16x16x32_bf16 v[108:111], v[244:247], v[188:191], v[108:111]
    buffer_load_dwordx4 v15, s[8:11], s74 offen offset:1024 sc1 lds
    buffer_load_dwordx4 v15, s[8:11], s74 offen offset:2048 sc1 lds
    v_mfma_f32_16x16x32_bf16 v[100:103], v[244:247], v[184:187], v[100:103]
    ds_read_b128 v[244:247], v2 offset:21504
    buffer_load_dwordx4 v15, s[8:11], s74 offen offset:3072 sc1 lds
    v_mfma_f32_16x16x32_bf16 v[112:115], v[248:251], v[184:187], v[112:115]
    s_cmp_eq_u32 s69, 1
    s_cselect_b32 s62, -1.0, s72
    v_mfma_f32_16x16x32_bf16 v[120:123], v[248:251], v[188:191], v[120:123]
    ds_read_b128 v[248:251], v2 offset:22528
    s_add_u32 s74, s74, 16384
    v_mfma_f32_16x16x32_bf16 v[124:127], v[252:255], v[188:191], v[124:127]
    s_add_u32 s91, s91, 32768
    s_cmp_ge_u32 s91, 163840
    v_add_f32 v169, v171, v8
    v_add_f32 v3, v168, v169
    v_cmp_nge_f32 vcc, s62, v3
    v_mfma_f32_16x16x32_bf16 v[116:119], v[252:255], v[184:187], v[116:119]
    ds_read_b128 v[252:255], v2 offset:23552
    s_cselect_b32 s91, s77, s91
    s_cbranch_vccz att_loop1
    v_add_f32 v3, v168, v169
    v_cmp_nge_f32 vcc, s72, v3
    s_mov_b32 s71, 5
    s_cbranch_vccnz rare0
ret_82:
    s_cmp_lg_u32 s69, 1
    s_cbranch_scc1 att_loop1
    s_branch att_last_odd
att_sp1:
    v_add_f32 v3, v170, v171
    v_cmp_nge_f32 vcc, s72, v3
    s_mov_b32 s71, 6
    s_cbranch_vccnz rare1
ret_83:
    s_cmp_eq_u32 s69, 0
    s_cbranch_scc1 att_sp1x
    s_cmp_lt_u32 s75, s76
    s_cbranch_scc1 att_cont1
    s_mov_b32 s73, 1073741824
    s_cmp_eq_u32 s75, s76
    s_cbranch_scc1 att_cont1
    s_waitcnt vmcnt(16)
    s_barrier
    s_mov_b32 s99, 1
    s_cmp_gt_u32 s75, s76
    s_cbranch_scc1 wo_dma
    s_cmp_lt_u32 s75, s76
    s_cselect_b32 s84, s73, 1073741824
    s_mov_b32 s85, s74
    s_mov_b32 m0, s91
    s_add_u32 s73, s73, 16384
    buffer_load_dwordx4 v15, s[8:11], s84 offen offset:0 sc1 lds
    buffer_load_dwordx4 v15, s[8:11], s84 offen offset:1024 sc1 lds
    buffer_load_dwordx4 v15, s[8:11], s84 offen offset:2048 sc1 lds
    buffer_load_dwordx4 v15, s[8:11], s84 offen offset:3072 sc1 lds
    s_add_u32 m0, s91, 16384
    s_add_u32 s74, s74, 16384
    buffer_load_dwordx4 v15, s[8:11], s85 offen offset:0 sc1 lds
    buffer_load_dwordx4 v15, s[8:11], s85 offen offset:1024 sc1 lds
    buffer_load_dwordx4 v15, s[8:11], s85 offen offset:2048 sc1 lds
    buffer_load_dwordx4 v15, s[8:11], s85 offen offset:3072 sc1 lds
wor_84:
    s_add_u32 s75, s75, 1
    s_add_u32 s91, s91, 32768
    s_cmp_ge_u32 s91, 163840
    s_cselect_b32 s91, s77, s91
    s_waitcnt lgkmcnt(8)
    v_mfma_f32_16x16x32_bf16 v[144:147], v[192:195], v[32:35], v[160:163]
    v_exp_f32 v12, v128
    v_mfma_f32_16x16x32_bf16 v[152:155], v[192:195], v[36:39], v[164:167]
    ds_read_b128 v[192:195], v2 offset:0
    v_exp_f32 v13, v129
    v_mfma_f32_16x16x32_bf16 v[148:151], v[196:199], v[32:35], v[160:163]
    v_exp_f32 v1, v130
    v_mfma_f32_16x16x32_bf16 v[156:159], v[196:199], v[36:39], v[164:167]
    ds_read_b128 v[196:199], v2 offset:1024
    v_cvt_pk_bf16_f32 v176, v12, v13
    v_mfma_f32_16x16x32_bf16 v[144:147], v[200:203], v[40:43], v[144:147]
    v_exp_f32 v21, v131
    v_mfma_f32_16x16x32_bf16 v[152:155], v[200:203], v[44:47], v[152:155]
    ds_read_b128 v[200:203], v2 offset:2048
    v_exp_f32 v22, v132
    v_mfma_f32_16x16x32_bf16 v[148:151], v[204:207], v[40:43], v[148:151]
    v_exp_f32 v23, v133
    v_mfma_f32_16x16x32_bf16 v[156:159], v[204:207], v[44:47], v[156:159]
    ds_read_b128 v[204:207], v2 offset:3072
    v_cvt_pk_bf16_f32 v177, v1, v21
    v_mfma_f32_16x16x32_bf16 v[144:147], v[208:211], v[48:51], v[144:147]
    v_exp_f32 v12, v134
    v_mfma_f32_16x16x32_bf16 v[152:155], v[208:211], v[52:55], v[152:155]
    ds_read_b128 v[208:211], v2 offset:4096
    v_exp_f32 v13, v135
    v_cvt_pk_bf16_f32 v178, v22, v23
    v_mfma_f32_16x16x32_bf16 v[148:151], v[212:215], v[48:51], v[148:151]
    v_exp_f32 v1, v136
    v_mfma_f32_16x16x32_bf16 v[156:159], v[212:215], v[52:55], v[156:159]
    ds_read_b128 v[212:215], v2 offset:5120
    v_cvt_pk_bf16_f32 v179, v12, v13
    v_mfma_f32_16x16x32_bf16 v[144:147], v[216:219], v[56:59], v[144:147]
    v_exp_f32 v21, v137
    v_mfma_f32_16x16x32_bf16 v[152:155], v[216:219], v[60:63], v[152:155]
    ds_read_b128 v[216:219], v2 offset:6144
    v_exp_f32 v22, v138
    v_mfma_f32_16x16x32_bf16 v[148:151], v[220:223], v[56:59], v[148:151]
    v_exp_f32 v23, v139
    v_mfma_f32_16x16x32_bf16 v[156:159], v[220:223], v[60:63], v[156:159]
    ds_read_b128 v[220:223], v2 offset:7168
    v_cvt_pk_bf16_f32 v180, v1, v21
    v_mfma_f32_16x16x32_bf16 v[4:7], v[28:31], v[176:179], 0
    s_waitcnt lgkmcnt(8)
    v_mfma_f32_16x16x32_bf16 v[64:67], v[224:227], v[184:187], v[64:67]
    v_exp_f32 v12, v140
    v_mfma_f32_16x16x32_bf16 v[72:75], v[224:227], v[188:191], v[72:75]
    ds_read_b128 v[224:227], v2 offset:16384
    v_exp_f32 v13, v141
    v_cvt_pk_bf16_f32 v181, v22, v23
    v_mfma_f32_16x16x32_bf16 v[68:71], v[228:231], v[184:187], v[68:71]
    v_exp_f32 v1, v142
    v_mfma_f32_16x16x32_bf16 v[76:79], v[228:231], v[188:191], v[76:79]
    ds_read_b128 v[228:231], v2 offset:17408
    v_cvt_pk_bf16_f32 v182, v12, v13
    v_mfma_f32_16x16x32_bf16 v[80:83], v[232:235], v[184:187], v[80:83]
    v_exp_f32 v21, v143
    v_mfma_f32_16x16x32_bf16 v[88:91], v[232:235], v[188:191], v[88:91]
    ds_read_b128 v[232:235], v2 offset:18432
    v_mfma_f32_16x16x32_bf16 v[84:87], v[236:239], v[184:187], v[84:87]
    v_cvt_pk_bf16_f32 v183, v1, v21
    v_mfma_f32_16x16x32_bf16 v[92:95], v[236:239], v[188:191], v[92:95]
    ds_read_b128 v[236:239], v2 offset:19456
    v_mfma_f32_16x16x32_bf16 v[96:99], v[240:243], v[184:187], v[96:99]
    v_mfma_f32_16x16x32_bf16 v[8:11], v[28:31], v[180:183], 0
    v_mfma_f32_16x16x32_bf16 v[104:107], v[240:243], v[188:191], v[104:107]
    ds_read_b128 v[240:243], v2 offset:20480
    v_mfma_f32_16x16x32_bf16 v[100:103], v[244:247], v[184:187], v[100:103]
    v_add_f32 v168, v170, v4
    v_mfma_f32_16x16x32_bf16 v[108:111], v[244:247], v[188:191], v[108:111]
    ds_read_b128 v[244:247], v2 offset:21504
    v_mfma_f32_16x16x32_bf16 v[112:115], v[248:251], v[184:187], v[112:115]
    s_nop 0
    v_add_f32 v169, v171, v8
    v_mfma_f32_16x16x32_bf16 v[120:123], v[248:251], v[188:191], v[120:123]
    ds_read_b128 v[248:251], v2 offset:22528
    v_mfma_f32_16x16x32_bf16 v[116:119], v[252:255], v[184:187], v[116:119]
    v_mfma_f32_16x16x32_bf16 v[124:127], v[252:255], v[188:191], v[124:127]
    ds_read_b128 v[252:255], v2 offset:23552
    v_add_f32 v3, v168, v169
    v_cmp_nge_f32 vcc, s72, v3
    s_mov_b32 s71, 7
    s_cbranch_vccnz rare0
ret_85:
    s_branch att_last_odd
att_sp1x:
    s_waitcnt vmcnt(16)
    s_barrier
    s_branch att_last_even1
att_g0:
    s_waitcnt lgkmcnt(8)
    v_exp_f32 v12, v128
    v_exp_f32 v13, v129
    v_exp_f32 v1, v130
    v_cvt_pk_bf16_f32 v176, v12, v13
    v_exp_f32 v21, v131
    v_exp_f32 v22, v132
    v_exp_f32 v23, v133
    v_cvt_pk_bf16_f32 v177, v1, v21
    v_exp_f32 v12, v134
    v_exp_f32 v13, v135
    v_cvt_pk_bf16_f32 v178, v22, v23
    v_exp_f32 v1, v136
    v_cvt_pk_bf16_f32 v179, v12, v13
    v_exp_f32 v21, v137
    v_exp_f32 v22, v138
    v_exp_f32 v23, v139
    v_cvt_pk_bf16_f32 v180, v1, v21
    v_mfma_f32_16x16x32_bf16 v[4:7], v[28:31], v[176:179], 0
    s_waitcnt lgkmcnt(8)
    v_exp_f32 v12, v140
    ds_read_b128 v[224:227], v2 offset:16384
    v_exp_f32 v13, v141
    v_cvt_pk_bf16_f32 v181, v22, v23
    v_exp_f32 v1, v142
    ds_read_b128 v[228:231], v2 offset:17408
    v_cvt_pk_bf16_f32 v182, v12, v13
    v_exp_f32 v21, v143
    ds_read_b128 v[232:235], v2 offset:18432
    v_cvt_pk_bf16_f32 v183, v1, v21
    ds_read_b128 v[236:239], v2 offset:19456
    s_nop 0
    v_mfma_f32_16x16x32_bf16 v[8:11], v[28:31], v[180:183], 0
    ds_read_b128 v[240:243], v2 offset:20480
    v_add_f32 v168, v170, v4
    ds_read_b128 v[244:247], v2 offset:21504
    s_nop 4
    v_add_f32 v169, v171, v8
    ds_read_b128 v[248:251], v2 offset:22528
    ds_read_b128 v[252:255], v2 offset:23552
    v_add_f32 v3, v168, v169
    v_cmp_nge_f32 vcc, s72, v3
    s_mov_b32 s71, 8
    s_cbranch_vccnz rare0
ret_86:
    s_branch att_fin_odd
att_last_even1:
    s_mov_b32 s99, 2
    s_cmp_gt_u32 s75, s76
    s_cbranch_scc1 wo_dma
    s_cmp_lt_u32 s75, s76
    s_cselect_b32 s84, s73, 1073741824
    s_mov_b32 s85, s74
    s_mov_b32 m0, s91
    s_add_u32 s73, s73, 16384
    buffer_load_dwordx4 v15, s[8:11], s84 offen offset:0 sc1 lds
    buffer_load_dwordx4 v15, s[8:11], s84 offen offset:1024 sc1 lds
    buffer_load_dwordx4 v15, s[8:11], s84 offen offset:2048 sc1 lds
    buffer_load_dwordx4 v15, s[8:11], s84 offen offset:3072 sc1 lds
    s_add_u32 m0, s91, 16384
    s_add_u32 s74, s74, 16384
    buffer_load_dwordx4 v15, s[8:11], s85 offen offset:0 sc1 lds
    buffer_load_dwordx4 v15, s[8:11], s85 offen offset:1024 sc1 lds
    buffer_load_dwordx4 v15, s[8:11], s85 offen offset:2048 sc1 lds
    buffer_load_dwordx4 v15, s[8:11], s85 offen offset:3072 sc1 lds
wor_87:
    s_add_u32 s75, s75, 1
    s_add_u32 s91, s91, 32768
    s_cmp_ge_u32 s91, 163840
    s_cselect_b32 s91, s77, s91
att_last_even0:
    s_setprio 2
    s_nop 3
    v_cndmask_b32 v128, v128, v14, s[24:25]
    v_cndmask_b32 v129, v129, v14, s[26:27]
    s_waitcnt lgkmcnt(8)
    v_exp_f32 v12, v128
    v_exp_f32 v13, v129
    v_cndmask_b32 v130, v130, v14, s[28:29]
    v_exp_f32 v1, v130
    v_cvt_pk_bf16_f32 v176, v12, v13
    v_cndmask_b32 v131, v131, v14, s[30:31]
    v_cndmask_b32 v132, v132, v14, s[32:33]
    v_exp_f32 v21, v131
    v_exp_f32 v22, v132
    v_cndmask_b32 v133, v133, v14, s[34:35]
    v_exp_f32 v23, v133
    v_cvt_pk_bf16_f32 v177, v1, v21
    v_cndmask_b32 v134, v134, v14, s[36:37]
    v_cndmask_b32 v135, v135, v14, s[38:39]
    v_exp_f32 v12, v134
    v_exp_f32 v13, v135
    v_cvt_pk_bf16_f32 v178, v22, v23
    v_exp_f32 v1, v136
    v_cvt_pk_bf16_f32 v179, v12, v13
    v_exp_f32 v21, v137
    v_exp_f32 v22, v138
    v_exp_f32 v23, v139
    v_cvt_pk_bf16_f32 v180, v1, v21
    v_mfma_f32_16x16x32_bf16 v[4:7], v[28:31], v[176:179], 0
    v_cndmask_b32 v140, v140, v14, s[48:49]
    v_cndmask_b32 v141, v141, v14, s[50:51]
    s_waitcnt lgkmcnt(0)
    v_mfma_f32_16x16x32_bf16 v[64:67], v[224:227], v[184:187], v[64:67]
    v_exp_f32 v12, v140
    v_mfma_f32_16x16x32_bf16 v[72:75], v[224:227], v[188:191], v[72:75]
    ds_read_b128 v[224:227], v2 offset:16384
    v_exp_f32 v13, v141
    v_cvt_pk_bf16_f32 v181, v22, v23
    v_cndmask_b32 v142, v142, v14, s[52:53]
    v_mfma_f32_16x16x32_bf16 v[68:71], v[228:231], v[184:187], v[68:71]
    v_exp_f32 v1, v142
    v_mfma_f32_16x16x32_bf16 v[76:79], v[228:231], v[188:191], v[76:79]
    ds_read_b128 v[228:231], v2 offset:17408
    v_cvt_pk_bf16_f32 v182, v12, v13
    v_cndmask_b32 v143, v143, v14, s[54:55]
    v_mfma_f32_16x16x32_bf16 v[80:83], v[232:235], v[184:187], v[80:83]
    v_exp_f32 v21, v143
    v_mfma_f32_16x16x32_bf16 v[88:91], v[232:235], v[188:191], v[88:91]
    ds_read_b128 v[232:235], v2 offset:18432
    v_mfma_f32_16x16x32_bf16 v[84:87], v[236:239], v[184:187], v[84:87]
    v_cvt_pk_bf16_f32 v183, v1, v21
    v_mfma_f32_16x16x32_bf16 v[92:95], v[236:239], v[188:191], v[92:95]
    ds_read_b128 v[236:239], v2 offset:19456
    v_mfma_f32_16x16x32_bf16 v[96:99], v[240:243], v[184:187], v[96:99]
    v_mfma_f32_16x16x32_bf16 v[8:11], v[28:31], v[180:183], 0
    v_mfma_f32_16x16x32_bf16 v[104:107], v[240:243], v[188:191], v[104:107]
    ds_read_b128 v[240:243], v2 offset:20480
    v_mfma_f32_16x16x32_bf16 v[100:103], v[244:247], v[184:187], v[100:103]
    v_add_f32 v168, v170, v4
    v_mfma_f32_16x16x32_bf16 v[108:111], v[244:247], v[188:191], v[108:111]
    ds_read_b128 v[244:247], v2 offset:21504
    v_mfma_f32_16x16x32_bf16 v[112:115], v[248:251], v[184:187], v[112:115]
    s_nop 0
    v_add_f32 v169, v171, v8
    v_mfma_f32_16x16x32_bf16 v[120:123], v[248:251], v[188:191], v[120:123]
    ds_read_b128 v[248:251], v2 offset:22528
    v_mfma_f32_16x16x32_bf16 v[116:119], v[252:255], v[184:187], v[116:119]
    v_mfma_f32_16x16x32_bf16 v[124:127], v[252:255], v[188:191], v[124:127]
    ds_read_b128 v[252:255], v2 offset:23552
    v_add_f32 v3, v168, v169
    v_cmp_nge_f32 vcc, s72, v3
    s_mov_b32 s71, 9
    s_cbranch_vccnz rare0
ret_88:
att_fin_odd:
    v_mov_b32 v172, v168
    v_mov_b32 v174, v169
    s_waitcnt lgkmcnt(0)
    s_waitcnt lgkmcnt(0)
    v_mfma_f32_16x16x32_bf16 v[64:67], v[224:227], v[176:179], v[64:67]
    v_mfma_f32_16x16x32_bf16 v[72:75], v[224:227], v[180:183], v[72:75]
    v_mfma_f32_16x16x32_bf16 v[68:71], v[228:231], v[176:179], v[68:71]
    v_mfma_f32_16x16x32_bf16 v[76:79], v[228:231], v[180:183], v[76:79]
    v_mfma_f32_16x16x32_bf16 v[80:83], v[232:235], v[176:179], v[80:83]
    v_mfma_f32_16x16x32_bf16 v[88:91], v[232:235], v[180:183], v[88:91]
    v_mfma_f32_16x16x32_bf16 v[84:87], v[236:239], v[176:179], v[84:87]
    v_mfma_f32_16x16x32_bf16 v[92:95], v[236:239], v[180:183], v[92:95]
    v_mfma_f32_16x16x32_bf16 v[96:99], v[240:243], v[176:179], v[96:99]
    v_mfma_f32_16x16x32_bf16 v[104:107], v[240:243], v[180:183], v[104:107]
    v_mfma_f32_16x16x32_bf16 v[100:103], v[244:247], v[176:179], v[100:103]
    v_mfma_f32_16x16x32_bf16 v[108:111], v[244:247], v[180:183], v[108:111]
    v_mfma_f32_16x16x32_bf16 v[112:115], v[248:251], v[176:179], v[112:115]
    v_mfma_f32_16x16x32_bf16 v[120:123], v[248:251], v[180:183], v[120:123]
    v_mfma_f32_16x16x32_bf16 v[116:119], v[252:255], v[176:179], v[116:119]
    v_mfma_f32_16x16x32_bf16 v[124:127], v[252:255], v[180:183], v[124:127]
    s_cmp_gt_u32 s83, s76
    s_cbranch_scc1 nosync_89
    s_add_u32 s70, s70, 32768
    s_cmp_ge_u32 s70, 163840
    s_cselect_b32 s70, 0, s70
    s_add_u32 s83, s83, 1
    v_add_u32 v2, s70, v15
    s_waitcnt vmcnt(16)
    s_barrier
    s_cmp_lt_u32 s3, 4
    s_cbranch_scc1 nold_90
    s_mov_b32 s99, 3
    s_cmp_gt_u32 s75, s76
    s_cbranch_scc1 wo_dma
    s_cmp_lt_u32 s75, s76
    s_cselect_b32 s84, s73, 1073741824
    s_mov_b32 s85, s74
    s_mov_b32 m0, s91
    s_add_u32 s73, s73, 16384
    buffer_load_dwordx4 v15, s[8:11], s84 offen offset:0 sc1 lds
    buffer_load_dwordx4 v15, s[8:11], s84 offen offset:1024 sc1 lds
    buffer_load_dwordx4 v15, s[8:11], s84 offen offset:2048 sc1 lds
    buffer_load_dwordx4 v15, s[8:11], s84 offen offset:3072 sc1 lds
    s_add_u32 m0, s91, 16384
    s_add_u32 s74, s74, 16384
    buffer_load_dwordx4 v15, s[8:11], s85 offen offset:0 sc1 lds
    buffer_load_dwordx4 v15, s[8:11], s85 offen offset:1024 sc1 lds
    buffer_load_dwordx4 v15, s[8:11], s85 offen offset:2048 sc1 lds
    buffer_load_dwordx4 v15, s[8:11], s85 offen offset:3072 sc1 lds
wor_91:
    s_add_u32 s75, s75, 1
    s_add_u32 s91, s91, 32768
    s_cmp_ge_u32 s91, 163840
    s_cselect_b32 s91, s77, s91
nold_90:
nosync_89:
    s_branch att_done
att_last_odd:
    s_setprio 2
    s_nop 3
    v_cndmask_b32 v144, v144, v14, s[24:25]
    v_cndmask_b32 v145, v145, v14, s[26:27]
    s_waitcnt lgkmcnt(8)
    v_exp_f32 v12, v144
    v_exp_f32 v13, v145
    v_cndmask_b32 v146, v146, v14, s[28:29]
    v_exp_f32 v1, v146
    v_cvt_pk_bf16_f32 v184, v12, v13
    v_cndmask_b32 v147, v147, v14, s[30:31]
    v_cndmask_b32 v148, v148, v14, s[32:33]
    v_exp_f32 v21, v147
    v_exp_f32 v22, v148
    v_cndmask_b32 v149, v149, v14, s[34:35]
    v_exp_f32 v23, v149
    v_cvt_pk_bf16_f32 v185, v1, v21
    v_cndmask_b32 v150, v150, v14, s[36:37]
    v_cndmask_b32 v151, v151, v14, s[38:39]
    v_exp_f32 v12, v150
    v_exp_f32 v13, v151
    v_cvt_pk_bf16_f32 v186, v22, v23
    v_exp_f32 v1, v152
    v_cvt_pk_bf16_f32 v187, v12, v13
    v_exp_f32 v21, v153
    v_exp_f32 v22, v154
    v_exp_f32 v23, v155
    v_cvt_pk_bf16_f32 v188, v1, v21
    v_mfma_f32_16x16x32_bf16 v[4:7], v[28:31], v[184:187], 0
    v_cndmask_b32 v156, v156, v14, s[48:49]
    v_cndmask_b32 v157, v157, v14, s[50:51]
    s_waitcnt lgkmcnt(0)
    v_mfma_f32_16x16x32_bf16 v[64:67], v[224:227], v[176:179], v[64:67]
    v_exp_f32 v12, v156
    v_mfma_f32_16x16x32_bf16 v[72:75], v[224:227], v[180:183], v[72:75]
    ds_read_b128 v[224:227], v2 offset:24576
    v_exp_f32 v13, v157
    v_cvt_pk_bf16_f32 v189, v22, v23
    v_cndmask_b32 v158, v158, v14, s[52:53]
    v_mfma_f32_16x16x32_bf16 v[68:71], v[228:231], v[176:179], v[68:71]
    v_exp_f32 v1, v158
    v_mfma_f32_16x16x32_bf16 v[76:79], v[228:231], v[180:183], v[76:79]
    ds_read_b128 v[228:231], v2 offset:25600
    v_cvt_pk_bf16_f32 v190, v12, v13
    v_cndmask_b32 v159, v159, v14, s[54:55]
    v_mfma_f32_16x16x32_bf16 v[80:83], v[232:235], v[176:179], v[80:83]
    v_exp_f32 v21, v159
    v_mfma_f32_16x16x32_bf16 v[88:91], v[232:235], v[180:183], v[88:91]
    ds_read_b128 v[232:235], v2 offset:26624
    v_mfma_f32_16x16x32_bf16 v[84:87], v[236:239], v[176:179], v[84:87]
    v_cvt_pk_bf16_f32 v191, v1, v21
    v_mfma_f32_16x16x32_bf16 v[92:95], v[236:239], v[180:183], v[92:95]
    ds_read_b128 v[236:239], v2 offset:27648
    v_mfma_f32_16x16x32_bf16 v[96:99], v[240:243], v[176:179], v[96:99]
    v_mfma_f32_16x16x32_bf16 v[8:11], v[28:31], v[188:191], 0
    v_mfma_f32_16x16x32_bf16 v[104:107], v[240:243], v[180:183], v[104:107]
    ds_read_b128 v[240:243], v2 offset:28672
    v_mfma_f32_16x16x32_bf16 v[100:103], v[244:247], v[176:179], v[100:103]
    v_add_f32 v170, v168, v4
    v_mfma_f32_16x16x32_bf16 v[108:111], v[244:247], v[180:183], v[108:111]
    ds_read_b128 v[244:247], v2 offset:29696
    v_mfma_f32_16x16x32_bf16 v[112:115], v[248:251], v[176:179], v[112:115]
    s_nop 0
    v_add_f32 v171, v169, v8
    v_mfma_f32_16x16x32_bf16 v[120:123], v[248:251], v[180:183], v[120:123]
    ds_read_b128 v[248:251], v2 offset:30720
    v_mfma_f32_16x16x32_bf16 v[116:119], v[252:255], v[176:179], v[116:119]
    v_mfma_f32_16x16x32_bf16 v[124:127], v[252:255], v[180:183], v[124:127]
    ds_read_b128 v[252:255], v2 offset:31744
    v_add_f32 v3, v170, v171
    v_cmp_nge_f32 vcc, s72, v3
    s_mov_b32 s71, 10
    s_cbranch_vccnz rare1
ret_92:
    s_waitcnt lgkmcnt(0)
    s_cmp_gt_u32 s83, s76
    s_cbranch_scc1 nosync_93
    s_add_u32 s70, s70, 32768
    s_cmp_ge_u32 s70, 163840
    s_cselect_b32 s70, 0, s70
    s_add_u32 s83, s83, 1
    v_add_u32 v2, s70, v15
    s_waitcnt vmcnt(16)
    s_barrier
    s_cmp_lt_u32 s3, 4
    s_cbranch_scc1 nold_94
    s_mov_b32 s99, 4
    s_cmp_gt_u32 s75, s76
    s_cbranch_scc1 wo_dma
    s_cmp_lt_u32 s75, s76
    s_cselect_b32 s84, s73, 1073741824
    s_mov_b32 s85, s74
    s_mov_b32 m0, s91
    s_add_u32 s73, s73, 16384
    buffer_load_dwordx4 v15, s[8:11], s84 offen offset:0 sc1 lds
    buffer_load_dwordx4 v15, s[8:11], s84 offen offset:1024 sc1 lds
    buffer_load_dwordx4 v15, s[8:11], s84 offen offset:2048 sc1 lds
    buffer_load_dwordx4 v15, s[8:11], s84 offen offset:3072 sc1 lds
    s_add_u32 m0, s91, 16384
    s_add_u32 s74, s74, 16384
    buffer_load_dwordx4 v15, s[8:11], s85 offen offset:0 sc1 lds
    buffer_load_dwordx4 v15, s[8:11], s85 offen offset:1024 sc1 lds
    buffer_load_dwordx4 v15, s[8:11], s85 offen offset:2048 sc1 lds
    buffer_load_dwordx4 v15, s[8:11], s85 offen offset:3072 sc1 lds
wor_95:
    s_add_u32 s75, s75, 1
    s_add_u32 s91, s91, 32768
    s_cmp_ge_u32 s91, 163840
    s_cselect_b32 s91, s77, s91
nold_94:
nosync_93:
    v_mov_b32 v172, v170
    v_mov_b32 v174, v171
    s_waitcnt lgkmcnt(0)
    s_waitcnt lgkmcnt(0)
    v_mfma_f32_16x16x32_bf16 v[64:67], v[224:227], v[184:187], v[64:67]
    v_mfma_f32_16x16x32_bf16 v[72:75], v[224:227], v[188:191], v[72:75]
    v_mfma_f32_16x16x32_bf16 v[68:71], v[228:231], v[184:187], v[68:71]
    v_mfma_f32_16x16x32_bf16 v[76:79], v[228:231], v[188:191], v[76:79]
    v_mfma_f32_16x16x32_bf16 v[80:83], v[232:235], v[184:187], v[80:83]
    v_mfma_f32_16x16x32_bf16 v[88:91], v[232:235], v[188:191], v[88:91]
    v_mfma_f32_16x16x32_bf16 v[84:87], v[236:239], v[184:187], v[84:87]
    v_mfma_f32_16x16x32_bf16 v[92:95], v[236:239], v[188:191], v[92:95]
    v_mfma_f32_16x16x32_bf16 v[96:99], v[240:243], v[184:187], v[96:99]
    v_mfma_f32_16x16x32_bf16 v[104:107], v[240:243], v[188:191], v[104:107]
    v_mfma_f32_16x16x32_bf16 v[100:103], v[244:247], v[184:187], v[100:103]
    v_mfma_f32_16x16x32_bf16 v[108:111], v[244:247], v[188:191], v[108:111]
    v_mfma_f32_16x16x32_bf16 v[112:115], v[248:251], v[184:187], v[112:115]
    v_mfma_f32_16x16x32_bf16 v[120:123], v[248:251], v[188:191], v[120:123]
    v_mfma_f32_16x16x32_bf16 v[116:119], v[252:255], v[184:187], v[116:119]
    v_mfma_f32_16x16x32_bf16 v[124:127], v[252:255], v[188:191], v[124:127]
att_done:
    v_mul_f32 v172, 1602224128, v172
    v_rcp_f32 v172, v172
    v_mul_f32 v174, 1602224128, v174
    v_rcp_f32 v174, v174
    s_load_dwordx2 s[16:17], s[0:1], 80
    s_mov_b32 s18, 4194304
    s_mov_b32 s19, 0x20000
    s_and_b32 s80, s4, 3
    s_lshl_b32 s81, s2, 2
    s_add_u32 s81, s81, s65
    s_lshl_b32 s81, s81, 2
    s_lshr_b32 s56, s3, 2
    s_add_u32 s81, s81, s56
    s_lshl_b32 s81, s81, 13
    s_add_u32 s81, s81, 100663296
    s_add_u32 s82, s81, 16384
    v_mov_b32 v173, v172
    v_mov_b32 v175, v174
    v_pk_mul_f32 v[64:65], v[64:65], v[172:173]
    v_pk_mul_f32 v[66:67], v[66:67], v[172:173]
    v_pk_mul_f32 v[68:69], v[68:69], v[172:173]
    v_pk_mul_f32 v[70:71], v[70:71], v[172:173]
    v_cvt_pk_bf16_f32 v192, v64, v65
    v_cvt_pk_bf16_f32 v193, v66, v67
    v_cvt_pk_bf16_f32 v194, v68, v69
    v_cvt_pk_bf16_f32 v195, v70, v71
    v_pk_mul_f32 v[72:73], v[72:73], v[174:175]
    v_pk_mul_f32 v[74:75], v[74:75], v[174:175]
    v_pk_mul_f32 v[76:77], v[76:77], v[174:175]
    v_pk_mul_f32 v[78:79], v[78:79], v[174:175]
    v_cvt_pk_bf16_f32 v196, v72, v73
    v_cvt_pk_bf16_f32 v197, v74, v75
    v_cvt_pk_bf16_f32 v198, v76, v77
    v_cvt_pk_bf16_f32 v199, v78, v79
    v_pk_mul_f32 v[80:81], v[80:81], v[172:173]
    v_pk_mul_f32 v[82:83], v[82:83], v[172:173]
    v_pk_mul_f32 v[84:85], v[84:85], v[172:173]
    v_pk_mul_f32 v[86:87], v[86:87], v[172:173]
    v_cvt_pk_bf16_f32 v200, v80, v81
    v_cvt_pk_bf16_f32 v201, v82, v83
    v_cvt_pk_bf16_f32 v202, v84, v85
    v_cvt_pk_bf16_f32 v203, v86, v87
    v_pk_mul_f32 v[88:89], v[88:89], v[174:175]
    v_pk_mul_f32 v[90:91], v[90:91], v[174:175]
    v_pk_mul_f32 v[92:93], v[92:93], v[174:175]
    v_pk_mul_f32 v[94:95], v[94:95], v[174:175]
    v_cvt_pk_bf16_f32 v204, v88, v89
    v_cvt_pk_bf16_f32 v205, v90, v91
    v_cvt_pk_bf16_f32 v206, v92, v93
    v_cvt_pk_bf16_f32 v207, v94, v95
    v_pk_mul_f32 v[96:97], v[96:97], v[172:173]
    v_pk_mul_f32 v[98:99], v[98:99], v[172:173]
    v_pk_mul_f32 v[100:101], v[100:101], v[172:173]
    v_pk_mul_f32 v[102:103], v[102:103], v[172:173]
    v_cvt_pk_bf16_f32 v208, v96, v97
    v_cvt_pk_bf16_f32 v209, v98, v99
    v_cvt_pk_bf16_f32 v210, v100, v101
    v_cvt_pk_bf16_f32 v211, v102, v103
    v_pk_mul_f32 v[104:105], v[104:105], v[174:175]
    v_pk_mul_f32 v[106:107], v[106:107], v[174:175]
    v_pk_mul_f32 v[108:109], v[108:109], v[174:175]
    v_pk_mul_f32 v[110:111], v[110:111], v[174:175]
    v_cvt_pk_bf16_f32 v212, v104, v105
    v_cvt_pk_bf16_f32 v213, v106, v107
    v_cvt_pk_bf16_f32 v214, v108, v109
    v_cvt_pk_bf16_f32 v215, v110, v111
    v_pk_mul_f32 v[112:113], v[112:113], v[172:173]
    v_pk_mul_f32 v[114:115], v[114:115], v[172:173]
    v_pk_mul_f32 v[116:117], v[116:117], v[172:173]
    v_pk_mul_f32 v[118:119], v[118:119], v[172:173]
    v_cvt_pk_bf16_f32 v216, v112, v113
    v_cvt_pk_bf16_f32 v217, v114, v115
    v_cvt_pk_bf16_f32 v218, v116, v117
    v_cvt_pk_bf16_f32 v219, v118, v119
    v_pk_mul_f32 v[120:121], v[120:121], v[174:175]
    v_pk_mul_f32 v[122:123], v[122:123], v[174:175]
    v_pk_mul_f32 v[124:125], v[124:125], v[174:175]
    v_pk_mul_f32 v[126:127], v[126:127], v[174:175]
    v_cvt_pk_bf16_f32 v220, v120, v121
    v_cvt_pk_bf16_f32 v221, v122, v123
    v_cvt_pk_bf16_f32 v222, v124, v125
    v_cvt_pk_bf16_f32 v223, v126, v127
    s_add_u32 s56, s81, 4096
    buffer_store_dwordx4 v[192:195], v15, s[8:11], s81 offen offset:0 sc1
    buffer_store_dwordx4 v[196:199], v15, s[8:11], s81 offen offset:1024 sc1
    buffer_store_dwordx4 v[200:203], v15, s[8:11], s81 offen offset:2048 sc1
    buffer_store_dwordx4 v[204:207], v15, s[8:11], s81 offen offset:3072 sc1
    buffer_store_dwordx4 v[208:211], v15, s[8:11], s56 offen offset:0 sc1
    buffer_store_dwordx4 v[212:215], v15, s[8:11], s56 offen offset:1024 sc1
    buffer_store_dwordx4 v[216:219], v15, s[8:11], s56 offen offset:2048 sc1
    buffer_store_dwordx4 v[220:223], v15, s[8:11], s56 offen offset:3072 sc1
    s_setprio 0
    s_mov_b32 s28, 0
    s_mov_b32 s29, 0
    s_waitcnt lgkmcnt(0)
    s_cmp_ge_u32 s3, 4
    s_cbranch_scc1 s_idle
l_idle:
    s_cmp_gt_u32 s83, s76
    s_cbranch_scc1 tail_gemm
    s_add_u32 s70, s70, 32768
    s_cmp_ge_u32 s70, 163840
    s_cselect_b32 s70, 0, s70
    s_add_u32 s83, s83, 1
    v_add_u32 v2, s70, v15
    s_barrier
    s_branch l_idle
s_idle:
    s_mov_b32 s67, 0
idle24:
    s_cmp_ge_u32 s83, s76
    s_cbranch_scc1 s_pre
    s_add_u32 s70, s70, 32768
    s_cmp_ge_u32 s70, 163840
    s_cselect_b32 s70, 0, s70
    s_add_u32 s83, s83, 1
    v_add_u32 v2, s70, v15
    s_waitcnt vmcnt(24)
    s_barrier
    s_cmp_lt_u32 s3, 4
    s_cbranch_scc1 nold_96
    s_mov_b32 s99, 5
    s_cmp_gt_u32 s75, s76
    s_cbranch_scc1 wo_dma
    s_cmp_lt_u32 s75, s76
    s_cselect_b32 s84, s73, 1073741824
    s_mov_b32 s85, s74
    s_mov_b32 m0, s91
    s_add_u32 s73, s73, 16384
    buffer_load_dwordx4 v15, s[8:11], s84 offen offset:0 sc1 lds
    buffer_load_dwordx4 v15, s[8:11], s84 offen offset:1024 sc1 lds
    buffer_load_dwordx4 v15, s[8:11], s84 offen offset:2048 sc1 lds
    buffer_load_dwordx4 v15, s[8:11], s84 offen offset:3072 sc1 lds
    s_add_u32 m0, s91, 16384
    s_add_u32 s74, s74, 16384
    buffer_load_dwordx4 v15, s[8:11], s85 offen offset:0 sc1 lds
    buffer_load_dwordx4 v15, s[8:11], s85 offen offset:1024 sc1 lds
    buffer_load_dwordx4 v15, s[8:11], s85 offen offset:2048 sc1 lds
    buffer_load_dwordx4 v15, s[8:11], s85 offen offset:3072 sc1 lds
wor_97:
    s_add_u32 s75, s75, 1
    s_add_u32 s91, s91, 32768
    s_cmp_ge_u32 s91, 163840
    s_cselect_b32 s91, s77, s91
nold_96:
    s_add_u32 s67, s67, 1
    s_cmp_lt_u32 s67, 3
    s_cbranch_scc1 idle24
idle16:
    s_cmp_ge_u32 s83, s76
    s_cbranch_scc1 s_pre
    s_add_u32 s70, s70, 32768
    s_cmp_ge_u32 s70, 163840
    s_cselect_b32 s70, 0, s70
    s_add_u32 s83, s83, 1
    v_add_u32 v2, s70, v15
    s_waitcnt vmcnt(16)
    s_barrier
    s_cmp_lt_u32 s3, 4
    s_cbranch_scc1 nold_98
    s_mov_b32 s99, 6
    s_cmp_gt_u32 s75, s76
    s_cbranch_scc1 wo_dma
    s_cmp_lt_u32 s75, s76
    s_cselect_b32 s84, s73, 1073741824
    s_mov_b32 s85, s74
    s_mov_b32 m0, s91
    s_add_u32 s73, s73, 16384
    buffer_load_dwordx4 v15, s[8:11], s84 offen offset:0 sc1 lds
    buffer_load_dwordx4 v15, s[8:11], s84 offen offset:1024 sc1 lds
    buffer_load_dwordx4 v15, s[8:11], s84 offen offset:2048 sc1 lds
    buffer_load_dwordx4 v15, s[8:11], s84 offen offset:3072 sc1 lds
    s_add_u32 m0, s91, 16384
    s_add_u32 s74, s74, 16384
    buffer_load_dwordx4 v15, s[8:11], s85 offen offset:0 sc1 lds
    buffer_load_dwordx4 v15, s[8:11], s85 offen offset:1024 sc1 lds
    buffer_load_dwordx4 v15, s[8:11], s85 offen offset:2048 sc1 lds
    buffer_load_dwordx4 v15, s[8:11], s85 offen offset:3072 sc1 lds
wor_99:
    s_add_u32 s75, s75, 1
    s_add_u32 s91, s91, 32768
    s_cmp_ge_u32 s91, 163840
    s_cselect_b32 s91, s77, s91
nold_98:
    s_cmp_lg_u32 s28, 0
    s_cbranch_scc1 idle_p
    s_lshl_b32 s56, s2, 3
    s_add_u32 s56, s56, s3
    s_lshl_b32 s56, s56, 7
    s_add_u32 s56, s56, 68681728
    v_mov_b32 v19, 1
    s_mov_b64 exec, 1
    buffer_store_dword v19, off, s[8:11], s56 sc1
    s_mov_b64 exec, -1
    s_mov_b32 s28, 1
    s_branch idle16
idle_p:
    s_sub_u32 s56, s76, s83
    s_cmp_lg_u32 s56, 5
    s_cbranch_scc1 idle_r
    s_cmp_le_u32 s83, 9
    s_cbranch_scc1 idle16
    s_andn2_b32 s56, s2, 24
    s_lshl_b32 s56, s56, 3
    s_add_u32 s56, s56, s3
    s_lshl_b32 s56, s56, 7
    s_add_u32 s56, s56, 68681728
    v_lshlrev_b32 v17, 13, v0
    s_mov_b64 exec, 15
    buffer_load_dword v18, v17, s[8:11], s56 offen sc1
    s_mov_b64 exec, -1
    s_add_u32 s70, s70, 32768
    s_cmp_ge_u32 s70, 163840
    s_cselect_b32 s70, 0, s70
    s_add_u32 s83, s83, 1
    v_add_u32 v2, s70, v15
    s_waitcnt vmcnt(17)
    s_barrier
    s_cmp_lt_u32 s3, 4
    s_cbranch_scc1 nold_100
    s_mov_b32 s99, 7
    s_cmp_gt_u32 s75, s76
    s_cbranch_scc1 wo_dma
    s_cmp_lt_u32 s75, s76
    s_cselect_b32 s84, s73, 1073741824
    s_mov_b32 s85, s74
    s_mov_b32 m0, s91
    s_add_u32 s73, s73, 16384
    buffer_load_dwordx4 v15, s[8:11], s84 offen offset:0 sc1 lds
    buffer_load_dwordx4 v15, s[8:11], s84 offen offset:1024 sc1 lds
    buffer_load_dwordx4 v15, s[8:11], s84 offen offset:2048 sc1 lds
    buffer_load_dwordx4 v15, s[8:11], s84 offen offset:3072 sc1 lds
    s_add_u32 m0, s91, 16384
    s_add_u32 s74, s74, 16384
    buffer_load_dwordx4 v15, s[8:11], s85 offen offset:0 sc1 lds
    buffer_load_dwordx4 v15, s[8:11], s85 offen offset:1024 sc1 lds
    buffer_load_dwordx4 v15, s[8:11], s85 offen offset:2048 sc1 lds
    buffer_load_dwordx4 v15, s[8:11], s85 offen offset:3072 sc1 lds
wor_101:
    s_add_u32 s75, s75, 1
    s_add_u32 s91, s91, 32768
    s_cmp_ge_u32 s91, 163840
    s_cselect_b32 s91, s77, s91
nold_100:
    s_waitcnt vmcnt(8)
    v_cmp_gt_i32 vcc, 1, v18
    s_nop 0
    s_and_b32 s56, vcc_lo, 15
    s_cbranch_scc1 idle16
    s_add_u32 s56, s80, 1
    s_and_b32 s56, s56, 3
    s_sub_u32 s56, s56, s80
    s_lshl_b32 s56, s56, 20
    s_add_u32 s56, s56, s81
    s_add_u32 s57, s56, 4096
    buffer_load_dwordx4 v[32:35], v15, s[8:11], s56 offen offset:0 sc1
    buffer_load_dwordx4 v[36:39], v15, s[8:11], s56 offen offset:1024 sc1
    buffer_load_dwordx4 v[40:43], v15, s[8:11], s56 offen offset:2048 sc1
    buffer_load_dwordx4 v[44:47], v15, s[8:11], s56 offen offset:3072 sc1
    buffer_load_dwordx4 v[48:51], v15, s[8:11], s57 offen offset:0 sc1
    buffer_load_dwordx4 v[52:55], v15, s[8:11], s57 offen offset:1024 sc1
    buffer_load_dwordx4 v[56:59], v15, s[8:11], s57 offen offset:2048 sc1
    buffer_load_dwordx4 v[60:63], v15, s[8:11], s57 offen offset:3072 sc1
    s_add_u32 s70, s70, 32768
    s_cmp_ge_u32 s70, 163840
    s_cselect_b32 s70, 0, s70
    s_add_u32 s83, s83, 1
    v_add_u32 v2, s70, v15
    s_waitcnt vmcnt(24)
    s_barrier
    s_cmp_lt_u32 s3, 4
    s_cbranch_scc1 nold_102
    s_mov_b32 s99, 8
    s_cmp_gt_u32 s75, s76
    s_cbranch_scc1 wo_dma
    s_cmp_lt_u32 s75, s76
    s_cselect_b32 s84, s73, 1073741824
    s_mov_b32 s85, s74
    s_mov_b32 m0, s91
    s_add_u32 s73, s73, 16384
    buffer_load_dwordx4 v15, s[8:11], s84 offen offset:0 sc1 lds
    buffer_load_dwordx4 v15, s[8:11], s84 offen offset:1024 sc1 lds
    buffer_load_dwordx4 v15, s[8:11], s84 offen offset:2048 sc1 lds
    buffer_load_dwordx4 v15, s[8:11], s84 offen offset:3072 sc1 lds
    s_add_u32 m0, s91, 16384
    s_add_u32 s74, s74, 16384
    buffer_load_dwordx4 v15, s[8:11], s85 offen offset:0 sc1 lds
    buffer_load_dwordx4 v15, s[8:11], s85 offen offset:1024 sc1 lds
    buffer_load_dwordx4 v15, s[8:11], s85 offen offset:2048 sc1 lds
    buffer_load_dwordx4 v15, s[8:11], s85 offen offset:3072 sc1 lds
wor_103:
    s_add_u32 s75, s75, 1
    s_add_u32 s91, s91, 32768
    s_cmp_ge_u32 s91, 163840
    s_cselect_b32 s91, s77, s91
nold_102:
    s_add_u32 s56, s80, 2
    s_and_b32 s56, s56, 3
    s_sub_u32 s56, s56, s80
    s_lshl_b32 s56, s56, 20
    s_add_u32 s56, s56, s81
    s_add_u32 s57, s56, 4096
    buffer_load_dwordx4 v[64:67], v15, s[8:11], s56 offen offset:0 sc1
    buffer_load_dwordx4 v[68:71], v15, s[8:11], s56 offen offset:1024 sc1
    buffer_load_dwordx4 v[72:75], v15, s[8:11], s56 offen offset:2048 sc1
    buffer_load_dwordx4 v[76:79], v15, s[8:11], s56 offen offset:3072 sc1
    buffer_load_dwordx4 v[80:83], v15, s[8:11], s57 offen offset:0 sc1
    buffer_load_dwordx4 v[84:87], v15, s[8:11], s57 offen offset:1024 sc1
    buffer_load_dwordx4 v[88:91], v15, s[8:11], s57 offen offset:2048 sc1
    buffer_load_dwordx4 v[92:95], v15, s[8:11], s57 offen offset:3072 sc1
    s_add_u32 s70, s70, 32768
    s_cmp_ge_u32 s70, 163840
    s_cselect_b32 s70, 0, s70
    s_add_u32 s83, s83, 1
    v_add_u32 v2, s70, v15
    s_waitcnt vmcnt(32)
    s_barrier
    s_cmp_lt_u32 s3, 4
    s_cbranch_scc1 nold_104
    s_mov_b32 s99, 9
    s_cmp_gt_u32 s75, s76
    s_cbranch_scc1 wo_dma
    s_cmp_lt_u32 s75, s76
    s_cselect_b32 s84, s73, 1073741824
    s_mov_b32 s85, s74
    s_mov_b32 m0, s91
    s_add_u32 s73, s73, 16384
    buffer_load_dwordx4 v15, s[8:11], s84 offen offset:0 sc1 lds
    buffer_load_dwordx4 v15, s[8:11], s84 offen offset:1024 sc1 lds
    buffer_load_dwordx4 v15, s[8:11], s84 offen offset:2048 sc1 lds
    buffer_load_dwordx4 v15, s[8:11], s84 offen offset:3072 sc1 lds
    s_add_u32 m0, s91, 16384
    s_add_u32 s74, s74, 16384
    buffer_load_dwordx4 v15, s[8:11], s85 offen offset:0 sc1 lds
    buffer_load_dwordx4 v15, s[8:11], s85 offen offset:1024 sc1 lds
    buffer_load_dwordx4 v15, s[8:11], s85 offen offset:2048 sc1 lds
    buffer_load_dwordx4 v15, s[8:11], s85 offen offset:3072 sc1 lds
wor_105:
    s_add_u32 s75, s75, 1
    s_add_u32 s91, s91, 32768
    s_cmp_ge_u32 s91, 163840
    s_cselect_b32 s91, s77, s91
nold_104:
    s_add_u32 s56, s80, 3
    s_and_b32 s56, s56, 3
    s_sub_u32 s56, s56, s80
    s_lshl_b32 s56, s56, 20
    s_add_u32 s56, s56, s81
    s_add_u32 s57, s56, 4096
    buffer_load_dwordx4 v[96:99], v15, s[8:11], s56 offen offset:0 sc1
    buffer_load_dwordx4 v[100:103], v15, s[8:11], s56 offen offset:1024 sc1
    buffer_load_dwordx4 v[104:107], v15, s[8:11], s56 offen offset:2048 sc1
    buffer_load_dwordx4 v[108:111], v15, s[8:11], s56 offen offset:3072 sc1
    buffer_load_dwordx4 v[112:115], v15, s[8:11], s57 offen offset:0 sc1
    buffer_load_dwordx4 v[116:119], v15, s[8:11], s57 offen offset:1024 sc1
    buffer_load_dwordx4 v[120:123], v15, s[8:11], s57 offen offset:2048 sc1
    buffer_load_dwordx4 v[124:127], v15, s[8:11], s57 offen offset:3072 sc1
    s_add_u32 s70, s70, 32768
    s_cmp_ge_u32 s70, 163840
    s_cselect_b32 s70, 0, s70
    s_add_u32 s83, s83, 1
    v_add_u32 v2, s70, v15
    s_waitcnt vmcnt(40)
    s_barrier
    s_cmp_lt_u32 s3, 4
    s_cbranch_scc1 nold_106
    s_mov_b32 s99, 10
    s_cmp_gt_u32 s75, s76
    s_cbranch_scc1 wo_dma
    s_cmp_lt_u32 s75, s76
    s_cselect_b32 s84, s73, 1073741824
    s_mov_b32 s85, s74
    s_mov_b32 m0, s91
    s_add_u32 s73, s73, 16384
    buffer_load_dwordx4 v15, s[8:11], s84 offen offset:0 sc1 lds
    buffer_load_dwordx4 v15, s[8:11], s84 offen offset:1024 sc1 lds
    buffer_load_dwordx4 v15, s[8:11], s84 offen offset:2048 sc1 lds
    buffer_load_dwordx4 v15, s[8:11], s84 offen offset:3072 sc1 lds
    s_add_u32 m0, s91, 16384
    s_add_u32 s74, s74, 16384
    buffer_load_dwordx4 v15, s[8:11], s85 offen offset:0 sc1 lds
    buffer_load_dwordx4 v15, s[8:11], s85 offen offset:1024 sc1 lds
    buffer_load_dwordx4 v15, s[8:11], s85 offen offset:2048 sc1 lds
    buffer_load_dwordx4 v15, s[8:11], s85 offen offset:3072 sc1 lds
wor_107:
    s_add_u32 s75, s75, 1
    s_add_u32 s91, s91, 32768
    s_cmp_ge_u32 s91, 163840
    s_cselect_b32 s91, s77, s91
nold_106:
    s_mov_b32 s29, 1
    s_branch idle16
idle_r:
    s_cmp_lg_u32 s56, 8
    s_cbranch_scc1 idle_r2
    s_sub_u32 s57, s96, 0
    s_cmp_ge_u32 s57, 4
    s_cbranch_scc1 idle16
    s_and_b32 s56, s2, 31
    s_lshl_b32 s57, s57, 5
    s_add_u32 s56, s56, s57
    s_lshl_b32 s56, s56, 2
    s_add_u32 s56, s56, s65
    s_and_b32 s26, s56, 15
    s_lshr_b32 s56, s56, 4
    s_lshl_b32 s59, s56, 6
    s_add_u32 s59, s59, s26
    s_lshl_b32 s56, s59, 11
    s_add_u32 s56, s56, 87031808
    s_lshl_b32 s58, s26, 12
    s_add_u32 s58, s58, 55574528
    buffer_load_dwordx4 v[32:35], v15, s[8:11], s58 offen offset:0 sc1
    buffer_load_dwordx4 v[36:39], v15, s[8:11], s58 offen offset:1024 sc1
    buffer_load_dwordx4 v[40:43], v15, s[8:11], s58 offen offset:2048 sc1
    buffer_load_dwordx4 v[44:47], v15, s[8:11], s58 offen offset:3072 sc1
    buffer_load_dwordx4 v[48:51], v15, s[8:11], s56 offen offset:0 sc1
    buffer_load_dwordx4 v[52:55], v15, s[8:11], s56 offen offset:1024 sc1
    s_add_u32 s56, s56, 32768
    buffer_load_dwordx4 v[56:59], v15, s[8:11], s56 offen offset:0 sc1
    buffer_load_dwordx4 v[60:63], v15, s[8:11], s56 offen offset:1024 sc1
    s_add_u32 s56, s56, 32768
    buffer_load_dwordx4 v[64:67], v15, s[8:11], s56 offen offset:0 sc1
    buffer_load_dwordx4 v[68:71], v15, s[8:11], s56 offen offset:1024 sc1
    s_add_u32 s56, s56, 32768
    buffer_load_dwordx4 v[72:75], v15, s[8:11], s56 offen offset:0 sc1
    buffer_load_dwordx4 v[76:79], v15, s[8:11], s56 offen offset:1024 sc1
    s_add_u32 s56, s56, 32768
    s_add_u32 s70, s70, 32768
    s_cmp_ge_u32 s70, 163840
    s_cselect_b32 s70, 0, s70
    s_add_u32 s83, s83, 1
    v_add_u32 v2, s70, v15
    s_waitcnt vmcnt(28)
    s_barrier
    s_cmp_lt_u32 s3, 4
    s_cbranch_scc1 nold_108
    s_mov_b32 s99, 11
    s_cmp_gt_u32 s75, s76
    s_cbranch_scc1 wo_dma
    s_cmp_lt_u32 s75, s76
    s_cselect_b32 s84, s73, 1073741824
    s_mov_b32 s85, s74
    s_mov_b32 m0, s91
    s_add_u32 s73, s73, 16384
    buffer_load_dwordx4 v15, s[8:11], s84 offen offset:0 sc1 lds
    buffer_load_dwordx4 v15, s[8:11], s84 offen offset:1024 sc1 lds
    buffer_load_dwordx4 v15, s[8:11], s84 offen offset:2048 sc1 lds
    buffer_load_dwordx4 v15, s[8:11], s84 offen offset:3072 sc1 lds
    s_add_u32 m0, s91, 16384
    s_add_u32 s74, s74, 16384
    buffer_load_dwordx4 v15, s[8:11], s85 offen offset:0 sc1 lds
    buffer_load_dwordx4 v15, s[8:11], s85 offen offset:1024 sc1 lds
    buffer_load_dwordx4 v15, s[8:11], s85 offen offset:2048 sc1 lds
    buffer_load_dwordx4 v15, s[8:11], s85 offen offset:3072 sc1 lds
wor_109:
    s_add_u32 s75, s75, 1
    s_add_u32 s91, s91, 32768
    s_cmp_ge_u32 s91, 163840
    s_cselect_b32 s91, s77, s91
nold_108:
    s_waitcnt vmcnt(8)
    s_mov_b32 s67, 0
val0:
    v_max3_u32 v3, v32, v33, v34
    v_max3_u32 v3, v3, v35, v36
    v_max3_u32 v3, v3, v37, v38
    v_max3_u32 v3, v3, v39, v40
    v_max3_u32 v3, v3, v41, v42
    v_max3_u32 v3, v3, v43, v44
    v_max3_u32 v3, v3, v45, v46
    v_max_u32 v3, v3, v47
    v_cmp_eq_u32 vcc, -1, v3
    s_cbranch_vccnz reload0
    s_cmp_eq_u32 exec_lo, 0
    s_mov_b64 exec, -1
    s_cbranch_scc1 loads0
valok0:
    v_mfma_f32_16x16x32_bf16 v[80:83], v[32:35], v[48:51], 0
    v_mfma_f32_16x16x32_bf16 v[84:87], v[36:39], v[48:51], 0
    v_mfma_f32_16x16x32_bf16 v[88:91], v[40:43], v[52:55], 0
    v_mfma_f32_16x16x32_bf16 v[92:95], v[44:47], v[52:55], 0
    v_mfma_f32_16x16x32_bf16 v[96:99], v[32:35], v[56:59], 0
    v_mfma_f32_16x16x32_bf16 v[100:103], v[36:39], v[56:59], 0
    v_mfma_f32_16x16x32_bf16 v[104:107], v[40:43], v[60:63], 0
    v_mfma_f32_16x16x32_bf16 v[108:111], v[44:47], v[60:63], 0
    v_mfma_f32_16x16x32_bf16 v[112:115], v[32:35], v[64:67], 0
    v_mfma_f32_16x16x32_bf16 v[116:119], v[36:39], v[64:67], 0
    v_mfma_f32_16x16x32_bf16 v[120:123], v[40:43], v[68:71], 0
    v_mfma_f32_16x16x32_bf16 v[124:127], v[44:47], v[68:71], 0
    v_mfma_f32_16x16x32_bf16 v[128:131], v[32:35], v[72:75], 0
    v_mfma_f32_16x16x32_bf16 v[132:135], v[36:39], v[72:75], 0
    v_mfma_f32_16x16x32_bf16 v[136:139], v[40:43], v[76:79], 0
    v_mfma_f32_16x16x32_bf16 v[140:143], v[44:47], v[76:79], 0
    s_lshl_b32 s59, s59, 10
    s_add_u32 s59, s59, 56098816
    v_add_f32 v84, 897988541, v84
    v_rcp_f32 v84, v84
    v_add_f32 v92, 897988541, v92
    v_rcp_f32 v92, v92
    v_add_f32 v100, 897988541, v100
    v_rcp_f32 v100, v100
    v_add_f32 v108, 897988541, v108
    v_rcp_f32 v108, v108
    v_add_f32 v116, 897988541, v116
    v_rcp_f32 v116, v116
    v_add_f32 v124, 897988541, v124
    v_rcp_f32 v124, v124
    v_add_f32 v132, 897988541, v132
    v_rcp_f32 v132, v132
    v_add_f32 v140, 897988541, v140
    v_rcp_f32 v140, v140
    s_add_u32 s70, s70, 32768
    s_cmp_ge_u32 s70, 163840
    s_cselect_b32 s70, 0, s70
    s_add_u32 s83, s83, 1
    v_add_u32 v2, s70, v15
    s_waitcnt vmcnt(16)
    s_barrier
    s_cmp_lt_u32 s3, 4
    s_cbranch_scc1 nold_110
    s_mov_b32 s99, 12
    s_cmp_gt_u32 s75, s76
    s_cbranch_scc1 wo_dma
    s_cmp_lt_u32 s75, s76
    s_cselect_b32 s84, s73, 1073741824
    s_mov_b32 s85, s74
    s_mov_b32 m0, s91
    s_add_u32 s73, s73, 16384
    buffer_load_dwordx4 v15, s[8:11], s84 offen offset:0 sc1 lds
    buffer_load_dwordx4 v15, s[8:11], s84 offen offset:1024 sc1 lds
    buffer_load_dwordx4 v15, s[8:11], s84 offen offset:2048 sc1 lds
    buffer_load_dwordx4 v15, s[8:11], s84 offen offset:3072 sc1 lds
    s_add_u32 m0, s91, 16384
    s_add_u32 s74, s74, 16384
    buffer_load_dwordx4 v15, s[8:11], s85 offen offset:0 sc1 lds
    buffer_load_dwordx4 v15, s[8:11], s85 offen offset:1024 sc1 lds
    buffer_load_dwordx4 v15, s[8:11], s85 offen offset:2048 sc1 lds
    buffer_load_dwordx4 v15, s[8:11], s85 offen offset:3072 sc1 lds
wor_111:
    s_add_u32 s75, s75, 1
    s_add_u32 s91, s91, 32768
    s_cmp_ge_u32 s91, 163840
    s_cselect_b32 s91, s77, s91
nold_110:
    v_mul_f32 v80, v80, v84
    v_mul_f32 v81, v81, v84
    v_mul_f32 v82, v82, v84
    v_mul_f32 v83, v83, v84
    v_cvt_pk_bf16_f32 v144, v80, v81
    v_cvt_pk_bf16_f32 v145, v82, v83
    v_mul_f32 v88, v88, v92
    v_mul_f32 v89, v89, v92
    v_mul_f32 v90, v90, v92
    v_mul_f32 v91, v91, v92
    v_cvt_pk_bf16_f32 v146, v88, v89
    v_cvt_pk_bf16_f32 v147, v90, v91
    buffer_store_dwordx4 v[144:147], v15, s[8:11], s59 offen sc1
    s_add_u32 s59, s59, 16384
    v_mul_f32 v96, v96, v100
    v_mul_f32 v97, v97, v100
    v_mul_f32 v98, v98, v100
    v_mul_f32 v99, v99, v100
    v_cvt_pk_bf16_f32 v148, v96, v97
    v_cvt_pk_bf16_f32 v149, v98, v99
    v_mul_f32 v104, v104, v108
    v_mul_f32 v105, v105, v108
    v_mul_f32 v106, v106, v108
    v_mul_f32 v107, v107, v108
    v_cvt_pk_bf16_f32 v150, v104, v105
    v_cvt_pk_bf16_f32 v151, v106, v107
    buffer_store_dwordx4 v[148:151], v15, s[8:11], s59 offen sc1
    s_add_u32 s59, s59, 16384
    v_mul_f32 v112, v112, v116
    v_mul_f32 v113, v113, v116
    v_mul_f32 v114, v114, v116
    v_mul_f32 v115, v115, v116
    v_cvt_pk_bf16_f32 v152, v112, v113
    v_cvt_pk_bf16_f32 v153, v114, v115
    v_mul_f32 v120, v120, v124
    v_mul_f32 v121, v121, v124
    v_mul_f32 v122, v122, v124
    v_mul_f32 v123, v123, v124
    v_cvt_pk_bf16_f32 v154, v120, v121
    v_cvt_pk_bf16_f32 v155, v122, v123
    buffer_store_dwordx4 v[152:155], v15, s[8:11], s59 offen sc1
    s_add_u32 s59, s59, 16384
    v_mul_f32 v128, v128, v132
    v_mul_f32 v129, v129, v132
    v_mul_f32 v130, v130, v132
    v_mul_f32 v131, v131, v132
    v_cvt_pk_bf16_f32 v156, v128, v129
    v_cvt_pk_bf16_f32 v157, v130, v131
    v_mul_f32 v136, v136, v140
    v_mul_f32 v137, v137, v140
    v_mul_f32 v138, v138, v140
    v_mul_f32 v139, v139, v140
    v_cvt_pk_bf16_f32 v158, v136, v137
    v_cvt_pk_bf16_f32 v159, v138, v139
    buffer_store_dwordx4 v[156:159], v15, s[8:11], s59 offen sc1
    s_add_u32 s59, s59, 16384
    s_branch idle16
idle_r2:
    s_cmp_lg_u32 s96, 1
    s_cbranch_scc1 idle16
    s_cmp_lg_u32 s83, 16
    s_cbranch_scc1 idle16
    s_lshl_b32 s56, s4, 16
    s_add_u32 s56, s56, s61
    s_add_u32 s56, s56, 65011712
    s_cmp_lt_u32 s65, 2
    s_cselect_b32 s57, -1, 0x300
    v_and_b32 v16, s57, v15
    buffer_load_dwordx4 v[32:35], v16, s[8:11], s56 offen sc1
    s_add_u32 s56, s56, 4096
    buffer_load_dwordx4 v[36:39], v16, s[8:11], s56 offen sc1
    s_add_u32 s56, s56, 4096
    buffer_load_dwordx4 v[40:43], v16, s[8:11], s56 offen sc1
    s_add_u32 s56, s56, 4096
    buffer_load_dwordx4 v[44:47], v16, s[8:11], s56 offen sc1
    s_add_u32 s56, s56, 4096
    buffer_load_dwordx4 v[48:51], v16, s[8:11], s56 offen sc1
    s_add_u32 s56, s56, 4096
    buffer_load_dwordx4 v[52:55], v16, s[8:11], s56 offen sc1
    s_add_u32 s56, s56, 4096
    buffer_load_dwordx4 v[56:59], v16, s[8:11], s56 offen sc1
    s_add_u32 s56, s56, 4096
    buffer_load_dwordx4 v[60:63], v16, s[8:11], s56 offen sc1
    s_add_u32 s56, s56, 4096
    buffer_load_dwordx4 v[64:67], v16, s[8:11], s56 offen sc1
    s_add_u32 s56, s56, 4096
    buffer_load_dwordx4 v[68:71], v16, s[8:11], s56 offen sc1
    s_add_u32 s56, s56, 4096
    buffer_load_dwordx4 v[72:75], v16, s[8:11], s56 offen sc1
    s_add_u32 s56, s56, 4096
    buffer_load_dwordx4 v[76:79], v16, s[8:11], s56 offen sc1
    s_add_u32 s56, s56, 4096
    buffer_load_dwordx4 v[80:83], v16, s[8:11], s56 offen sc1
    s_add_u32 s56, s56, 4096
    buffer_load_dwordx4 v[84:87], v16, s[8:11], s56 offen sc1
    s_add_u32 s56, s56, 4096
    buffer_load_dwordx4 v[88:91], v16, s[8:11], s56 offen sc1
    s_add_u32 s56, s56, 4096
    buffer_load_dwordx4 v[92:95], v16, s[8:11], s56 offen sc1
    s_add_u32 s56, s56, 4096
    s_add_u32 s70, s70, 32768
    s_cmp_ge_u32 s70, 163840
    s_cselect_b32 s70, 0, s70
    s_add_u32 s83, s83, 1
    v_add_u32 v2, s70, v15
    s_waitcnt vmcnt(32)
    s_barrier
    s_cmp_lt_u32 s3, 4
    s_cbranch_scc1 nold_112
    s_mov_b32 s99, 13
    s_cmp_gt_u32 s75, s76
    s_cbranch_scc1 wo_dma
    s_cmp_lt_u32 s75, s76
    s_cselect_b32 s84, s73, 1073741824
    s_mov_b32 s85, s74
    s_mov_b32 m0, s91
    s_add_u32 s73, s73, 16384
    buffer_load_dwordx4 v15, s[8:11], s84 offen offset:0 sc1 lds
    buffer_load_dwordx4 v15, s[8:11], s84 offen offset:1024 sc1 lds
    buffer_load_dwordx4 v15, s[8:11], s84 offen offset:2048 sc1 lds
    buffer_load_dwordx4 v15, s[8:11], s84 offen offset:3072 sc1 lds
    s_add_u32 m0, s91, 16384
    s_add_u32 s74, s74, 16384
    buffer_load_dwordx4 v15, s[8:11], s85 offen offset:0 sc1 lds
    buffer_load_dwordx4 v15, s[8:11], s85 offen offset:1024 sc1 lds
    buffer_load_dwordx4 v15, s[8:11], s85 offen offset:2048 sc1 lds
    buffer_load_dwordx4 v15, s[8:11], s85 offen offset:3072 sc1 lds
wor_113:
    s_add_u32 s75, s75, 1
    s_add_u32 s91, s91, 32768
    s_cmp_ge_u32 s91, 163840
    s_cselect_b32 s91, s77, s91
nold_112:
    s_add_u32 s70, s70, 32768
    s_cmp_ge_u32 s70, 163840
    s_cselect_b32 s70, 0, s70
    s_add_u32 s83, s83, 1
    v_add_u32 v2, s70, v15
    s_waitcnt vmcnt(32)
    s_barrier
    s_cmp_lt_u32 s3, 4
    s_cbranch_scc1 nold_114
    s_mov_b32 s99, 14
    s_cmp_gt_u32 s75, s76
    s_cbranch_scc1 wo_dma
    s_cmp_lt_u32 s75, s76
    s_cselect_b32 s84, s73, 1073741824
    s_mov_b32 s85, s74
    s_mov_b32 m0, s91
    s_add_u32 s73, s73, 16384
    buffer_load_dwordx4 v15, s[8:11], s84 offen offset:0 sc1 lds
    buffer_load_dwordx4 v15, s[8:11], s84 offen offset:1024 sc1 lds
    buffer_load_dwordx4 v15, s[8:11], s84 offen offset:2048 sc1 lds
    buffer_load_dwordx4 v15, s[8:11], s84 offen offset:3072 sc1 lds
    s_add_u32 m0, s91, 16384
    s_add_u32 s74, s74, 16384
    buffer_load_dwordx4 v15, s[8:11], s85 offen offset:0 sc1 lds
    buffer_load_dwordx4 v15, s[8:11], s85 offen offset:1024 sc1 lds
    buffer_load_dwordx4 v15, s[8:11], s85 offen offset:2048 sc1 lds
    buffer_load_dwordx4 v15, s[8:11], s85 offen offset:3072 sc1 lds
wor_115:
    s_add_u32 s75, s75, 1
    s_add_u32 s91, s91, 32768
    s_cmp_ge_u32 s91, 163840
    s_cselect_b32 s91, s77, s91
nold_114:
    s_waitcnt vmcnt(16)
    v_pk_add_f32 v[32:33], v[32:33], v[64:65]
    v_pk_add_f32 v[34:35], v[34:35], v[66:67]
    v_pk_add_f32 v[36:37], v[36:37], v[68:69]
    v_pk_add_f32 v[38:39], v[38:39], v[70:71]
    v_pk_add_f32 v[40:41], v[40:41], v[72:73]
    v_pk_add_f32 v[42:43], v[42:43], v[74:75]
    v_pk_add_f32 v[44:45], v[44:45], v[76:77]
    v_pk_add_f32 v[46:47], v[46:47], v[78:79]
    v_pk_add_f32 v[48:49], v[48:49], v[80:81]
    v_pk_add_f32 v[50:51], v[50:51], v[82:83]
    v_pk_add_f32 v[52:53], v[52:53], v[84:85]
    v_pk_add_f32 v[54:55], v[54:55], v[86:87]
    v_pk_add_f32 v[56:57], v[56:57], v[88:89]
    v_pk_add_f32 v[58:59], v[58:59], v[90:91]
    v_pk_add_f32 v[60:61], v[60:61], v[92:93]
    v_pk_add_f32 v[62:63], v[62:63], v[94:95]
    v_pk_add_f32 v[32:33], v[32:33], v[48:49]
    v_pk_add_f32 v[34:35], v[34:35], v[50:51]
    v_pk_add_f32 v[36:37], v[36:37], v[52:53]
    v_pk_add_f32 v[38:39], v[38:39], v[54:55]
    v_pk_add_f32 v[40:41], v[40:41], v[56:57]
    v_pk_add_f32 v[42:43], v[42:43], v[58:59]
    v_pk_add_f32 v[44:45], v[44:45], v[60:61]
    v_pk_add_f32 v[46:47], v[46:47], v[62:63]
    v_pk_add_f32 v[32:33], v[32:33], v[40:41]
    v_pk_add_f32 v[34:35], v[34:35], v[42:43]
    v_pk_add_f32 v[36:37], v[36:37], v[44:45]
    v_pk_add_f32 v[38:39], v[38:39], v[46:47]
    v_pk_add_f32 v[32:33], v[32:33], v[36:37]
    v_pk_add_f32 v[34:35], v[34:35], v[38:39]
    v_cvt_pk_bf16_f32 v36, v32, v33
    v_cvt_pk_bf16_f32 v37, v34, v35
    s_lshl_b32 s56, s4, 1
    s_lshr_b32 s57, s65, 1
    s_add_u32 s56, s56, s57
    s_lshl_b32 s56, s56, 10
    s_and_b32 s57, s65, 1
    s_lshl_b32 s57, s57, 3
    s_add_u32 s56, s56, s57
    s_add_u32 s56, s56, 55574528
    buffer_store_dwordx2 v[36:37], v15, s[8:11], s56 offen sc1
    s_branch idle16
s_pre:
    s_mov_b32 s30, s70
    s_setprio 2
    s_add_u32 s70, s70, 32768
    s_cmp_ge_u32 s70, 163840
    s_cselect_b32 s70, 0, s70
    s_add_u32 s83, s83, 1
    v_add_u32 v2, s70, v15
    s_waitcnt vmcnt(16)
    s_barrier
    s_cmp_lt_u32 s3, 4
    s_cbranch_scc1 nold_116
    s_mov_b32 s99, 15
    s_cmp_gt_u32 s75, s76
    s_cbranch_scc1 wo_dma
    s_cmp_lt_u32 s75, s76
    s_cselect_b32 s84, s73, 1073741824
    s_mov_b32 s85, s74
    s_mov_b32 m0, s91
    s_add_u32 s73, s73, 16384
    buffer_load_dwordx4 v15, s[8:11], s84 offen offset:0 sc1 lds
    buffer_load_dwordx4 v15, s[8:11], s84 offen offset:1024 sc1 lds
    buffer_load_dwordx4 v15, s[8:11], s84 offen offset:2048 sc1 lds
    buffer_load_dwordx4 v15, s[8:11], s84 offen offset:3072 sc1 lds
    s_add_u32 m0, s91, 16384
    s_add_u32 s74, s74, 16384
    buffer_load_dwordx4 v15, s[8:11], s85 offen offset:0 sc1 lds
    buffer_load_dwordx4 v15, s[8:11], s85 offen offset:1024 sc1 lds
    buffer_load_dwordx4 v15, s[8:11], s85 offen offset:2048 sc1 lds
    buffer_load_dwordx4 v15, s[8:11], s85 offen offset:3072 sc1 lds
wor_117:
    s_add_u32 s75, s75, 1
    s_add_u32 s91, s91, 32768
    s_cmp_ge_u32 s91, 163840
    s_cselect_b32 s91, s77, s91
nold_116:
    s_cmp_lg_u32 s28, 0
    s_cbranch_scc1 pub_done
    s_waitcnt vmcnt(8)
    s_lshl_b32 s56, s2, 3
    s_add_u32 s56, s56, s3
    s_lshl_b32 s56, s56, 7
    s_add_u32 s56, s56, 68681728
    v_mov_b32 v19, 1
    s_mov_b64 exec, 1
    buffer_store_dword v19, off, s[8:11], s56 sc1
    s_mov_b64 exec, -1
    s_mov_b32 s28, 1
pub_done:
    s_mov_b32 s31, s70
    s_add_u32 s56, s30, 32720
    v_mov_b32 v17, s56
    v_mov_b32 v24, 0
    v_mov_b32 v25, 0
    v_mov_b32 v26, 0
    v_mov_b32 v27, 0
    ds_write_b128 v17, v[24:27]
    ds_write_b128 v17, v[24:27] offset:32
    s_waitcnt lgkmcnt(0)
tail_gemm:
    v_lshrrev_b32 v5, 2, v0
    v_and_b32 v6, 7, v5
    v_lshlrev_b32 v4, 8, v5
    v_lshl_or_b32 v4, v6, 5, v4
    v_and_b32 v6, 3, v0
    v_lshl_or_b32 v4, v6, 3, v4
    v_add_u32 v4, s70, v4
    v_xor_b32 v5, 32, v4
    v_xor_b32 v6, 64, v4
    v_xor_b32 v7, 96, v4
    v_xor_b32 v8, 128, v4
    v_xor_b32 v9, 160, v4
    v_xor_b32 v10, 192, v4
    v_xor_b32 v11, 224, v4
    s_cmp_ge_u32 s3, 4
    s_cbranch_scc1 tail_c0
    s_sub_u32 s30, s70, 32768
    s_cselect_b32 s30, 131072, s30
    s_waitcnt vmcnt(0)
    s_lshl_b32 s56, s2, 3
    s_add_u32 s56, s56, s3
    s_lshl_b32 s56, s56, 7
    s_add_u32 s56, s56, 68681728
    v_mov_b32 v19, 1
    s_mov_b64 exec, 1
    buffer_store_dword v19, off, s[8:11], s56 sc1
    s_mov_b64 exec, -1
    s_barrier
    s_mov_b32 s67, 0
wp_118:
    s_andn2_b32 s56, s2, 24
    s_lshl_b32 s56, s56, 3
    s_add_u32 s56, s56, s3
    s_lshl_b32 s56, s56, 7
    s_add_u32 s56, s56, 68681728
    v_lshlrev_b32 v17, 13, v0
    s_mov_b64 exec, 15
    buffer_load_dword v18, v17, s[8:11], s56 offen sc1
    s_mov_b64 exec, -1
    s_add_u32 s67, s67, 1
    s_waitcnt vmcnt(0)
    v_cmp_gt_i32 vcc, 1, v18
    s_nop 0
    s_and_b32 s56, vcc_lo, 15
    s_cbranch_scc0 wok_119
    s_sleep 1
    s_cmp_lt_u32 s67, 800000
    s_cbranch_scc1 wp_118
wok_119:
    s_add_u32 s56, s80, 1
    s_and_b32 s56, s56, 3
    s_sub_u32 s56, s56, s80
    s_lshl_b32 s56, s56, 20
    s_add_u32 s56, s56, s81
    s_add_u32 s57, s56, 4096
    buffer_load_dwordx4 v[32:35], v15, s[8:11], s56 offen offset:0 sc1
    buffer_load_dwordx4 v[36:39], v15, s[8:11], s56 offen offset:1024 sc1
    buffer_load_dwordx4 v[40:43], v15, s[8:11], s56 offen offset:2048 sc1
    buffer_load_dwordx4 v[44:47], v15, s[8:11], s56 offen offset:3072 sc1
    buffer_load_dwordx4 v[48:51], v15, s[8:11], s57 offen offset:0 sc1
    buffer_load_dwordx4 v[52:55], v15, s[8:11], s57 offen offset:1024 sc1
    buffer_load_dwordx4 v[56:59], v15, s[8:11], s57 offen offset:2048 sc1
    buffer_load_dwordx4 v[60:63], v15, s[8:11], s57 offen offset:3072 sc1
    s_add_u32 s56, s80, 2
    s_and_b32 s56, s56, 3
    s_sub_u32 s56, s56, s80
    s_lshl_b32 s56, s56, 20
    s_add_u32 s56, s56, s81
    s_add_u32 s57, s56, 4096
    buffer_load_dwordx4 v[64:67], v15, s[8:11], s56 offen offset:0 sc1
    buffer_load_dwordx4 v[68:71], v15, s[8:11], s56 offen offset:1024 sc1
    buffer_load_dwordx4 v[72:75], v15, s[8:11], s56 offen offset:2048 sc1
    buffer_load_dwordx4 v[76:79], v15, s[8:11], s56 offen offset:3072 sc1
    buffer_load_dwordx4 v[80:83], v15, s[8:11], s57 offen offset:0 sc1
    buffer_load_dwordx4 v[84:87], v15, s[8:11], s57 offen offset:1024 sc1
    buffer_load_dwordx4 v[88:91], v15, s[8:11], s57 offen offset:2048 sc1
    buffer_load_dwordx4 v[92:95], v15, s[8:11], s57 offen offset:3072 sc1
    s_add_u32 s56, s80, 3
    s_and_b32 s56, s56, 3
    s_sub_u32 s56, s56, s80
    s_lshl_b32 s56, s56, 20
    s_add_u32 s56, s56, s81
    s_add_u32 s57, s56, 4096
    buffer_load_dwordx4 v[96:99], v15, s[8:11], s56 offen offset:0 sc1
    buffer_load_dwordx4 v[100:103], v15, s[8:11], s56 offen offset:1024 sc1
    buffer_load_dwordx4 v[104:107], v15, s[8:11], s56 offen offset:2048 sc1
    buffer_load_dwordx4 v[108:111], v15, s[8:11], s56 offen offset:3072 sc1
    buffer_load_dwordx4 v[112:115], v15, s[8:11], s57 offen offset:0 sc1
    buffer_load_dwordx4 v[116:119], v15, s[8:11], s57 offen offset:1024 sc1
    buffer_load_dwordx4 v[120:123], v15, s[8:11], s57 offen offset:2048 sc1
    buffer_load_dwordx4 v[124:127], v15, s[8:11], s57 offen offset:3072 sc1
    s_mov_b32 s29, 1
tail_c0:
    ds_read_b64_tr_b16 v[224:225], v4 offset:0
    ds_read_b64_tr_b16 v[226:227], v4 offset:4096
    ds_read_b64_tr_b16 v[228:229], v4 offset:8192
    ds_read_b64_tr_b16 v[230:231], v4 offset:12288
    ds_read_b64_tr_b16 v[232:233], v5 offset:0
    ds_read_b64_tr_b16 v[234:235], v5 offset:4096
    ds_read_b64_tr_b16 v[236:237], v5 offset:8192
    ds_read_b64_tr_b16 v[238:239], v5 offset:12288
    ds_read_b64_tr_b16 v[240:241], v6 offset:0
    ds_read_b64_tr_b16 v[242:243], v6 offset:4096
    ds_read_b64_tr_b16 v[244:245], v6 offset:8192
    ds_read_b64_tr_b16 v[246:247], v6 offset:12288
    ds_read_b64_tr_b16 v[248:249], v7 offset:0
    ds_read_b64_tr_b16 v[250:251], v7 offset:4096
    ds_read_b64_tr_b16 v[252:253], v7 offset:8192
    ds_read_b64_tr_b16 v[254:255], v7 offset:12288
    s_mov_b32 s64, s70
    s_add_u32 s70, s70, 32768
    s_cmp_ge_u32 s70, 163840
    s_cselect_b32 s70, 0, s70
    s_add_u32 s83, s83, 1
    s_sub_u32 s64, s70, s64
    s_waitcnt lgkmcnt(12)
    v_mfma_f32_16x16x32_bf16 v[128:131], v[224:227], v[192:195], 0
    v_mfma_f32_16x16x32_bf16 v[128:131], v[228:231], v[200:203], v[128:131]
    v_mfma_f32_16x16x32_bf16 v[136:139], v[228:231], v[204:207], 0
    v_mfma_f32_16x16x32_bf16 v[136:139], v[224:227], v[196:199], v[136:139]
    s_waitcnt lgkmcnt(8)
    v_mfma_f32_16x16x32_bf16 v[140:143], v[232:235], v[196:199], 0
    ds_read_b64_tr_b16 v[224:225], v8 offset:0
    v_mfma_f32_16x16x32_bf16 v[140:143], v[236:239], v[204:207], v[140:143]
    ds_read_b64_tr_b16 v[226:227], v8 offset:4096
    v_mfma_f32_16x16x32_bf16 v[132:135], v[236:239], v[200:203], 0
    ds_read_b64_tr_b16 v[228:229], v8 offset:8192
    v_mfma_f32_16x16x32_bf16 v[132:135], v[232:235], v[192:195], v[132:135]
    ds_read_b64_tr_b16 v[230:231], v8 offset:12288
    s_waitcnt lgkmcnt(8)
    v_mfma_f32_16x16x32_bf16 v[144:147], v[240:243], v[192:195], 0
    ds_read_b64_tr_b16 v[232:233], v9 offset:0
    v_mfma_f32_16x16x32_bf16 v[144:147], v[244:247], v[200:203], v[144:147]
    ds_read_b64_tr_b16 v[234:235], v9 offset:4096
    v_mfma_f32_16x16x32_bf16 v[152:155], v[244:247], v[204:207], 0
    ds_read_b64_tr_b16 v[236:237], v9 offset:8192
    v_mfma_f32_16x16x32_bf16 v[152:155], v[240:243], v[196:199], v[152:155]
    ds_read_b64_tr_b16 v[238:239], v9 offset:12288
    s_waitcnt lgkmcnt(8)
    v_mfma_f32_16x16x32_bf16 v[156:159], v[248:251], v[196:199], 0
    ds_read_b64_tr_b16 v[240:241], v10 offset:0
    v_mfma_f32_16x16x32_bf16 v[156:159], v[252:255], v[204:207], v[156:159]
    ds_read_b64_tr_b16 v[242:243], v10 offset:4096
    v_mfma_f32_16x16x32_bf16 v[148:151], v[252:255], v[200:203], 0
    ds_read_b64_tr_b16 v[244:245], v10 offset:8192
    v_mfma_f32_16x16x32_bf16 v[148:151], v[248:251], v[192:195], v[148:151]
    ds_read_b64_tr_b16 v[246:247], v10 offset:12288
    s_waitcnt lgkmcnt(8)
    v_mfma_f32_16x16x32_bf16 v[160:163], v[224:227], v[192:195], 0
    ds_read_b64_tr_b16 v[248:249], v11 offset:0
    v_mfma_f32_16x16x32_bf16 v[160:163], v[228:231], v[200:203], v[160:163]
    ds_read_b64_tr_b16 v[250:251], v11 offset:4096
    v_mfma_f32_16x16x32_bf16 v[168:171], v[228:231], v[204:207], 0
    ds_read_b64_tr_b16 v[252:253], v11 offset:8192
    v_mfma_f32_16x16x32_bf16 v[168:171], v[224:227], v[196:199], v[168:171]
    ds_read_b64_tr_b16 v[254:255], v11 offset:12288
    s_waitcnt lgkmcnt(8)
    v_mfma_f32_16x16x32_bf16 v[172:175], v[232:235], v[196:199], 0
    ds_read_b64_tr_b16 v[224:225], v4 offset:16384
    v_mfma_f32_16x16x32_bf16 v[172:175], v[236:239], v[204:207], v[172:175]
    ds_read_b64_tr_b16 v[226:227], v4 offset:20480
    v_mfma_f32_16x16x32_bf16 v[164:167], v[236:239], v[200:203], 0
    ds_read_b64_tr_b16 v[228:229], v4 offset:24576
    v_mfma_f32_16x16x32_bf16 v[164:167], v[232:235], v[192:195], v[164:167]
    ds_read_b64_tr_b16 v[230:231], v4 offset:28672
    v_add_u32 v4, s64, v4
    s_waitcnt lgkmcnt(8)
    v_mfma_f32_16x16x32_bf16 v[176:179], v[240:243], v[192:195], 0
    ds_read_b64_tr_b16 v[232:233], v5 offset:16384
    v_mfma_f32_16x16x32_bf16 v[176:179], v[244:247], v[200:203], v[176:179]
    ds_read_b64_tr_b16 v[234:235], v5 offset:20480
    v_mfma_f32_16x16x32_bf16 v[184:187], v[244:247], v[204:207], 0
    ds_read_b64_tr_b16 v[236:237], v5 offset:24576
    v_mfma_f32_16x16x32_bf16 v[184:187], v[240:243], v[196:199], v[184:187]
    ds_read_b64_tr_b16 v[238:239], v5 offset:28672
    v_add_u32 v5, s64, v5
    s_waitcnt lgkmcnt(8)
    v_mfma_f32_16x16x32_bf16 v[188:191], v[248:251], v[196:199], 0
    ds_read_b64_tr_b16 v[240:241], v6 offset:16384
    v_mfma_f32_16x16x32_bf16 v[188:191], v[252:255], v[204:207], v[188:191]
    ds_read_b64_tr_b16 v[242:243], v6 offset:20480
    v_mfma_f32_16x16x32_bf16 v[180:183], v[252:255], v[200:203], 0
    ds_read_b64_tr_b16 v[244:245], v6 offset:24576
    v_mfma_f32_16x16x32_bf16 v[180:183], v[248:251], v[192:195], v[180:183]
    ds_read_b64_tr_b16 v[246:247], v6 offset:28672
    v_add_u32 v6, s64, v6
    s_waitcnt lgkmcnt(8)
    v_mfma_f32_16x16x32_bf16 v[128:131], v[224:227], v[208:211], v[128:131]
    ds_read_b64_tr_b16 v[248:249], v7 offset:16384
    v_mfma_f32_16x16x32_bf16 v[128:131], v[228:231], v[216:219], v[128:131]
    ds_read_b64_tr_b16 v[250:251], v7 offset:20480
    v_mfma_f32_16x16x32_bf16 v[136:139], v[228:231], v[220:223], v[136:139]
    ds_read_b64_tr_b16 v[252:253], v7 offset:24576
    v_mfma_f32_16x16x32_bf16 v[136:139], v[224:227], v[212:215], v[136:139]
    ds_read_b64_tr_b16 v[254:255], v7 offset:28672
    v_add_u32 v7, s64, v7
    s_waitcnt lgkmcnt(8)
    v_mfma_f32_16x16x32_bf16 v[140:143], v[232:235], v[212:215], v[140:143]
    ds_read_b64_tr_b16 v[224:225], v8 offset:16384
    v_mfma_f32_16x16x32_bf16 v[140:143], v[236:239], v[220:223], v[140:143]
    ds_read_b64_tr_b16 v[226:227], v8 offset:20480
    v_mfma_f32_16x16x32_bf16 v[132:135], v[236:239], v[216:219], v[132:135]
    ds_read_b64_tr_b16 v[228:229], v8 offset:24576
    v_mfma_f32_16x16x32_bf16 v[132:135], v[232:235], v[208:211], v[132:135]
    ds_read_b64_tr_b16 v[230:231], v8 offset:28672
    v_add_u32 v8, s64, v8
    s_waitcnt lgkmcnt(8)
    v_mfma_f32_16x16x32_bf16 v[144:147], v[240:243], v[208:211], v[144:147]
    ds_read_b64_tr_b16 v[232:233], v9 offset:16384
    v_mfma_f32_16x16x32_bf16 v[144:147], v[244:247], v[216:219], v[144:147]
    ds_read_b64_tr_b16 v[234:235], v9 offset:20480
    v_mfma_f32_16x16x32_bf16 v[152:155], v[244:247], v[220:223], v[152:155]
    ds_read_b64_tr_b16 v[236:237], v9 offset:24576
    v_mfma_f32_16x16x32_bf16 v[152:155], v[240:243], v[212:215], v[152:155]
    ds_read_b64_tr_b16 v[238:239], v9 offset:28672
    v_add_u32 v9, s64, v9
    s_waitcnt lgkmcnt(8)
    v_mfma_f32_16x16x32_bf16 v[156:159], v[248:251], v[212:215], v[156:159]
    ds_read_b64_tr_b16 v[240:241], v10 offset:16384
    v_mfma_f32_16x16x32_bf16 v[156:159], v[252:255], v[220:223], v[156:159]
    ds_read_b64_tr_b16 v[242:243], v10 offset:20480
    v_mfma_f32_16x16x32_bf16 v[148:151], v[252:255], v[216:219], v[148:151]
    ds_read_b64_tr_b16 v[244:245], v10 offset:24576
    v_mfma_f32_16x16x32_bf16 v[148:151], v[248:251], v[208:211], v[148:151]
    ds_read_b64_tr_b16 v[246:247], v10 offset:28672
    v_add_u32 v10, s64, v10
    s_waitcnt lgkmcnt(8)
    v_mfma_f32_16x16x32_bf16 v[160:163], v[224:227], v[208:211], v[160:163]
    ds_read_b64_tr_b16 v[248:249], v11 offset:16384
    v_mfma_f32_16x16x32_bf16 v[160:163], v[228:231], v[216:219], v[160:163]
    ds_read_b64_tr_b16 v[250:251], v11 offset:20480
    v_mfma_f32_16x16x32_bf16 v[168:171], v[228:231], v[220:223], v[168:171]
    ds_read_b64_tr_b16 v[252:253], v11 offset:24576
    v_mfma_f32_16x16x32_bf16 v[168:171], v[224:227], v[212:215], v[168:171]
    ds_read_b64_tr_b16 v[254:255], v11 offset:28672
    v_add_u32 v11, s64, v11
    s_waitcnt lgkmcnt(8)
    v_mfma_f32_16x16x32_bf16 v[172:175], v[232:235], v[212:215], v[172:175]
    v_mfma_f32_16x16x32_bf16 v[172:175], v[236:239], v[220:223], v[172:175]
    v_mfma_f32_16x16x32_bf16 v[164:167], v[236:239], v[216:219], v[164:167]
    v_mfma_f32_16x16x32_bf16 v[164:167], v[232:235], v[208:211], v[164:167]
    s_waitcnt lgkmcnt(4)
    v_mfma_f32_16x16x32_bf16 v[176:179], v[240:243], v[208:211], v[176:179]
    v_mfma_f32_16x16x32_bf16 v[176:179], v[244:247], v[216:219], v[176:179]
    v_mfma_f32_16x16x32_bf16 v[184:187], v[244:247], v[220:223], v[184:187]
    v_mfma_f32_16x16x32_bf16 v[184:187], v[240:243], v[212:215], v[184:187]
    s_waitcnt lgkmcnt(0)
    v_mfma_f32_16x16x32_bf16 v[188:191], v[248:251], v[212:215], v[188:191]
    v_mfma_f32_16x16x32_bf16 v[188:191], v[252:255], v[220:223], v[188:191]
    v_mfma_f32_16x16x32_bf16 v[180:183], v[252:255], v[216:219], v[180:183]
    v_mfma_f32_16x16x32_bf16 v[180:183], v[248:251], v[208:211], v[180:183]
    s_cmp_lt_u32 s3, 4
    s_cbranch_scc1 tail_b2
    s_waitcnt vmcnt(0)
    s_barrier
tail_b2:
    s_nop 0
    s_lshl_b32 s56, s3, 2
    s_add_u32 s56, s56, s30
    s_add_u32 s56, s56, 32720
    v_mov_b32 v17, s56
    v_mov_b32 v19, 1
    ds_write_b32 v17, v19
    s_waitcnt lgkmcnt(0)
    ds_read_b64_tr_b16 v[224:225], v4 offset:0
    ds_read_b64_tr_b16 v[226:227], v4 offset:4096
    ds_read_b64_tr_b16 v[228:229], v4 offset:8192
    ds_read_b64_tr_b16 v[230:231], v4 offset:12288
    ds_read_b64_tr_b16 v[232:233], v5 offset:0
    ds_read_b64_tr_b16 v[234:235], v5 offset:4096
    ds_read_b64_tr_b16 v[236:237], v5 offset:8192
    ds_read_b64_tr_b16 v[238:239], v5 offset:12288
    ds_read_b64_tr_b16 v[240:241], v6 offset:0
    ds_read_b64_tr_b16 v[242:243], v6 offset:4096
    ds_read_b64_tr_b16 v[244:245], v6 offset:8192
    ds_read_b64_tr_b16 v[246:247], v6 offset:12288
    ds_read_b64_tr_b16 v[248:249], v7 offset:0
    ds_read_b64_tr_b16 v[250:251], v7 offset:4096
    ds_read_b64_tr_b16 v[252:253], v7 offset:8192
    ds_read_b64_tr_b16 v[254:255], v7 offset:12288
    s_cmp_lg_u32 s29, 0
    s_cbranch_scc1 tail_have
    s_mov_b32 s67, 0
wp_120:
    s_andn2_b32 s56, s2, 24
    s_lshl_b32 s56, s56, 3
    s_add_u32 s56, s56, s3
    s_lshl_b32 s56, s56, 7
    s_add_u32 s56, s56, 68681728
    v_lshlrev_b32 v17, 13, v0
    s_mov_b64 exec, 15
    buffer_load_dword v18, v17, s[8:11], s56 offen sc1
    s_mov_b64 exec, -1
    s_add_u32 s67, s67, 1
    s_waitcnt vmcnt(0)
    v_cmp_gt_i32 vcc, 1, v18
    s_nop 0
    s_and_b32 s56, vcc_lo, 15
    s_cbranch_scc0 wok_121
    s_sleep 1
    s_cmp_lt_u32 s67, 800000
    s_cbranch_scc1 wp_120
wok_121:
    s_add_u32 s56, s80, 1
    s_and_b32 s56, s56, 3
    s_sub_u32 s56, s56, s80
    s_lshl_b32 s56, s56, 20
    s_add_u32 s56, s56, s81
    s_add_u32 s57, s56, 4096
    buffer_load_dwordx4 v[32:35], v15, s[8:11], s56 offen offset:0 sc1
    buffer_load_dwordx4 v[36:39], v15, s[8:11], s56 offen offset:1024 sc1
    buffer_load_dwordx4 v[40:43], v15, s[8:11], s56 offen offset:2048 sc1
    buffer_load_dwordx4 v[44:47], v15, s[8:11], s56 offen offset:3072 sc1
    buffer_load_dwordx4 v[48:51], v15, s[8:11], s57 offen offset:0 sc1
    buffer_load_dwordx4 v[52:55], v15, s[8:11], s57 offen offset:1024 sc1
    buffer_load_dwordx4 v[56:59], v15, s[8:11], s57 offen offset:2048 sc1
    buffer_load_dwordx4 v[60:63], v15, s[8:11], s57 offen offset:3072 sc1
    s_add_u32 s56, s80, 2
    s_and_b32 s56, s56, 3
    s_sub_u32 s56, s56, s80
    s_lshl_b32 s56, s56, 20
    s_add_u32 s56, s56, s81
    s_add_u32 s57, s56, 4096
    buffer_load_dwordx4 v[64:67], v15, s[8:11], s56 offen offset:0 sc1
    buffer_load_dwordx4 v[68:71], v15, s[8:11], s56 offen offset:1024 sc1
    buffer_load_dwordx4 v[72:75], v15, s[8:11], s56 offen offset:2048 sc1
    buffer_load_dwordx4 v[76:79], v15, s[8:11], s56 offen offset:3072 sc1
    buffer_load_dwordx4 v[80:83], v15, s[8:11], s57 offen offset:0 sc1
    buffer_load_dwordx4 v[84:87], v15, s[8:11], s57 offen offset:1024 sc1
    buffer_load_dwordx4 v[88:91], v15, s[8:11], s57 offen offset:2048 sc1
    buffer_load_dwordx4 v[92:95], v15, s[8:11], s57 offen offset:3072 sc1
    s_add_u32 s56, s80, 3
    s_and_b32 s56, s56, 3
    s_sub_u32 s56, s56, s80
    s_lshl_b32 s56, s56, 20
    s_add_u32 s56, s56, s81
    s_add_u32 s57, s56, 4096
    buffer_load_dwordx4 v[96:99], v15, s[8:11], s56 offen offset:0 sc1
    buffer_load_dwordx4 v[100:103], v15, s[8:11], s56 offen offset:1024 sc1
    buffer_load_dwordx4 v[104:107], v15, s[8:11], s56 offen offset:2048 sc1
    buffer_load_dwordx4 v[108:111], v15, s[8:11], s56 offen offset:3072 sc1
    buffer_load_dwordx4 v[112:115], v15, s[8:11], s57 offen offset:0 sc1
    buffer_load_dwordx4 v[116:119], v15, s[8:11], s57 offen offset:1024 sc1
    buffer_load_dwordx4 v[120:123], v15, s[8:11], s57 offen offset:2048 sc1
    buffer_load_dwordx4 v[124:127], v15, s[8:11], s57 offen offset:3072 sc1
tail_have:
    s_waitcnt vmcnt(16)
    s_mov_b32 s64, s70
    s_add_u32 s70, s70, 32768
    s_cmp_ge_u32 s70, 163840
    s_cselect_b32 s70, 0, s70
    s_add_u32 s83, s83, 1
    s_sub_u32 s64, s70, s64
    s_waitcnt lgkmcnt(12)
    v_mfma_f32_16x16x32_bf16 v[128:131], v[224:227], v[32:35], v[128:131]
    v_mfma_f32_16x16x32_bf16 v[128:131], v[228:231], v[40:43], v[128:131]
    v_mfma_f32_16x16x32_bf16 v[136:139], v[228:231], v[44:47], v[136:139]
    v_mfma_f32_16x16x32_bf16 v[136:139], v[224:227], v[36:39], v[136:139]
    s_waitcnt lgkmcnt(8)
    v_mfma_f32_16x16x32_bf16 v[140:143], v[232:235], v[36:39], v[140:143]
    ds_read_b64_tr_b16 v[224:225], v8 offset:0
    v_mfma_f32_16x16x32_bf16 v[140:143], v[236:239], v[44:47], v[140:143]
    ds_read_b64_tr_b16 v[226:227], v8 offset:4096
    v_mfma_f32_16x16x32_bf16 v[132:135], v[236:239], v[40:43], v[132:135]
    ds_read_b64_tr_b16 v[228:229], v8 offset:8192
    v_mfma_f32_16x16x32_bf16 v[132:135], v[232:235], v[32:35], v[132:135]
    ds_read_b64_tr_b16 v[230:231], v8 offset:12288
    s_waitcnt lgkmcnt(8)
    v_mfma_f32_16x16x32_bf16 v[144:147], v[240:243], v[32:35], v[144:147]
    ds_read_b64_tr_b16 v[232:233], v9 offset:0
    v_mfma_f32_16x16x32_bf16 v[144:147], v[244:247], v[40:43], v[144:147]
    ds_read_b64_tr_b16 v[234:235], v9 offset:4096
    v_mfma_f32_16x16x32_bf16 v[152:155], v[244:247], v[44:47], v[152:155]
    ds_read_b64_tr_b16 v[236:237], v9 offset:8192
    v_mfma_f32_16x16x32_bf16 v[152:155], v[240:243], v[36:39], v[152:155]
    ds_read_b64_tr_b16 v[238:239], v9 offset:12288
    s_waitcnt lgkmcnt(8)
    v_mfma_f32_16x16x32_bf16 v[156:159], v[248:251], v[36:39], v[156:159]
    ds_read_b64_tr_b16 v[240:241], v10 offset:0
    v_mfma_f32_16x16x32_bf16 v[156:159], v[252:255], v[44:47], v[156:159]
    ds_read_b64_tr_b16 v[242:243], v10 offset:4096
    v_mfma_f32_16x16x32_bf16 v[148:151], v[252:255], v[40:43], v[148:151]
    ds_read_b64_tr_b16 v[244:245], v10 offset:8192
    v_mfma_f32_16x16x32_bf16 v[148:151], v[248:251], v[32:35], v[148:151]
    ds_read_b64_tr_b16 v[246:247], v10 offset:12288
    s_waitcnt lgkmcnt(8)
    v_mfma_f32_16x16x32_bf16 v[160:163], v[224:227], v[32:35], v[160:163]
    ds_read_b64_tr_b16 v[248:249], v11 offset:0
    v_mfma_f32_16x16x32_bf16 v[160:163], v[228:231], v[40:43], v[160:163]
    ds_read_b64_tr_b16 v[250:251], v11 offset:4096
    v_mfma_f32_16x16x32_bf16 v[168:171], v[228:231], v[44:47], v[168:171]
    ds_read_b64_tr_b16 v[252:253], v11 offset:8192
    v_mfma_f32_16x16x32_bf16 v[168:171], v[224:227], v[36:39], v[168:171]
    ds_read_b64_tr_b16 v[254:255], v11 offset:12288
    s_waitcnt lgkmcnt(8)
    v_mfma_f32_16x16x32_bf16 v[172:175], v[232:235], v[36:39], v[172:175]
    ds_read_b64_tr_b16 v[224:225], v4 offset:16384
    v_mfma_f32_16x16x32_bf16 v[172:175], v[236:239], v[44:47], v[172:175]
    ds_read_b64_tr_b16 v[226:227], v4 offset:20480
    v_mfma_f32_16x16x32_bf16 v[164:167], v[236:239], v[40:43], v[164:167]
    ds_read_b64_tr_b16 v[228:229], v4 offset:24576
    v_mfma_f32_16x16x32_bf16 v[164:167], v[232:235], v[32:35], v[164:167]
    ds_read_b64_tr_b16 v[230:231], v4 offset:28672
    v_add_u32 v4, s64, v4
    s_waitcnt lgkmcnt(8)
    v_mfma_f32_16x16x32_bf16 v[176:179], v[240:243], v[32:35], v[176:179]
    ds_read_b64_tr_b16 v[232:233], v5 offset:16384
    v_mfma_f32_16x16x32_bf16 v[176:179], v[244:247], v[40:43], v[176:179]
    ds_read_b64_tr_b16 v[234:235], v5 offset:20480
    v_mfma_f32_16x16x32_bf16 v[184:187], v[244:247], v[44:47], v[184:187]
    ds_read_b64_tr_b16 v[236:237], v5 offset:24576
    v_mfma_f32_16x16x32_bf16 v[184:187], v[240:243], v[36:39], v[184:187]
    ds_read_b64_tr_b16 v[238:239], v5 offset:28672
    v_add_u32 v5, s64, v5
    s_waitcnt lgkmcnt(8)
    v_mfma_f32_16x16x32_bf16 v[188:191], v[248:251], v[36:39], v[188:191]
    ds_read_b64_tr_b16 v[240:241], v6 offset:16384
    v_mfma_f32_16x16x32_bf16 v[188:191], v[252:255], v[44:47], v[188:191]
    ds_read_b64_tr_b16 v[242:243], v6 offset:20480
    v_mfma_f32_16x16x32_bf16 v[180:183], v[252:255], v[40:43], v[180:183]
    ds_read_b64_tr_b16 v[244:245], v6 offset:24576
    v_mfma_f32_16x16x32_bf16 v[180:183], v[248:251], v[32:35], v[180:183]
    ds_read_b64_tr_b16 v[246:247], v6 offset:28672
    v_add_u32 v6, s64, v6
    s_waitcnt lgkmcnt(8)
    v_mfma_f32_16x16x32_bf16 v[128:131], v[224:227], v[48:51], v[128:131]
    ds_read_b64_tr_b16 v[248:249], v7 offset:16384
    v_mfma_f32_16x16x32_bf16 v[128:131], v[228:231], v[56:59], v[128:131]
    ds_read_b64_tr_b16 v[250:251], v7 offset:20480
    v_mfma_f32_16x16x32_bf16 v[136:139], v[228:231], v[60:63], v[136:139]
    ds_read_b64_tr_b16 v[252:253], v7 offset:24576
    v_mfma_f32_16x16x32_bf16 v[136:139], v[224:227], v[52:55], v[136:139]
    ds_read_b64_tr_b16 v[254:255], v7 offset:28672
    v_add_u32 v7, s64, v7
    s_waitcnt lgkmcnt(8)
    v_mfma_f32_16x16x32_bf16 v[140:143], v[232:235], v[52:55], v[140:143]
    ds_read_b64_tr_b16 v[224:225], v8 offset:16384
    v_mfma_f32_16x16x32_bf16 v[140:143], v[236:239], v[60:63], v[140:143]
    ds_read_b64_tr_b16 v[226:227], v8 offset:20480
    v_mfma_f32_16x16x32_bf16 v[132:135], v[236:239], v[56:59], v[132:135]
    ds_read_b64_tr_b16 v[228:229], v8 offset:24576
    v_mfma_f32_16x16x32_bf16 v[132:135], v[232:235], v[48:51], v[132:135]
    ds_read_b64_tr_b16 v[230:231], v8 offset:28672
    v_add_u32 v8, s64, v8
    s_waitcnt lgkmcnt(8)
    v_mfma_f32_16x16x32_bf16 v[144:147], v[240:243], v[48:51], v[144:147]
    ds_read_b64_tr_b16 v[232:233], v9 offset:16384
    v_mfma_f32_16x16x32_bf16 v[144:147], v[244:247], v[56:59], v[144:147]
    ds_read_b64_tr_b16 v[234:235], v9 offset:20480
    v_mfma_f32_16x16x32_bf16 v[152:155], v[244:247], v[60:63], v[152:155]
    ds_read_b64_tr_b16 v[236:237], v9 offset:24576
    v_mfma_f32_16x16x32_bf16 v[152:155], v[240:243], v[52:55], v[152:155]
    ds_read_b64_tr_b16 v[238:239], v9 offset:28672
    v_add_u32 v9, s64, v9
    s_waitcnt lgkmcnt(8)
    v_mfma_f32_16x16x32_bf16 v[156:159], v[248:251], v[52:55], v[156:159]
    ds_read_b64_tr_b16 v[240:241], v10 offset:16384
    v_mfma_f32_16x16x32_bf16 v[156:159], v[252:255], v[60:63], v[156:159]
    ds_read_b64_tr_b16 v[242:243], v10 offset:20480
    v_mfma_f32_16x16x32_bf16 v[148:151], v[252:255], v[56:59], v[148:151]
    ds_read_b64_tr_b16 v[244:245], v10 offset:24576
    v_mfma_f32_16x16x32_bf16 v[148:151], v[248:251], v[48:51], v[148:151]
    ds_read_b64_tr_b16 v[246:247], v10 offset:28672
    v_add_u32 v10, s64, v10
    s_waitcnt lgkmcnt(8)
    v_mfma_f32_16x16x32_bf16 v[160:163], v[224:227], v[48:51], v[160:163]
    ds_read_b64_tr_b16 v[248:249], v11 offset:16384
    v_mfma_f32_16x16x32_bf16 v[160:163], v[228:231], v[56:59], v[160:163]
    ds_read_b64_tr_b16 v[250:251], v11 offset:20480
    v_mfma_f32_16x16x32_bf16 v[168:171], v[228:231], v[60:63], v[168:171]
    ds_read_b64_tr_b16 v[252:253], v11 offset:24576
    v_mfma_f32_16x16x32_bf16 v[168:171], v[224:227], v[52:55], v[168:171]
    ds_read_b64_tr_b16 v[254:255], v11 offset:28672
    v_add_u32 v11, s64, v11
    s_waitcnt lgkmcnt(8)
    v_mfma_f32_16x16x32_bf16 v[172:175], v[232:235], v[52:55], v[172:175]
    ds_read_b64_tr_b16 v[224:225], v4 offset:0
    v_mfma_f32_16x16x32_bf16 v[172:175], v[236:239], v[60:63], v[172:175]
    ds_read_b64_tr_b16 v[226:227], v4 offset:4096
    v_mfma_f32_16x16x32_bf16 v[164:167], v[236:239], v[56:59], v[164:167]
    ds_read_b64_tr_b16 v[228:229], v4 offset:8192
    v_mfma_f32_16x16x32_bf16 v[164:167], v[232:235], v[48:51], v[164:167]
    ds_read_b64_tr_b16 v[230:231], v4 offset:12288
    s_waitcnt lgkmcnt(8)
    v_mfma_f32_16x16x32_bf16 v[176:179], v[240:243], v[48:51], v[176:179]
    ds_read_b64_tr_b16 v[232:233], v5 offset:0
    v_mfma_f32_16x16x32_bf16 v[176:179], v[244:247], v[56:59], v[176:179]
    ds_read_b64_tr_b16 v[234:235], v5 offset:4096
    v_mfma_f32_16x16x32_bf16 v[184:187], v[244:247], v[60:63], v[184:187]
    ds_read_b64_tr_b16 v[236:237], v5 offset:8192
    v_mfma_f32_16x16x32_bf16 v[184:187], v[240:243], v[52:55], v[184:187]
    ds_read_b64_tr_b16 v[238:239], v5 offset:12288
    s_waitcnt lgkmcnt(8)
    v_mfma_f32_16x16x32_bf16 v[188:191], v[248:251], v[52:55], v[188:191]
    ds_read_b64_tr_b16 v[240:241], v6 offset:0
    v_mfma_f32_16x16x32_bf16 v[188:191], v[252:255], v[60:63], v[188:191]
    ds_read_b64_tr_b16 v[242:243], v6 offset:4096
    v_mfma_f32_16x16x32_bf16 v[180:183], v[252:255], v[56:59], v[180:183]
    ds_read_b64_tr_b16 v[244:245], v6 offset:8192
    v_mfma_f32_16x16x32_bf16 v[180:183], v[248:251], v[48:51], v[180:183]
    ds_read_b64_tr_b16 v[246:247], v6 offset:12288
    ds_read_b64_tr_b16 v[248:249], v7 offset:0
    ds_read_b64_tr_b16 v[250:251], v7 offset:4096
    ds_read_b64_tr_b16 v[252:253], v7 offset:8192
    ds_read_b64_tr_b16 v[254:255], v7 offset:12288
    s_waitcnt vmcnt(8)
    s_mov_b32 s64, s70
    s_add_u32 s70, s70, 32768
    s_cmp_ge_u32 s70, 163840
    s_cselect_b32 s70, 0, s70
    s_add_u32 s83, s83, 1
    s_sub_u32 s64, s70, s64
    s_waitcnt lgkmcnt(12)
    v_mfma_f32_16x16x32_bf16 v[128:131], v[224:227], v[64:67], v[128:131]
    v_mfma_f32_16x16x32_bf16 v[128:131], v[228:231], v[72:75], v[128:131]
    v_mfma_f32_16x16x32_bf16 v[136:139], v[228:231], v[76:79], v[136:139]
    v_mfma_f32_16x16x32_bf16 v[136:139], v[224:227], v[68:71], v[136:139]
    s_waitcnt lgkmcnt(8)
    v_mfma_f32_16x16x32_bf16 v[140:143], v[232:235], v[68:71], v[140:143]
    ds_read_b64_tr_b16 v[224:225], v8 offset:0
    v_mfma_f32_16x16x32_bf16 v[140:143], v[236:239], v[76:79], v[140:143]
    ds_read_b64_tr_b16 v[226:227], v8 offset:4096
    v_mfma_f32_16x16x32_bf16 v[132:135], v[236:239], v[72:75], v[132:135]
    ds_read_b64_tr_b16 v[228:229], v8 offset:8192
    v_mfma_f32_16x16x32_bf16 v[132:135], v[232:235], v[64:67], v[132:135]
    ds_read_b64_tr_b16 v[230:231], v8 offset:12288
    s_waitcnt lgkmcnt(8)
    v_mfma_f32_16x16x32_bf16 v[144:147], v[240:243], v[64:67], v[144:147]
    ds_read_b64_tr_b16 v[232:233], v9 offset:0
    v_mfma_f32_16x16x32_bf16 v[144:147], v[244:247], v[72:75], v[144:147]
    ds_read_b64_tr_b16 v[234:235], v9 offset:4096
    v_mfma_f32_16x16x32_bf16 v[152:155], v[244:247], v[76:79], v[152:155]
    ds_read_b64_tr_b16 v[236:237], v9 offset:8192
    v_mfma_f32_16x16x32_bf16 v[152:155], v[240:243], v[68:71], v[152:155]
    ds_read_b64_tr_b16 v[238:239], v9 offset:12288
    s_waitcnt lgkmcnt(8)
    v_mfma_f32_16x16x32_bf16 v[156:159], v[248:251], v[68:71], v[156:159]
    ds_read_b64_tr_b16 v[240:241], v10 offset:0
    v_mfma_f32_16x16x32_bf16 v[156:159], v[252:255], v[76:79], v[156:159]
    ds_read_b64_tr_b16 v[242:243], v10 offset:4096
    v_mfma_f32_16x16x32_bf16 v[148:151], v[252:255], v[72:75], v[148:151]
    ds_read_b64_tr_b16 v[244:245], v10 offset:8192
    v_mfma_f32_16x16x32_bf16 v[148:151], v[248:251], v[64:67], v[148:151]
    ds_read_b64_tr_b16 v[246:247], v10 offset:12288
    s_waitcnt lgkmcnt(8)
    v_mfma_f32_16x16x32_bf16 v[160:163], v[224:227], v[64:67], v[160:163]
    ds_read_b64_tr_b16 v[248:249], v11 offset:0
    v_mfma_f32_16x16x32_bf16 v[160:163], v[228:231], v[72:75], v[160:163]
    ds_read_b64_tr_b16 v[250:251], v11 offset:4096
    v_mfma_f32_16x16x32_bf16 v[168:171], v[228:231], v[76:79], v[168:171]
    ds_read_b64_tr_b16 v[252:253], v11 offset:8192
    v_mfma_f32_16x16x32_bf16 v[168:171], v[224:227], v[68:71], v[168:171]
    ds_read_b64_tr_b16 v[254:255], v11 offset:12288
    s_waitcnt lgkmcnt(8)
    v_mfma_f32_16x16x32_bf16 v[172:175], v[232:235], v[68:71], v[172:175]
    ds_read_b64_tr_b16 v[224:225], v4 offset:16384
    v_mfma_f32_16x16x32_bf16 v[172:175], v[236:239], v[76:79], v[172:175]
    ds_read_b64_tr_b16 v[226:227], v4 offset:20480
    v_mfma_f32_16x16x32_bf16 v[164:167], v[236:239], v[72:75], v[164:167]
    ds_read_b64_tr_b16 v[228:229], v4 offset:24576
    v_mfma_f32_16x16x32_bf16 v[164:167], v[232:235], v[64:67], v[164:167]
    ds_read_b64_tr_b16 v[230:231], v4 offset:28672
    v_add_u32 v4, s64, v4
    s_waitcnt lgkmcnt(8)
    v_mfma_f32_16x16x32_bf16 v[176:179], v[240:243], v[64:67], v[176:179]
    ds_read_b64_tr_b16 v[232:233], v5 offset:16384
    v_mfma_f32_16x16x32_bf16 v[176:179], v[244:247], v[72:75], v[176:179]
    ds_read_b64_tr_b16 v[234:235], v5 offset:20480
    v_mfma_f32_16x16x32_bf16 v[184:187], v[244:247], v[76:79], v[184:187]
    ds_read_b64_tr_b16 v[236:237], v5 offset:24576
    v_mfma_f32_16x16x32_bf16 v[184:187], v[240:243], v[68:71], v[184:187]
    ds_read_b64_tr_b16 v[238:239], v5 offset:28672
    v_add_u32 v5, s64, v5
    s_waitcnt lgkmcnt(8)
    v_mfma_f32_16x16x32_bf16 v[188:191], v[248:251], v[68:71], v[188:191]
    ds_read_b64_tr_b16 v[240:241], v6 offset:16384
    v_mfma_f32_16x16x32_bf16 v[188:191], v[252:255], v[76:79], v[188:191]
    ds_read_b64_tr_b16 v[242:243], v6 offset:20480
    v_mfma_f32_16x16x32_bf16 v[180:183], v[252:255], v[72:75], v[180:183]
    ds_read_b64_tr_b16 v[244:245], v6 offset:24576
    v_mfma_f32_16x16x32_bf16 v[180:183], v[248:251], v[64:67], v[180:183]
    ds_read_b64_tr_b16 v[246:247], v6 offset:28672
    v_add_u32 v6, s64, v6
    s_waitcnt lgkmcnt(8)
    v_mfma_f32_16x16x32_bf16 v[128:131], v[224:227], v[80:83], v[128:131]
    ds_read_b64_tr_b16 v[248:249], v7 offset:16384
    v_mfma_f32_16x16x32_bf16 v[128:131], v[228:231], v[88:91], v[128:131]
    ds_read_b64_tr_b16 v[250:251], v7 offset:20480
    v_mfma_f32_16x16x32_bf16 v[136:139], v[228:231], v[92:95], v[136:139]
    ds_read_b64_tr_b16 v[252:253], v7 offset:24576
    v_mfma_f32_16x16x32_bf16 v[136:139], v[224:227], v[84:87], v[136:139]
    ds_read_b64_tr_b16 v[254:255], v7 offset:28672
    v_add_u32 v7, s64, v7
    s_waitcnt lgkmcnt(8)
    v_mfma_f32_16x16x32_bf16 v[140:143], v[232:235], v[84:87], v[140:143]
    ds_read_b64_tr_b16 v[224:225], v8 offset:16384
    v_mfma_f32_16x16x32_bf16 v[140:143], v[236:239], v[92:95], v[140:143]
    ds_read_b64_tr_b16 v[226:227], v8 offset:20480
    v_mfma_f32_16x16x32_bf16 v[132:135], v[236:239], v[88:91], v[132:135]
    ds_read_b64_tr_b16 v[228:229], v8 offset:24576
    v_mfma_f32_16x16x32_bf16 v[132:135], v[232:235], v[80:83], v[132:135]
    ds_read_b64_tr_b16 v[230:231], v8 offset:28672
    v_add_u32 v8, s64, v8
    s_waitcnt lgkmcnt(8)
    v_mfma_f32_16x16x32_bf16 v[144:147], v[240:243], v[80:83], v[144:147]
    ds_read_b64_tr_b16 v[232:233], v9 offset:16384
    v_mfma_f32_16x16x32_bf16 v[144:147], v[244:247], v[88:91], v[144:147]
    ds_read_b64_tr_b16 v[234:235], v9 offset:20480
    v_mfma_f32_16x16x32_bf16 v[152:155], v[244:247], v[92:95], v[152:155]
    ds_read_b64_tr_b16 v[236:237], v9 offset:24576
    v_mfma_f32_16x16x32_bf16 v[152:155], v[240:243], v[84:87], v[152:155]
    ds_read_b64_tr_b16 v[238:239], v9 offset:28672
    v_add_u32 v9, s64, v9
    s_waitcnt lgkmcnt(8)
    v_mfma_f32_16x16x32_bf16 v[156:159], v[248:251], v[84:87], v[156:159]
    ds_read_b64_tr_b16 v[240:241], v10 offset:16384
    v_mfma_f32_16x16x32_bf16 v[156:159], v[252:255], v[92:95], v[156:159]
    ds_read_b64_tr_b16 v[242:243], v10 offset:20480
    v_mfma_f32_16x16x32_bf16 v[148:151], v[252:255], v[88:91], v[148:151]
    ds_read_b64_tr_b16 v[244:245], v10 offset:24576
    v_mfma_f32_16x16x32_bf16 v[148:151], v[248:251], v[80:83], v[148:151]
    ds_read_b64_tr_b16 v[246:247], v10 offset:28672
    v_add_u32 v10, s64, v10
    s_waitcnt lgkmcnt(8)
    v_mfma_f32_16x16x32_bf16 v[160:163], v[224:227], v[80:83], v[160:163]
    ds_read_b64_tr_b16 v[248:249], v11 offset:16384
    v_mfma_f32_16x16x32_bf16 v[160:163], v[228:231], v[88:91], v[160:163]
    ds_read_b64_tr_b16 v[250:251], v11 offset:20480
    v_mfma_f32_16x16x32_bf16 v[168:171], v[228:231], v[92:95], v[168:171]
    ds_read_b64_tr_b16 v[252:253], v11 offset:24576
    v_mfma_f32_16x16x32_bf16 v[168:171], v[224:227], v[84:87], v[168:171]
    ds_read_b64_tr_b16 v[254:255], v11 offset:28672
    v_add_u32 v11, s64, v11
    s_waitcnt lgkmcnt(8)
    v_mfma_f32_16x16x32_bf16 v[172:175], v[232:235], v[84:87], v[172:175]
    ds_read_b64_tr_b16 v[224:225], v4 offset:0
    v_mfma_f32_16x16x32_bf16 v[172:175], v[236:239], v[92:95], v[172:175]
    ds_read_b64_tr_b16 v[226:227], v4 offset:4096
    v_mfma_f32_16x16x32_bf16 v[164:167], v[236:239], v[88:91], v[164:167]
    ds_read_b64_tr_b16 v[228:229], v4 offset:8192
    v_mfma_f32_16x16x32_bf16 v[164:167], v[232:235], v[80:83], v[164:167]
    ds_read_b64_tr_b16 v[230:231], v4 offset:12288
    s_waitcnt lgkmcnt(8)
    v_mfma_f32_16x16x32_bf16 v[176:179], v[240:243], v[80:83], v[176:179]
    ds_read_b64_tr_b16 v[232:233], v5 offset:0
    v_mfma_f32_16x16x32_bf16 v[176:179], v[244:247], v[88:91], v[176:179]
    ds_read_b64_tr_b16 v[234:235], v5 offset:4096
    v_mfma_f32_16x16x32_bf16 v[184:187], v[244:247], v[92:95], v[184:187]
    ds_read_b64_tr_b16 v[236:237], v5 offset:8192
    v_mfma_f32_16x16x32_bf16 v[184:187], v[240:243], v[84:87], v[184:187]
    ds_read_b64_tr_b16 v[238:239], v5 offset:12288
    s_waitcnt lgkmcnt(8)
    v_mfma_f32_16x16x32_bf16 v[188:191], v[248:251], v[84:87], v[188:191]
    ds_read_b64_tr_b16 v[240:241], v6 offset:0
    v_mfma_f32_16x16x32_bf16 v[188:191], v[252:255], v[92:95], v[188:191]
    ds_read_b64_tr_b16 v[242:243], v6 offset:4096
    v_mfma_f32_16x16x32_bf16 v[180:183], v[252:255], v[88:91], v[180:183]
    ds_read_b64_tr_b16 v[244:245], v6 offset:8192
    v_mfma_f32_16x16x32_bf16 v[180:183], v[248:251], v[80:83], v[180:183]
    ds_read_b64_tr_b16 v[246:247], v6 offset:12288
    ds_read_b64_tr_b16 v[248:249], v7 offset:0
    ds_read_b64_tr_b16 v[250:251], v7 offset:4096
    ds_read_b64_tr_b16 v[252:253], v7 offset:8192
    ds_read_b64_tr_b16 v[254:255], v7 offset:12288
    s_waitcnt vmcnt(0)
    s_cmp_lt_u32 s3, 4
    s_cbranch_scc1 tail_nw
    s_lshl_b32 s56, s6, 1
    s_and_b32 s57, s7, 1
    s_add_u32 s56, s56, s57
    s_lshr_b32 s57, s7, 1
    s_lshl_b32 s24, s56, 16
    s_add_u32 s24, s24, s77
    s_add_u32 s24, s24, 56098816
    s_lshl_b32 s26, s57, 16
    s_add_u32 s26, s26, s77
    s_add_u32 s26, s26, 63963136
    s_lshl_b32 s28, s56, 2
    s_add_u32 s28, s28, s65
    s_lshl_b32 s28, s28, 15
    s_lshl_b32 s57, s57, 7
    s_add_u32 s28, s28, s57
    s_add_u32 s56, s26, 0
    buffer_load_dwordx4 v[192:195], v15, s[8:11], s56 offen offset:0 sc1
    buffer_load_dwordx4 v[196:199], v15, s[8:11], s56 offen offset:1024 sc1
    buffer_load_dwordx4 v[200:203], v15, s[8:11], s56 offen offset:2048 sc1
    buffer_load_dwordx4 v[204:207], v15, s[8:11], s56 offen offset:3072 sc1
    s_add_u32 s56, s26, 16384
    buffer_load_dwordx4 v[208:211], v15, s[8:11], s56 offen offset:0 sc1
    buffer_load_dwordx4 v[212:215], v15, s[8:11], s56 offen offset:1024 sc1
    buffer_load_dwordx4 v[216:219], v15, s[8:11], s56 offen offset:2048 sc1
    buffer_load_dwordx4 v[220:223], v15, s[8:11], s56 offen offset:3072 sc1
    s_add_u32 s56, s26, 32768
    buffer_load_dwordx4 v[32:35], v15, s[8:11], s56 offen offset:0 sc1
    buffer_load_dwordx4 v[36:39], v15, s[8:11], s56 offen offset:1024 sc1
    buffer_load_dwordx4 v[40:43], v15, s[8:11], s56 offen offset:2048 sc1
    buffer_load_dwordx4 v[44:47], v15, s[8:11], s56 offen offset:3072 sc1
    s_add_u32 s56, s26, 49152
    buffer_load_dwordx4 v[48:51], v15, s[8:11], s56 offen offset:0 sc1
    buffer_load_dwordx4 v[52:55], v15, s[8:11], s56 offen offset:1024 sc1
    buffer_load_dwordx4 v[56:59], v15, s[8:11], s56 offen offset:2048 sc1
    buffer_load_dwordx4 v[60:63], v15, s[8:11], s56 offen offset:3072 sc1
tail_nw:
    s_add_u32 s64, s82, 4096
    s_waitcnt lgkmcnt(12)
    v_mfma_f32_16x16x32_bf16 v[128:131], v[224:227], v[96:99], v[128:131]
    v_mfma_f32_16x16x32_bf16 v[128:131], v[228:231], v[104:107], v[128:131]
    v_mfma_f32_16x16x32_bf16 v[136:139], v[228:231], v[108:111], v[136:139]
    v_mfma_f32_16x16x32_bf16 v[136:139], v[224:227], v[100:103], v[136:139]
    s_waitcnt lgkmcnt(8)
    v_mfma_f32_16x16x32_bf16 v[140:143], v[232:235], v[100:103], v[140:143]
    ds_read_b64_tr_b16 v[224:225], v8 offset:0
    v_mfma_f32_16x16x32_bf16 v[140:143], v[236:239], v[108:111], v[140:143]
    ds_read_b64_tr_b16 v[226:227], v8 offset:4096
    v_mfma_f32_16x16x32_bf16 v[132:135], v[236:239], v[104:107], v[132:135]
    ds_read_b64_tr_b16 v[228:229], v8 offset:8192
    v_mfma_f32_16x16x32_bf16 v[132:135], v[232:235], v[96:99], v[132:135]
    ds_read_b64_tr_b16 v[230:231], v8 offset:12288
    s_waitcnt lgkmcnt(8)
    v_mfma_f32_16x16x32_bf16 v[144:147], v[240:243], v[96:99], v[144:147]
    ds_read_b64_tr_b16 v[232:233], v9 offset:0
    v_mfma_f32_16x16x32_bf16 v[144:147], v[244:247], v[104:107], v[144:147]
    ds_read_b64_tr_b16 v[234:235], v9 offset:4096
    v_mfma_f32_16x16x32_bf16 v[152:155], v[244:247], v[108:111], v[152:155]
    ds_read_b64_tr_b16 v[236:237], v9 offset:8192
    v_mfma_f32_16x16x32_bf16 v[152:155], v[240:243], v[100:103], v[152:155]
    ds_read_b64_tr_b16 v[238:239], v9 offset:12288
    s_waitcnt lgkmcnt(8)
    v_mfma_f32_16x16x32_bf16 v[156:159], v[248:251], v[100:103], v[156:159]
    ds_read_b64_tr_b16 v[240:241], v10 offset:0
    v_mfma_f32_16x16x32_bf16 v[156:159], v[252:255], v[108:111], v[156:159]
    ds_read_b64_tr_b16 v[242:243], v10 offset:4096
    v_mfma_f32_16x16x32_bf16 v[148:151], v[252:255], v[104:107], v[148:151]
    ds_read_b64_tr_b16 v[244:245], v10 offset:8192
    v_mfma_f32_16x16x32_bf16 v[148:151], v[248:251], v[96:99], v[148:151]
    ds_read_b64_tr_b16 v[246:247], v10 offset:12288
    s_waitcnt lgkmcnt(8)
    v_mfma_f32_16x16x32_bf16 v[160:163], v[224:227], v[96:99], v[160:163]
    ds_read_b64_tr_b16 v[248:249], v11 offset:0
    v_mfma_f32_16x16x32_bf16 v[160:163], v[228:231], v[104:107], v[160:163]
    ds_read_b64_tr_b16 v[250:251], v11 offset:4096
    v_mfma_f32_16x16x32_bf16 v[168:171], v[228:231], v[108:111], v[168:171]
    ds_read_b64_tr_b16 v[252:253], v11 offset:8192
    v_mfma_f32_16x16x32_bf16 v[168:171], v[224:227], v[100:103], v[168:171]
    ds_read_b64_tr_b16 v[254:255], v11 offset:12288
    s_waitcnt lgkmcnt(8)
    v_mfma_f32_16x16x32_bf16 v[172:175], v[232:235], v[100:103], v[172:175]
    ds_read_b64_tr_b16 v[224:225], v4 offset:16384
    v_mfma_f32_16x16x32_bf16 v[172:175], v[236:239], v[108:111], v[172:175]
    ds_read_b64_tr_b16 v[226:227], v4 offset:20480
    v_mfma_f32_16x16x32_bf16 v[164:167], v[236:239], v[104:107], v[164:167]
    ds_read_b64_tr_b16 v[228:229], v4 offset:24576
    v_mfma_f32_16x16x32_bf16 v[164:167], v[232:235], v[96:99], v[164:167]
    ds_read_b64_tr_b16 v[230:231], v4 offset:28672
    s_waitcnt lgkmcnt(8)
    v_mfma_f32_16x16x32_bf16 v[176:179], v[240:243], v[96:99], v[176:179]
    ds_read_b64_tr_b16 v[232:233], v5 offset:16384
    v_mfma_f32_16x16x32_bf16 v[176:179], v[244:247], v[104:107], v[176:179]
    ds_read_b64_tr_b16 v[234:235], v5 offset:20480
    v_mfma_f32_16x16x32_bf16 v[184:187], v[244:247], v[108:111], v[184:187]
    ds_read_b64_tr_b16 v[236:237], v5 offset:24576
    v_mfma_f32_16x16x32_bf16 v[184:187], v[240:243], v[100:103], v[184:187]
    ds_read_b64_tr_b16 v[238:239], v5 offset:28672
    s_waitcnt lgkmcnt(8)
    v_mfma_f32_16x16x32_bf16 v[188:191], v[248:251], v[100:103], v[188:191]
    ds_read_b64_tr_b16 v[240:241], v6 offset:16384
    v_mfma_f32_16x16x32_bf16 v[188:191], v[252:255], v[108:111], v[188:191]
    ds_read_b64_tr_b16 v[242:243], v6 offset:20480
    v_mfma_f32_16x16x32_bf16 v[180:183], v[252:255], v[104:107], v[180:183]
    ds_read_b64_tr_b16 v[244:245], v6 offset:24576
    v_mfma_f32_16x16x32_bf16 v[180:183], v[248:251], v[96:99], v[180:183]
    ds_read_b64_tr_b16 v[246:247], v6 offset:28672
    s_waitcnt lgkmcnt(8)
    v_mfma_f32_16x16x32_bf16 v[128:131], v[224:227], v[112:115], v[128:131]
    ds_read_b64_tr_b16 v[248:249], v7 offset:16384
    v_mfma_f32_16x16x32_bf16 v[128:131], v[228:231], v[120:123], v[128:131]
    ds_read_b64_tr_b16 v[250:251], v7 offset:20480
    v_mfma_f32_16x16x32_bf16 v[136:139], v[228:231], v[124:127], v[136:139]
    ds_read_b64_tr_b16 v[252:253], v7 offset:24576
    v_mfma_f32_16x16x32_bf16 v[136:139], v[224:227], v[116:119], v[136:139]
    ds_read_b64_tr_b16 v[254:255], v7 offset:28672
    s_waitcnt lgkmcnt(8)
    v_mfma_f32_16x16x32_bf16 v[140:143], v[232:235], v[116:119], v[140:143]
    ds_read_b64_tr_b16 v[224:225], v8 offset:16384
    v_mfma_f32_16x16x32_bf16 v[140:143], v[236:239], v[124:127], v[140:143]
    ds_read_b64_tr_b16 v[226:227], v8 offset:20480
    v_mfma_f32_16x16x32_bf16 v[132:135], v[236:239], v[120:123], v[132:135]
    ds_read_b64_tr_b16 v[228:229], v8 offset:24576
    v_mfma_f32_16x16x32_bf16 v[132:135], v[232:235], v[112:115], v[132:135]
    ds_read_b64_tr_b16 v[230:231], v8 offset:28672
    s_waitcnt lgkmcnt(8)
    v_mfma_f32_16x16x32_bf16 v[144:147], v[240:243], v[112:115], v[144:147]
    ds_read_b64_tr_b16 v[232:233], v9 offset:16384
    v_mfma_f32_16x16x32_bf16 v[144:147], v[244:247], v[120:123], v[144:147]
    ds_read_b64_tr_b16 v[234:235], v9 offset:20480
    v_mfma_f32_16x16x32_bf16 v[152:155], v[244:247], v[124:127], v[152:155]
    ds_read_b64_tr_b16 v[236:237], v9 offset:24576
    v_mfma_f32_16x16x32_bf16 v[152:155], v[240:243], v[116:119], v[152:155]
    ds_read_b64_tr_b16 v[238:239], v9 offset:28672
    s_waitcnt lgkmcnt(8)
    v_mfma_f32_16x16x32_bf16 v[156:159], v[248:251], v[116:119], v[156:159]
    ds_read_b64_tr_b16 v[240:241], v10 offset:16384
    v_cvt_pk_bf16_f32 v64, v128, v129
    v_mfma_f32_16x16x32_bf16 v[156:159], v[252:255], v[124:127], v[156:159]
    ds_read_b64_tr_b16 v[242:243], v10 offset:20480
    v_cvt_pk_bf16_f32 v65, v130, v131
    v_mfma_f32_16x16x32_bf16 v[148:151], v[252:255], v[120:123], v[148:151]
    ds_read_b64_tr_b16 v[244:245], v10 offset:24576
    v_cvt_pk_bf16_f32 v66, v132, v133
    v_mfma_f32_16x16x32_bf16 v[148:151], v[248:251], v[112:115], v[148:151]
    ds_read_b64_tr_b16 v[246:247], v10 offset:28672
    v_cvt_pk_bf16_f32 v67, v134, v135
    s_waitcnt lgkmcnt(8)
    v_mfma_f32_16x16x32_bf16 v[160:163], v[224:227], v[112:115], v[160:163]
    ds_read_b64_tr_b16 v[248:249], v11 offset:16384
    buffer_store_dwordx4 v[64:67], v15, s[8:11], s82 offen offset:0 sc1
    v_mfma_f32_16x16x32_bf16 v[160:163], v[228:231], v[120:123], v[160:163]
    ds_read_b64_tr_b16 v[250:251], v11 offset:20480
    v_cvt_pk_bf16_f32 v80, v136, v137
    v_mfma_f32_16x16x32_bf16 v[168:171], v[228:231], v[124:127], v[168:171]
    ds_read_b64_tr_b16 v[252:253], v11 offset:24576
    v_cvt_pk_bf16_f32 v81, v138, v139
    v_mfma_f32_16x16x32_bf16 v[168:171], v[224:227], v[116:119], v[168:171]
    ds_read_b64_tr_b16 v[254:255], v11 offset:28672
    v_cvt_pk_bf16_f32 v82, v140, v141
    s_waitcnt lgkmcnt(8)
    v_mfma_f32_16x16x32_bf16 v[172:175], v[232:235], v[116:119], v[172:175]
    v_cvt_pk_bf16_f32 v83, v142, v143
    buffer_store_dwordx4 v[80:83], v15, s[8:11], s64 offen offset:0 sc1
    v_mfma_f32_16x16x32_bf16 v[172:175], v[236:239], v[124:127], v[172:175]
    v_cvt_pk_bf16_f32 v68, v144, v145
    v_cvt_pk_bf16_f32 v69, v146, v147
    v_mfma_f32_16x16x32_bf16 v[164:167], v[236:239], v[120:123], v[164:167]
    v_cvt_pk_bf16_f32 v70, v148, v149
    v_cvt_pk_bf16_f32 v71, v150, v151
    v_mfma_f32_16x16x32_bf16 v[164:167], v[232:235], v[112:115], v[164:167]
    buffer_store_dwordx4 v[68:71], v15, s[8:11], s82 offen offset:1024 sc1
    v_cvt_pk_bf16_f32 v84, v152, v153
    s_waitcnt lgkmcnt(4)
    v_mfma_f32_16x16x32_bf16 v[176:179], v[240:243], v[112:115], v[176:179]
    v_cvt_pk_bf16_f32 v85, v154, v155
    v_cvt_pk_bf16_f32 v86, v156, v157
    v_mfma_f32_16x16x32_bf16 v[176:179], v[244:247], v[120:123], v[176:179]
    v_cvt_pk_bf16_f32 v87, v158, v159
    buffer_store_dwordx4 v[84:87], v15, s[8:11], s64 offen offset:1024 sc1
    v_mfma_f32_16x16x32_bf16 v[184:187], v[244:247], v[124:127], v[184:187]
    v_mfma_f32_16x16x32_bf16 v[184:187], v[240:243], v[116:119], v[184:187]
    s_waitcnt lgkmcnt(0)
    v_mfma_f32_16x16x32_bf16 v[188:191], v[248:251], v[116:119], v[188:191]
    v_cvt_pk_bf16_f32 v72, v160, v161
    v_cvt_pk_bf16_f32 v73, v162, v163
    v_mfma_f32_16x16x32_bf16 v[188:191], v[252:255], v[124:127], v[188:191]
    v_cvt_pk_bf16_f32 v74, v164, v165
    v_cvt_pk_bf16_f32 v75, v166, v167
    v_mfma_f32_16x16x32_bf16 v[180:183], v[252:255], v[120:123], v[180:183]
    buffer_store_dwordx4 v[72:75], v15, s[8:11], s82 offen offset:2048 sc1
    v_cvt_pk_bf16_f32 v88, v168, v169
    v_mfma_f32_16x16x32_bf16 v[180:183], v[248:251], v[112:115], v[180:183]
    v_cvt_pk_bf16_f32 v89, v170, v171
    v_cvt_pk_bf16_f32 v90, v172, v173
    v_cvt_pk_bf16_f32 v91, v174, v175
    buffer_store_dwordx4 v[88:91], v15, s[8:11], s64 offen offset:2048 sc1
    v_cvt_pk_bf16_f32 v76, v176, v177
    v_cvt_pk_bf16_f32 v77, v178, v179
    s_nop 1
    v_cvt_pk_bf16_f32 v78, v180, v181
    v_cvt_pk_bf16_f32 v79, v182, v183
    buffer_store_dwordx4 v[76:79], v15, s[8:11], s82 offen offset:3072 sc1
    v_cvt_pk_bf16_f32 v92, v184, v185
    v_cvt_pk_bf16_f32 v93, v186, v187
    v_cvt_pk_bf16_f32 v94, v188, v189
    v_cvt_pk_bf16_f32 v95, v190, v191
    buffer_store_dwordx4 v[92:95], v15, s[8:11], s64 offen offset:3072 sc1
    s_cmp_lt_u32 s3, 4
    s_cbranch_scc1 tail_pk
    s_add_u32 s56, s65, 0
    s_and_b32 s56, s56, 3
    s_lshl_b32 s56, s56, 14
    s_add_u32 s56, s56, s24
    buffer_load_dwordx4 v[64:67], v15, s[8:11], s56 offen offset:0 sc1
    buffer_load_dwordx4 v[68:71], v15, s[8:11], s56 offen offset:1024 sc1
    buffer_load_dwordx4 v[72:75], v15, s[8:11], s56 offen offset:2048 sc1
    buffer_load_dwordx4 v[76:79], v15, s[8:11], s56 offen offset:3072 sc1
    s_add_u32 s56, s65, 1
    s_and_b32 s56, s56, 3
    s_lshl_b32 s56, s56, 14
    s_add_u32 s56, s56, s24
    buffer_load_dwordx4 v[80:83], v15, s[8:11], s56 offen offset:0 sc1
    buffer_load_dwordx4 v[84:87], v15, s[8:11], s56 offen offset:1024 sc1
    buffer_load_dwordx4 v[88:91], v15, s[8:11], s56 offen offset:2048 sc1
    buffer_load_dwordx4 v[92:95], v15, s[8:11], s56 offen offset:3072 sc1
    s_add_u32 s56, s65, 2
    s_and_b32 s56, s56, 3
    s_lshl_b32 s56, s56, 14
    s_add_u32 s56, s56, s24
    buffer_load_dwordx4 v[96:99], v15, s[8:11], s56 offen offset:0 sc1
    buffer_load_dwordx4 v[100:103], v15, s[8:11], s56 offen offset:1024 sc1
    buffer_load_dwordx4 v[104:107], v15, s[8:11], s56 offen offset:2048 sc1
    buffer_load_dwordx4 v[108:111], v15, s[8:11], s56 offen offset:3072 sc1
    s_add_u32 s56, s65, 3
    s_and_b32 s56, s56, 3
    s_lshl_b32 s56, s56, 14
    s_add_u32 s56, s56, s24
    buffer_load_dwordx4 v[112:115], v15, s[8:11], s56 offen offset:0 sc1
    buffer_load_dwordx4 v[116:119], v15, s[8:11], s56 offen offset:1024 sc1
    buffer_load_dwordx4 v[120:123], v15, s[8:11], s56 offen offset:2048 sc1
    buffer_load_dwordx4 v[124:127], v15, s[8:11], s56 offen offset:3072 sc1
tail_pk:
    v_and_b32 v16, 15, v0
    v_lshlrev_b32 v16, 11, v16
    v_lshrrev_b32 v17, 4, v0
    v_lshl_or_b32 v16, v17, 4, v16
    s_cmp_lt_u32 s3, 4
    s_cbranch_scc1 tail_ex
    s_waitcnt vmcnt(0)
    s_lshl_b32 s56, s2, 3
    s_add_u32 s56, s56, s3
    s_lshl_b32 s56, s56, 7
    s_add_u32 s56, s56, 68681728
    v_mov_b32 v19, 2
    s_mov_b64 exec, 1
    buffer_store_dword v19, off, s[8:11], s56 sc1
    s_mov_b64 exec, -1
    s_setprio 0
    s_mov_b32 s67, 0
val1:
    v_max3_u32 v3, v64, v65, v66
    v_max3_u32 v3, v3, v67, v68
    v_max3_u32 v3, v3, v69, v70
    v_max3_u32 v3, v3, v71, v72
    v_max3_u32 v3, v3, v73, v74
    v_max3_u32 v3, v3, v75, v76
    v_max3_u32 v3, v3, v77, v78
    v_max3_u32 v3, v3, v79, v80
    v_max3_u32 v3, v3, v81, v82
    v_max3_u32 v3, v3, v83, v84
    v_max3_u32 v3, v3, v85, v86
    v_max3_u32 v3, v3, v87, v88
    v_max3_u32 v3, v3, v89, v90
    v_max3_u32 v3, v3, v91, v92
    v_max3_u32 v3, v3, v93, v94
    v_max3_u32 v3, v3, v95, v96
    v_max3_u32 v3, v3, v97, v98
    v_max3_u32 v3, v3, v99, v100
    v_max3_u32 v3, v3, v101, v102
    v_max3_u32 v3, v3, v103, v104
    v_max3_u32 v3, v3, v105, v106
    v_max3_u32 v3, v3, v107, v108
    v_max3_u32 v3, v3, v109, v110
    v_max3_u32 v3, v3, v111, v112
    v_max3_u32 v3, v3, v113, v114
    v_max3_u32 v3, v3, v115, v116
    v_max3_u32 v3, v3, v117, v118
    v_max3_u32 v3, v3, v119, v120
    v_max3_u32 v3, v3, v121, v122
    v_max3_u32 v3, v3, v123, v124
    v_max3_u32 v3, v3, v125, v126
    v_max_u32 v3, v3, v127
    v_cmp_eq_u32 vcc, -1, v3
    s_cbranch_vccnz reload1
    s_cmp_eq_u32 exec_lo, 0
    s_mov_b64 exec, -1
    s_cbranch_scc1 loads1
valok1:
    v_mfma_f32_16x16x32_bf16 v[128:131], v[192:195], v[64:67], 0
    v_mfma_f32_16x16x32_bf16 v[132:135], v[208:211], v[64:67], 0
    v_mfma_f32_16x16x32_bf16 v[136:139], v[32:35], v[64:67], 0
    v_mfma_f32_16x16x32_bf16 v[140:143], v[48:51], v[64:67], 0
    v_mfma_f32_16x16x32_bf16 v[144:147], v[192:195], v[80:83], 0
    v_mfma_f32_16x16x32_bf16 v[148:151], v[208:211], v[80:83], 0
    v_mfma_f32_16x16x32_bf16 v[152:155], v[32:35], v[80:83], 0
    v_mfma_f32_16x16x32_bf16 v[156:159], v[48:51], v[80:83], 0
    v_mfma_f32_16x16x32_bf16 v[160:163], v[192:195], v[96:99], 0
    v_mfma_f32_16x16x32_bf16 v[164:167], v[208:211], v[96:99], 0
    v_mfma_f32_16x16x32_bf16 v[168:171], v[32:35], v[96:99], 0
    v_mfma_f32_16x16x32_bf16 v[172:175], v[48:51], v[96:99], 0
    v_mfma_f32_16x16x32_bf16 v[176:179], v[192:195], v[112:115], 0
    v_mfma_f32_16x16x32_bf16 v[180:183], v[208:211], v[112:115], 0
    v_mfma_f32_16x16x32_bf16 v[184:187], v[32:35], v[112:115], 0
    v_mfma_f32_16x16x32_bf16 v[188:191], v[48:51], v[112:115], 0
    v_mfma_f32_16x16x32_bf16 v[128:131], v[196:199], v[68:71], v[128:131]
    v_mfma_f32_16x16x32_bf16 v[132:135], v[212:215], v[68:71], v[132:135]
    v_mfma_f32_16x16x32_bf16 v[136:139], v[36:39], v[68:71], v[136:139]
    v_mfma_f32_16x16x32_bf16 v[140:143], v[52:55], v[68:71], v[140:143]
    v_mfma_f32_16x16x32_bf16 v[144:147], v[196:199], v[84:87], v[144:147]
    v_mfma_f32_16x16x32_bf16 v[148:151], v[212:215], v[84:87], v[148:151]
    v_mfma_f32_16x16x32_bf16 v[152:155], v[36:39], v[84:87], v[152:155]
    v_mfma_f32_16x16x32_bf16 v[156:159], v[52:55], v[84:87], v[156:159]
    v_mfma_f32_16x16x32_bf16 v[160:163], v[196:199], v[100:103], v[160:163]
    v_mfma_f32_16x16x32_bf16 v[164:167], v[212:215], v[100:103], v[164:167]
    v_mfma_f32_16x16x32_bf16 v[168:171], v[36:39], v[100:103], v[168:171]
    v_mfma_f32_16x16x32_bf16 v[172:175], v[52:55], v[100:103], v[172:175]
    v_mfma_f32_16x16x32_bf16 v[176:179], v[196:199], v[116:119], v[176:179]
    v_mfma_f32_16x16x32_bf16 v[180:183], v[212:215], v[116:119], v[180:183]
    v_mfma_f32_16x16x32_bf16 v[184:187], v[36:39], v[116:119], v[184:187]
    v_mfma_f32_16x16x32_bf16 v[188:191], v[52:55], v[116:119], v[188:191]
    v_mfma_f32_16x16x32_bf16 v[128:131], v[200:203], v[72:75], v[128:131]
    v_mfma_f32_16x16x32_bf16 v[132:135], v[216:219], v[72:75], v[132:135]
    v_mfma_f32_16x16x32_bf16 v[136:139], v[40:43], v[72:75], v[136:139]
    v_mfma_f32_16x16x32_bf16 v[140:143], v[56:59], v[72:75], v[140:143]
    v_mfma_f32_16x16x32_bf16 v[144:147], v[200:203], v[88:91], v[144:147]
    v_mfma_f32_16x16x32_bf16 v[148:151], v[216:219], v[88:91], v[148:151]
    v_mfma_f32_16x16x32_bf16 v[152:155], v[40:43], v[88:91], v[152:155]
    v_mfma_f32_16x16x32_bf16 v[156:159], v[56:59], v[88:91], v[156:159]
    v_mfma_f32_16x16x32_bf16 v[160:163], v[200:203], v[104:107], v[160:163]
    v_mfma_f32_16x16x32_bf16 v[164:167], v[216:219], v[104:107], v[164:167]
    v_mfma_f32_16x16x32_bf16 v[168:171], v[40:43], v[104:107], v[168:171]
    v_mfma_f32_16x16x32_bf16 v[172:175], v[56:59], v[104:107], v[172:175]
    v_mfma_f32_16x16x32_bf16 v[176:179], v[200:203], v[120:123], v[176:179]
    v_mfma_f32_16x16x32_bf16 v[180:183], v[216:219], v[120:123], v[180:183]
    v_mfma_f32_16x16x32_bf16 v[184:187], v[40:43], v[120:123], v[184:187]
    v_mfma_f32_16x16x32_bf16 v[188:191], v[56:59], v[120:123], v[188:191]
    v_mfma_f32_16x16x32_bf16 v[128:131], v[204:207], v[76:79], v[128:131]
    v_mfma_f32_16x16x32_bf16 v[132:135], v[220:223], v[76:79], v[132:135]
    v_mfma_f32_16x16x32_bf16 v[136:139], v[44:47], v[76:79], v[136:139]
    v_mfma_f32_16x16x32_bf16 v[140:143], v[60:63], v[76:79], v[140:143]
    v_mfma_f32_16x16x32_bf16 v[144:147], v[204:207], v[92:95], v[144:147]
    v_mfma_f32_16x16x32_bf16 v[148:151], v[220:223], v[92:95], v[148:151]
    v_mfma_f32_16x16x32_bf16 v[152:155], v[44:47], v[92:95], v[152:155]
    v_mfma_f32_16x16x32_bf16 v[156:159], v[60:63], v[92:95], v[156:159]
    v_mfma_f32_16x16x32_bf16 v[160:163], v[204:207], v[108:111], v[160:163]
    v_mfma_f32_16x16x32_bf16 v[164:167], v[220:223], v[108:111], v[164:167]
    v_mfma_f32_16x16x32_bf16 v[168:171], v[44:47], v[108:111], v[168:171]
    v_mfma_f32_16x16x32_bf16 v[172:175], v[60:63], v[108:111], v[172:175]
    v_mfma_f32_16x16x32_bf16 v[176:179], v[204:207], v[124:127], v[176:179]
    v_mfma_f32_16x16x32_bf16 v[180:183], v[220:223], v[124:127], v[180:183]
    v_mfma_f32_16x16x32_bf16 v[184:187], v[44:47], v[124:127], v[184:187]
    v_mfma_f32_16x16x32_bf16 v[188:191], v[60:63], v[124:127], v[188:191]
    s_add_u32 s56, s65, 1
    s_bitcmp1_b32 s56, 1
    s_cselect_b32 s57, s31, s30
    s_and_b32 s56, s56, 1
    s_mul_i32 s56, s56, 12288
    s_add_u32 s56, s56, s57
    v_add_u32 v24, s56, v15
    s_add_u32 s56, s65, 2
    s_bitcmp1_b32 s56, 1
    s_cselect_b32 s57, s31, s30
    s_and_b32 s56, s56, 1
    s_mul_i32 s56, s56, 12288
    s_add_u32 s56, s56, s57
    v_add_u32 v25, s56, v15
    s_add_u32 s56, s65, 3
    s_bitcmp1_b32 s56, 1
    s_cselect_b32 s57, s31, s30
    s_and_b32 s56, s56, 1
    s_mul_i32 s56, s56, 12288
    s_add_u32 s56, s56, s57
    v_add_u32 v26, s56, v15
    s_add_u32 s57, s30, 32720
    v_mov_b32 v18, s57
    s_mov_b32 s67, 0
l_spin:
    ds_read_b128 v[28:31], v18
    s_add_u32 s67, s67, 1
    s_waitcnt lgkmcnt(0)
    v_and_b32 v28, v28, v29
    v_and_b32 v30, v30, v31
    v_and_b32 v28, v28, v30
    v_cmp_eq_u32 vcc, 1, v28
    s_cbranch_vccnz l_go
    s_sleep 1
    s_cmp_lt_u32 s67, 80000000
    s_cbranch_scc1 l_spin
l_go:
    ds_write_b128 v24, v[144:147] offset:0
    ds_write_b128 v24, v[148:151] offset:1024
    ds_write_b128 v24, v[152:155] offset:2048
    ds_write_b128 v24, v[156:159] offset:3072
    ds_write_b128 v25, v[160:163] offset:4096
    ds_write_b128 v25, v[164:167] offset:5120
    ds_write_b128 v25, v[168:171] offset:6144
    ds_write_b128 v25, v[172:175] offset:7168
    ds_write_b128 v26, v[176:179] offset:8192
    ds_write_b128 v26, v[180:183] offset:9216
    ds_write_b128 v26, v[184:187] offset:10240
    ds_write_b128 v26, v[188:191] offset:11264
    s_lshl_b32 s56, s65, 2
    s_add_u32 s57, s30, 32752
    s_add_u32 s56, s56, s57
    v_mov_b32 v17, s56
    v_mov_b32 v18, s57
    v_mov_b32 v19, 1
    s_bitcmp1_b32 s65, 1
    s_cselect_b32 s57, s31, s30
    s_and_b32 s56, s65, 1
    s_mul_i32 s56, s56, 12288
    s_add_u32 s56, s56, s57
    v_add_u32 v24, s56, v15
    s_waitcnt lgkmcnt(0)
    ds_write_b32 v17, v19
    v_mov_b32 v25, v18
    s_mov_b32 s67, 0
wp_122:
    s_andn2_b32 s56, s2, 7
    s_lshl_b32 s56, s56, 3
    s_add_u32 s56, s56, s3
    s_lshl_b32 s56, s56, 7
    s_add_u32 s56, s56, 68681728
    v_lshlrev_b32 v17, 10, v0
    s_mov_b64 exec, 255
    buffer_load_dword v18, v17, s[8:11], s56 offen sc1
    s_mov_b64 exec, -1
    s_add_u32 s67, s67, 1
    s_waitcnt vmcnt(0)
    v_cmp_gt_i32 vcc, 2, v18
    s_nop 0
    s_and_b32 s56, vcc_lo, 255
    s_cbranch_scc0 wok_123
    s_sleep 1
    s_cmp_lt_u32 s67, 1600000
    s_cbranch_scc1 wp_122
wok_123:
    s_and_b32 s57, s2, 7
    s_lshl_b32 s56, s57, 17
    s_sub_u32 s56, s82, s56
    s_lshl_b32 s57, s57, 10
    s_add_u32 s56, s56, s57
    buffer_load_dwordx4 v[64:67], v15, s[8:11], s56 offen sc1
    s_add_u32 s56, s56, 131072
    buffer_load_dwordx4 v[68:71], v15, s[8:11], s56 offen sc1
    s_add_u32 s56, s56, 131072
    buffer_load_dwordx4 v[72:75], v15, s[8:11], s56 offen sc1
    s_add_u32 s56, s56, 131072
    buffer_load_dwordx4 v[76:79], v15, s[8:11], s56 offen sc1
    s_add_u32 s56, s56, 131072
    buffer_load_dwordx4 v[80:83], v15, s[8:11], s56 offen sc1
    s_add_u32 s56, s56, 131072
    buffer_load_dwordx4 v[84:87], v15, s[8:11], s56 offen sc1
    s_add_u32 s56, s56, 131072
    buffer_load_dwordx4 v[88:91], v15, s[8:11], s56 offen sc1
    s_add_u32 s56, s56, 131072
    buffer_load_dwordx4 v[92:95], v15, s[8:11], s56 offen sc1
    s_add_u32 s56, s56, 131072
    s_mov_b32 s67, 0
g_spin:
    ds_read_b128 v[28:31], v25
    s_add_u32 s67, s67, 1
    s_waitcnt lgkmcnt(0)
    v_and_b32 v28, v28, v29
    v_and_b32 v30, v30, v31
    v_and_b32 v28, v28, v30
    v_cmp_eq_u32 vcc, 1, v28
    s_cbranch_vccnz g_go
    s_sleep 1
    s_cmp_lt_u32 s67, 80000000
    s_cbranch_scc1 g_spin
g_go:
    ds_read_b128 v[144:147], v24 offset:0
    ds_read_b128 v[148:151], v24 offset:1024
    ds_read_b128 v[152:155], v24 offset:2048
    ds_read_b128 v[156:159], v24 offset:3072
    ds_read_b128 v[160:163], v24 offset:4096
    ds_read_b128 v[164:167], v24 offset:5120
    ds_read_b128 v[168:171], v24 offset:6144
    ds_read_b128 v[172:175], v24 offset:7168
    ds_read_b128 v[176:179], v24 offset:8192
    ds_read_b128 v[180:183], v24 offset:9216
    ds_read_b128 v[184:187], v24 offset:10240
    ds_read_b128 v[188:191], v24 offset:11264
    s_waitcnt lgkmcnt(0)
    v_pk_add_f32 v[128:129], v[128:129], v[144:145]
    v_pk_add_f32 v[160:161], v[160:161], v[176:177]
    v_pk_add_f32 v[130:131], v[130:131], v[146:147]
    v_pk_add_f32 v[162:163], v[162:163], v[178:179]
    v_pk_add_f32 v[132:133], v[132:133], v[148:149]
    v_pk_add_f32 v[164:165], v[164:165], v[180:181]
    v_pk_add_f32 v[134:135], v[134:135], v[150:151]
    v_pk_add_f32 v[166:167], v[166:167], v[182:183]
    v_pk_add_f32 v[136:137], v[136:137], v[152:153]
    v_pk_add_f32 v[168:169], v[168:169], v[184:185]
    v_pk_add_f32 v[138:139], v[138:139], v[154:155]
    v_pk_add_f32 v[170:171], v[170:171], v[186:187]
    v_pk_add_f32 v[140:141], v[140:141], v[156:157]
    v_pk_add_f32 v[172:173], v[172:173], v[188:189]
    v_pk_add_f32 v[142:143], v[142:143], v[158:159]
    v_pk_add_f32 v[174:175], v[174:175], v[190:191]
    v_pk_add_f32 v[128:129], v[128:129], v[160:161]
    v_pk_add_f32 v[130:131], v[130:131], v[162:163]
    v_pk_add_f32 v[132:133], v[132:133], v[164:165]
    v_pk_add_f32 v[134:135], v[134:135], v[166:167]
    v_pk_add_f32 v[136:137], v[136:137], v[168:169]
    v_pk_add_f32 v[138:139], v[138:139], v[170:171]
    v_pk_add_f32 v[140:141], v[140:141], v[172:173]
    v_pk_add_f32 v[142:143], v[142:143], v[174:175]
    v_cvt_pk_bf16_f32 v192, v128, v129
    v_cvt_pk_bf16_f32 v193, v130, v131
    v_cvt_pk_bf16_f32 v194, v132, v133
    v_cvt_pk_bf16_f32 v195, v134, v135
    v_cvt_pk_bf16_f32 v196, v136, v137
    v_cvt_pk_bf16_f32 v197, v138, v139
    v_cvt_pk_bf16_f32 v198, v140, v141
    v_cvt_pk_bf16_f32 v199, v142, v143
    buffer_store_dwordx4 v[192:195], v16, s[16:19], s28 offen offset:0 nt
    buffer_store_dwordx4 v[196:199], v16, s[16:19], s28 offen offset:64 nt
    s_waitcnt vmcnt(2)
    s_branch tail_ex2
tail_ex:
    s_and_b32 s57, s2, 7
    s_lshl_b32 s56, s57, 17
    s_sub_u32 s56, s82, s56
    s_lshl_b32 s57, s57, 10
    s_add_u32 s56, s56, s57
    buffer_load_dwordx4 v[64:67], v15, s[8:11], s56 offen sc1
    s_add_u32 s56, s56, 131072
    buffer_load_dwordx4 v[68:71], v15, s[8:11], s56 offen sc1
    s_add_u32 s56, s56, 131072
    buffer_load_dwordx4 v[72:75], v15, s[8:11], s56 offen sc1
    s_add_u32 s56, s56, 131072
    buffer_load_dwordx4 v[76:79], v15, s[8:11], s56 offen sc1
    s_add_u32 s56, s56, 131072
    buffer_load_dwordx4 v[80:83], v15, s[8:11], s56 offen sc1
    s_add_u32 s56, s56, 131072
    buffer_load_dwordx4 v[84:87], v15, s[8:11], s56 offen sc1
    s_add_u32 s56, s56, 131072
    buffer_load_dwordx4 v[88:91], v15, s[8:11], s56 offen sc1
    s_add_u32 s56, s56, 131072
    buffer_load_dwordx4 v[92:95], v15, s[8:11], s56 offen sc1
    s_add_u32 s56, s56, 131072
    s_waitcnt vmcnt(0)
tail_ex2:
    s_lshl_b32 s58, s68, 1
    s_bfe_u32 s59, s2, 0x10002
    s_add_u32 s58, s58, s59
    s_lshl_b32 s58, s58, 15
    s_lshl_b32 s59, s80, 8
    s_add_u32 s58, s58, s59
    s_and_b32 s59, s2, 3
    s_lshl_b32 s59, s59, 6
    s_add_u32 s58, s58, s59
    s_add_u32 s58, s58, 1024
    s_mov_b32 s67, 0
val2:
    v_max3_u32 v3, v64, v65, v66
    v_max3_u32 v3, v3, v67, v68
    v_max3_u32 v3, v3, v69, v70
    v_max3_u32 v3, v3, v71, v72
    v_max3_u32 v3, v3, v73, v74
    v_max3_u32 v3, v3, v75, v76
    v_max3_u32 v3, v3, v77, v78
    v_max3_u32 v3, v3, v79, v80
    v_max3_u32 v3, v3, v81, v82
    v_max3_u32 v3, v3, v83, v84
    v_max3_u32 v3, v3, v85, v86
    v_max3_u32 v3, v3, v87, v88
    v_max3_u32 v3, v3, v89, v90
    v_max3_u32 v3, v3, v91, v92
    v_max3_u32 v3, v3, v93, v94
    v_max_u32 v3, v3, v95
    v_cmp_eq_u32 vcc, -1, v3
    s_cbranch_vccnz reload2
    s_cmp_eq_u32 exec_lo, 0
    s_mov_b64 exec, -1
    s_cbranch_scc1 loads2
valok2:
    v_lshlrev_b32 v128, 16, v64
    v_and_b32 v129, 0xffff0000, v64
    v_lshlrev_b32 v130, 16, v65
    v_and_b32 v131, 0xffff0000, v65
    v_lshlrev_b32 v132, 16, v66
    v_and_b32 v133, 0xffff0000, v66
    v_lshlrev_b32 v134, 16, v67
    v_and_b32 v135, 0xffff0000, v67
    v_lshlrev_b32 v136, 16, v68
    v_and_b32 v137, 0xffff0000, v68
    v_lshlrev_b32 v138, 16, v69
    v_and_b32 v139, 0xffff0000, v69
    v_lshlrev_b32 v140, 16, v70
    v_and_b32 v141, 0xffff0000, v70
    v_lshlrev_b32 v142, 16, v71
    v_and_b32 v143, 0xffff0000, v71
    v_lshlrev_b32 v144, 16, v72
    v_and_b32 v145, 0xffff0000, v72
    v_lshlrev_b32 v146, 16, v73
    v_and_b32 v147, 0xffff0000, v73
    v_lshlrev_b32 v148, 16, v74
    v_and_b32 v149, 0xffff0000, v74
    v_lshlrev_b32 v150, 16, v75
    v_and_b32 v151, 0xffff0000, v75
    v_lshlrev_b32 v152, 16, v76
    v_and_b32 v153, 0xffff0000, v76
    v_lshlrev_b32 v154, 16, v77
    v_and_b32 v155, 0xffff0000, v77
    v_lshlrev_b32 v156, 16, v78
    v_and_b32 v157, 0xffff0000, v78
    v_lshlrev_b32 v158, 16, v79
    v_and_b32 v159, 0xffff0000, v79
    v_lshlrev_b32 v160, 16, v80
    v_and_b32 v161, 0xffff0000, v80
    v_lshlrev_b32 v162, 16, v81
    v_and_b32 v163, 0xffff0000, v81
    v_lshlrev_b32 v164, 16, v82
    v_and_b32 v165, 0xffff0000, v82
    v_lshlrev_b32 v166, 16, v83
    v_and_b32 v167, 0xffff0000, v83
    v_lshlrev_b32 v168, 16, v84
    v_and_b32 v169, 0xffff0000, v84
    v_lshlrev_b32 v170, 16, v85
    v_and_b32 v171, 0xffff0000, v85
    v_lshlrev_b32 v172, 16, v86
    v_and_b32 v173, 0xffff0000, v86
    v_lshlrev_b32 v174, 16, v87
    v_and_b32 v175, 0xffff0000, v87
    v_lshlrev_b32 v176, 16, v88
    v_and_b32 v177, 0xffff0000, v88
    v_lshlrev_b32 v178, 16, v89
    v_and_b32 v179, 0xffff0000, v89
    v_lshlrev_b32 v180, 16, v90
    v_and_b32 v181, 0xffff0000, v90
    v_lshlrev_b32 v182, 16, v91
    v_and_b32 v183, 0xffff0000, v91
    v_lshlrev_b32 v184, 16, v92
    v_and_b32 v185, 0xffff0000, v92
    v_lshlrev_b32 v186, 16, v93
    v_and_b32 v187, 0xffff0000, v93
    v_lshlrev_b32 v188, 16, v94
    v_and_b32 v189, 0xffff0000, v94
    v_lshlrev_b32 v190, 16, v95
    v_and_b32 v191, 0xffff0000, v95
    v_pk_add_f32 v[128:129], v[128:129], v[160:161]
    v_pk_add_f32 v[130:131], v[130:131], v[162:163]
    v_pk_add_f32 v[132:133], v[132:133], v[164:165]
    v_pk_add_f32 v[134:135], v[134:135], v[166:167]
    v_pk_add_f32 v[136:137], v[136:137], v[168:169]
    v_pk_add_f32 v[138:139], v[138:139], v[170:171]
    v_pk_add_f32 v[140:141], v[140:141], v[172:173]
    v_pk_add_f32 v[142:143], v[142:143], v[174:175]
    v_pk_add_f32 v[144:145], v[144:145], v[176:177]
    v_pk_add_f32 v[146:147], v[146:147], v[178:179]
    v_pk_add_f32 v[148:149], v[148:149], v[180:181]
    v_pk_add_f32 v[150:151], v[150:151], v[182:183]
    v_pk_add_f32 v[152:153], v[152:153], v[184:185]
    v_pk_add_f32 v[154:155], v[154:155], v[186:187]
    v_pk_add_f32 v[156:157], v[156:157], v[188:189]
    v_pk_add_f32 v[158:159], v[158:159], v[190:191]
    v_pk_add_f32 v[128:129], v[128:129], v[144:145]
    v_pk_add_f32 v[130:131], v[130:131], v[146:147]
    v_pk_add_f32 v[132:133], v[132:133], v[148:149]
    v_pk_add_f32 v[134:135], v[134:135], v[150:151]
    v_pk_add_f32 v[136:137], v[136:137], v[152:153]
    v_pk_add_f32 v[138:139], v[138:139], v[154:155]
    v_pk_add_f32 v[140:141], v[140:141], v[156:157]
    v_pk_add_f32 v[142:143], v[142:143], v[158:159]
    v_pk_add_f32 v[128:129], v[128:129], v[136:137]
    v_pk_add_f32 v[130:131], v[130:131], v[138:139]
    v_pk_add_f32 v[132:133], v[132:133], v[140:141]
    v_pk_add_f32 v[134:135], v[134:135], v[142:143]
    v_cvt_pk_bf16_f32 v64, v128, v129
    v_cvt_pk_bf16_f32 v65, v130, v131
    v_cvt_pk_bf16_f32 v66, v132, v133
    v_cvt_pk_bf16_f32 v67, v134, v135
    v_lshrrev_b32 v17, 4, v0
    v_lshlrev_b32 v17, 3, v17
    v_sub_u32 v16, v16, v17
    buffer_store_dwordx2 v[64:65], v16, s[16:19], s58 offen nt
    buffer_store_dwordx2 v[66:67], v16, s[16:19], s58 offen offset:32 nt
ka_end:
    s_endpgm
reload0:
    s_mov_b64 exec, -1
    s_add_u32 s67, s67, 1
    s_cmp_ge_u32 s67, 400000
    s_cbranch_scc1 valok0
    s_nop 0
    s_nop 0
    s_sleep 1
loads0:
    s_lshl_b32 s58, s26, 12
    s_add_u32 s58, s58, 55574528
    buffer_load_dwordx4 v[32:35], v15, s[8:11], s58 offen offset:0 sc1
    buffer_load_dwordx4 v[36:39], v15, s[8:11], s58 offen offset:1024 sc1
    buffer_load_dwordx4 v[40:43], v15, s[8:11], s58 offen offset:2048 sc1
    buffer_load_dwordx4 v[44:47], v15, s[8:11], s58 offen offset:3072 sc1
    s_waitcnt vmcnt(0)
    s_branch val0
reload1:
    s_mov_b64 exec, -1
    s_add_u32 s67, s67, 1
    s_cmp_ge_u32 s67, 1600000
    s_cbranch_scc1 valok1
    s_nop 0
    s_nop 0
    s_sleep 1
loads1:
    s_add_u32 s56, s65, 0
    s_and_b32 s56, s56, 3
    s_lshl_b32 s56, s56, 14
    s_add_u32 s56, s56, s24
    buffer_load_dwordx4 v[64:67], v15, s[8:11], s56 offen offset:0 sc1
    buffer_load_dwordx4 v[68:71], v15, s[8:11], s56 offen offset:1024 sc1
    buffer_load_dwordx4 v[72:75], v15, s[8:11], s56 offen offset:2048 sc1
    buffer_load_dwordx4 v[76:79], v15, s[8:11], s56 offen offset:3072 sc1
    s_add_u32 s56, s65, 1
    s_and_b32 s56, s56, 3
    s_lshl_b32 s56, s56, 14
    s_add_u32 s56, s56, s24
    buffer_load_dwordx4 v[80:83], v15, s[8:11], s56 offen offset:0 sc1
    buffer_load_dwordx4 v[84:87], v15, s[8:11], s56 offen offset:1024 sc1
    buffer_load_dwordx4 v[88:91], v15, s[8:11], s56 offen offset:2048 sc1
    buffer_load_dwordx4 v[92:95], v15, s[8:11], s56 offen offset:3072 sc1
    s_add_u32 s56, s65, 2
    s_and_b32 s56, s56, 3
    s_lshl_b32 s56, s56, 14
    s_add_u32 s56, s56, s24
    buffer_load_dwordx4 v[96:99], v15, s[8:11], s56 offen offset:0 sc1
    buffer_load_dwordx4 v[100:103], v15, s[8:11], s56 offen offset:1024 sc1
    buffer_load_dwordx4 v[104:107], v15, s[8:11], s56 offen offset:2048 sc1
    buffer_load_dwordx4 v[108:111], v15, s[8:11], s56 offen offset:3072 sc1
    s_add_u32 s56, s65, 3
    s_and_b32 s56, s56, 3
    s_lshl_b32 s56, s56, 14
    s_add_u32 s56, s56, s24
    buffer_load_dwordx4 v[112:115], v15, s[8:11], s56 offen offset:0 sc1
    buffer_load_dwordx4 v[116:119], v15, s[8:11], s56 offen offset:1024 sc1
    buffer_load_dwordx4 v[120:123], v15, s[8:11], s56 offen offset:2048 sc1
    buffer_load_dwordx4 v[124:127], v15, s[8:11], s56 offen offset:3072 sc1
    s_waitcnt vmcnt(0)
    s_branch val1
reload2:
    s_mov_b64 exec, -1
    s_add_u32 s67, s67, 1
    s_cmp_ge_u32 s67, 1600000
    s_cbranch_scc1 valok2
    s_nop 0
    s_nop 0
    s_sleep 1
loads2:
    s_and_b32 s57, s2, 7
    s_lshl_b32 s56, s57, 17
    s_sub_u32 s56, s82, s56
    s_lshl_b32 s57, s57, 10
    s_add_u32 s56, s56, s57
    buffer_load_dwordx4 v[64:67], v15, s[8:11], s56 offen sc1
    s_add_u32 s56, s56, 131072
    buffer_load_dwordx4 v[68:71], v15, s[8:11], s56 offen sc1
    s_add_u32 s56, s56, 131072
    buffer_load_dwordx4 v[72:75], v15, s[8:11], s56 offen sc1
    s_add_u32 s56, s56, 131072
    buffer_load_dwordx4 v[76:79], v15, s[8:11], s56 offen sc1
    s_add_u32 s56, s56, 131072
    buffer_load_dwordx4 v[80:83], v15, s[8:11], s56 offen sc1
    s_add_u32 s56, s56, 131072
    buffer_load_dwordx4 v[84:87], v15, s[8:11], s56 offen sc1
    s_add_u32 s56, s56, 131072
    buffer_load_dwordx4 v[88:91], v15, s[8:11], s56 offen sc1
    s_add_u32 s56, s56, 131072
    buffer_load_dwordx4 v[92:95], v15, s[8:11], s56 offen sc1
    s_add_u32 s56, s56, 131072
    s_waitcnt vmcnt(0)
    s_branch val2
wo_dma:
    s_sub_u32 s84, s91, s77
    s_add_u32 s84, s84, s61
    s_add_u32 m0, s84, 0
    s_add_u32 s64, s79, 0
    buffer_load_dwordx4 v20, s[20:23], s64 offen lds
    s_add_u32 m0, s84, 4096
    s_add_u32 s64, s79, 16384
    buffer_load_dwordx4 v20, s[20:23], s64 offen lds
    s_add_u32 m0, s84, 8192
    s_add_u32 s64, s79, 32768
    buffer_load_dwordx4 v20, s[20:23], s64 offen lds
    s_add_u32 m0, s84, 12288
    s_add_u32 s64, s79, 49152
    buffer_load_dwordx4 v20, s[20:23], s64 offen lds
    s_add_u32 m0, s84, 16384
    s_add_u32 s64, s79, 65536
    buffer_load_dwordx4 v20, s[20:23], s64 offen lds
    s_add_u32 m0, s84, 20480
    s_add_u32 s64, s79, 81920
    buffer_load_dwordx4 v20, s[20:23], s64 offen lds
    s_add_u32 m0, s84, 24576
    s_add_u32 s64, s79, 98304
    buffer_load_dwordx4 v20, s[20:23], s64 offen lds
    s_add_u32 m0, s84, 28672
    s_add_u32 s64, s79, 114688
    buffer_load_dwordx4 v20, s[20:23], s64 offen lds
    s_add_u32 s79, s79, 0x100000
    s_and_b32 s79, s79, 0x3fffff
    s_cmp_eq_u32 s99, 0
    s_cbranch_scc1 wor_76
    s_cmp_eq_u32 s99, 1
    s_cbranch_scc1 wor_84
    s_cmp_eq_u32 s99, 2
    s_cbranch_scc1 wor_87
    s_cmp_eq_u32 s99, 3
    s_cbranch_scc1 wor_91
    s_cmp_eq_u32 s99, 4
    s_cbranch_scc1 wor_95
    s_cmp_eq_u32 s99, 5
    s_cbranch_scc1 wor_97
    s_cmp_eq_u32 s99, 6
    s_cbranch_scc1 wor_99
    s_cmp_eq_u32 s99, 7
    s_cbranch_scc1 wor_101
    s_cmp_eq_u32 s99, 8
    s_cbranch_scc1 wor_103
    s_cmp_eq_u32 s99, 9
    s_cbranch_scc1 wor_105
    s_cmp_eq_u32 s99, 10
    s_cbranch_scc1 wor_107
    s_cmp_eq_u32 s99, 11
    s_cbranch_scc1 wor_109
    s_cmp_eq_u32 s99, 12
    s_cbranch_scc1 wor_111
    s_cmp_eq_u32 s99, 13
    s_cbranch_scc1 wor_113
    s_cmp_eq_u32 s99, 14
    s_cbranch_scc1 wor_115
    s_branch wor_117
lvlb:
    s_cmp_eq_u32 s83, 5
    s_cbranch_scc1 lvlb_chk0
    s_cmp_eq_u32 s83, s94
    s_cbranch_scc1 lvlb_wait
    s_add_u32 s56, s94, 1
    s_cmp_eq_u32 s83, s56
    s_cbranch_scc1 lvlb_chk1
    s_cmp_gt_u32 s83, s78
    s_cbranch_scc1 lvlb_chk2
lvlb_load:
    s_and_b32 s58, s4, 3
    s_lshl_b32 s58, s58, 3
    s_add_u32 s58, s58, s5
    s_sub_u32 s58, s58, 1024
    v_lshlrev_b32 v19, 5, v0
    v_add_u32 v19, s58, v19
    s_lshr_b32 s58, s4, 2
    s_lshl_b32 s58, s58, 5
    s_mov_b32 exec_hi, 0
    v_add_u32 v19, s58, v0
    s_mov_b32 exec_hi, 0xff
    v_lshlrev_b32 v19, 7, v19
    s_mov_b32 s58, 68157440
    buffer_load_dword v18, v19, s[8:11], s58 offen sc1
    s_mov_b64 exec, -1
    s_branch lvlb_ret
lvlb_pub:
    s_and_b32 s58, s4, 3
    s_lshl_b32 s58, s58, 3
    s_add_u32 s58, s58, s5
    s_sub_u32 s58, s58, 1024
    v_lshlrev_b32 v19, 5, v0
    v_add_u32 v19, s58, v19
    s_lshr_b32 s58, s4, 2
    s_lshl_b32 s58, s58, 5
    s_mov_b32 exec_hi, 0
    v_add_u32 v19, s58, v0
    s_mov_b32 exec_hi, 0xff
    v_lshlrev_b32 v19, 7, v19
    s_mov_b32 s58, 68157440
    v_add_u32 v17, 3, v20
    s_and_b32 s59, s4, 3
    s_lshl_b32 s59, s59, 3
    s_add_u32 s59, s59, s5
    s_lshl_b32 exec_lo, 1, s59
    s_mov_b32 exec_hi, 0
    buffer_store_dword v17, v19, s[8:11], s58 offen sc1
    s_mov_b64 exec, -1
    s_branch lvlb_ret
lvlb_wait:
    s_waitcnt vmcnt(0)
    s_branch lvlb_ret
lvlb_chk0:
    s_cmp_lg_u32 s95, 0
    s_cbranch_scc1 lvlb_chk
    s_waitcnt vmcnt(0)
lvlb_chk:
    s_mov_b32 s67, 0
    s_waitcnt vmcnt(4)
    s_branch polltst_126
poll_124:
    s_sleep 2
    s_and_b32 s58, s4, 3
    s_lshl_b32 s58, s58, 3
    s_add_u32 s58, s58, s5
    s_sub_u32 s58, s58, 1024
    v_lshlrev_b32 v19, 5, v0
    v_add_u32 v19, s58, v19
    s_lshr_b32 s58, s4, 2
    s_lshl_b32 s58, s58, 5
    s_mov_b32 exec_hi, 0
    v_add_u32 v19, s58, v0
    s_mov_b32 exec_hi, 0xff
    v_lshlrev_b32 v19, 7, v19
    s_mov_b32 s58, 68157440
    buffer_load_dword v18, v19, s[8:11], s58 offen sc1
    s_mov_b64 exec, -1
    s_waitcnt vmcnt(0)
polltst_126:
    v_sub_u32 v18, v18, v20
    s_and_b32 s59, s4, 3
    s_lshl_b32 s59, s59, 3
    s_lshl_b32 s59, 0xff, s59
    v_cmp_gt_u32 vcc, 1, v18
    s_add_u32 s67, s67, 1
    s_and_b32 s57, vcc_lo, s59
    s_and_b32 s58, vcc_hi, 0
    s_or_b32 s57, s57, s58
    s_cbranch_scc0 pollok_125
    s_cmp_lt_u32 s67, 60000
    s_cbranch_scc1 poll_124
pollok_125:
    s_branch lvlb_ret
lvlb_chk1:
    s_mov_b32 s67, 0
    s_waitcnt vmcnt(0)
    s_branch polltst_129
poll_127:
    s_sleep 2
    s_and_b32 s58, s4, 3
    s_lshl_b32 s58, s58, 3
    s_add_u32 s58, s58, s5
    s_sub_u32 s58, s58, 1024
    v_lshlrev_b32 v19, 5, v0
    v_add_u32 v19, s58, v19
    s_lshr_b32 s58, s4, 2
    s_lshl_b32 s58, s58, 5
    s_mov_b32 exec_hi, 0
    v_add_u32 v19, s58, v0
    s_mov_b32 exec_hi, 0xff
    v_lshlrev_b32 v19, 7, v19
    s_mov_b32 s58, 68157440
    buffer_load_dword v18, v19, s[8:11], s58 offen sc1
    s_mov_b64 exec, -1
    s_waitcnt vmcnt(0)
polltst_129:
    v_sub_u32 v18, v18, v20
    s_mov_b32 s59, -1
    v_cmp_gt_u32 vcc, 2, v18
    s_add_u32 s67, s67, 1
    s_and_b32 s57, vcc_lo, s59
    s_and_b32 s58, vcc_hi, 0
    s_or_b32 s57, s57, s58
    s_cbranch_scc0 pollok_128
    s_cmp_lt_u32 s67, 60000
    s_cbranch_scc1 poll_127
pollok_128:
    s_branch lvlb_pub
lvlb_chk2:
    s_mov_b32 s67, 0
    s_waitcnt vmcnt(0)
    s_branch polltst_132
poll_130:
    s_sleep 2
    s_and_b32 s58, s4, 3
    s_lshl_b32 s58, s58, 3
    s_add_u32 s58, s58, s5
    s_sub_u32 s58, s58, 1024
    v_lshlrev_b32 v19, 5, v0
    v_add_u32 v19, s58, v19
    s_lshr_b32 s58, s4, 2
    s_lshl_b32 s58, s58, 5
    s_mov_b32 exec_hi, 0
    v_add_u32 v19, s58, v0
    s_mov_b32 exec_hi, 0xff
    v_lshlrev_b32 v19, 7, v19
    s_mov_b32 s58, 68157440
    buffer_load_dword v18, v19, s[8:11], s58 offen sc1
    s_mov_b64 exec, -1
    s_waitcnt vmcnt(0)
polltst_132:
    v_sub_u32 v18, v18, v20
    s_mov_b32 s59, 0
    v_cmp_gt_u32 vcc, 3, v18
    s_add_u32 s67, s67, 1
    s_and_b32 s57, vcc_lo, s59
    s_and_b32 s58, vcc_hi, 255
    s_or_b32 s57, s57, s58
    s_cbranch_scc0 pollok_131
    s_cmp_lt_u32 s67, 180000
    s_cbranch_scc1 poll_130
pollok_131:
    s_branch lvlb_ret
pub_46:
    s_cmp_lt_u32 s5, 2
    s_cbranch_scc0 pubr_47
    s_and_b32 s58, s4, 3
    s_lshl_b32 s58, s58, 3
    s_add_u32 s58, s58, s5
    s_sub_u32 s58, s58, 1024
    v_lshlrev_b32 v19, 5, v0
    v_add_u32 v19, s58, v19
    s_lshr_b32 s58, s4, 2
    s_lshl_b32 s58, s58, 5
    s_mov_b32 exec_hi, 0
    v_add_u32 v19, s58, v0
    s_mov_b32 exec_hi, 0xff
    v_lshlrev_b32 v19, 7, v19
    s_mov_b32 s58, 68157440
    v_add_u32 v17, 1, v20
    s_and_b32 s59, s4, 3
    s_lshl_b32 s59, s59, 3
    s_add_u32 s59, s59, s5
    s_lshl_b32 exec_lo, 1, s59
    s_mov_b32 exec_hi, 0
    buffer_store_dword v17, v19, s[8:11], s58 offen sc1
    s_mov_b64 exec, -1
    s_branch pubr_47
fl_56:
    s_and_b32 s58, s4, 3
    s_lshl_b32 s58, s58, 3
    s_add_u32 s58, s58, s5
    s_sub_u32 s58, s58, 1024
    v_lshlrev_b32 v19, 5, v0
    v_add_u32 v19, s58, v19
    s_lshr_b32 s58, s4, 2
    s_lshl_b32 s58, s58, 5
    s_mov_b32 exec_hi, 0
    v_add_u32 v19, s58, v0
    s_mov_b32 exec_hi, 0xff
    v_lshlrev_b32 v19, 7, v19
    s_mov_b32 s58, 68157440
    s_and_b32 s59, s4, 3
    s_lshl_b32 s59, s59, 3
    s_lshl_b32 exec_lo, 0xff, s59
    s_mov_b32 exec_hi, 0
    buffer_load_dword v18, v19, s[8:11], s58 offen sc1
    s_mov_b64 exec, -1
    s_branch flr_57
chk_64:
    s_mov_b32 s67, 0
    s_waitcnt vmcnt(0)
    s_branch polltst_68
poll_66:
    s_sleep 2
    s_and_b32 s58, s4, 3
    s_lshl_b32 s58, s58, 3
    s_add_u32 s58, s58, s5
    s_sub_u32 s58, s58, 1024
    v_lshlrev_b32 v19, 5, v0
    v_add_u32 v19, s58, v19
    s_lshr_b32 s58, s4, 2
    s_lshl_b32 s58, s58, 5
    s_mov_b32 exec_hi, 0
    v_add_u32 v19, s58, v0
    s_mov_b32 exec_hi, 0xff
    v_lshlrev_b32 v19, 7, v19
    s_mov_b32 s58, 68157440
    buffer_load_dword v18, v19, s[8:11], s58 offen sc1
    s_mov_b64 exec, -1
    s_waitcnt vmcnt(0)
polltst_68:
    v_sub_u32 v18, v18, v20
    s_and_b32 s59, s4, 3
    s_lshl_b32 s59, s59, 3
    s_lshl_b32 s59, 3, s59
    v_cmp_gt_u32 vcc, 1, v18
    s_add_u32 s67, s67, 1
    s_and_b32 s57, vcc_lo, s59
    s_and_b32 s58, vcc_hi, 0
    s_or_b32 s57, s57, s58
    s_cbranch_scc0 pollok_67
    s_cmp_lt_u32 s67, 20000
    s_cbranch_scc1 poll_66
pollok_67:
    s_branch chkr_65
pub_71:
    s_and_b32 s58, s4, 3
    s_lshl_b32 s58, s58, 3
    s_add_u32 s58, s58, s5
    s_sub_u32 s58, s58, 1024
    v_lshlrev_b32 v19, 5, v0
    v_add_u32 v19, s58, v19
    s_lshr_b32 s58, s4, 2
    s_lshl_b32 s58, s58, 5
    s_mov_b32 exec_hi, 0
    v_add_u32 v19, s58, v0
    s_mov_b32 exec_hi, 0xff
    v_lshlrev_b32 v19, 7, v19
    s_mov_b32 s58, 68157440
    v_add_u32 v17, 2, v20
    s_and_b32 s59, s4, 3
    s_lshl_b32 s59, s59, 3
    s_add_u32 s59, s59, s5
    s_lshl_b32 exec_lo, 1, s59
    s_mov_b32 exec_hi, 0
    buffer_store_dword v17, v19, s[8:11], s58 offen sc1
    s_mov_b64 exec, -1
    s_branch pubr_72
rare0:
    s_nop 11
    v_max3_f32 v172, v128, v129, v130
    v_max3_f32 v172, v172, v131, v132
    v_max3_f32 v172, v172, v133, v134
    v_max_f32 v172, v172, v135
    v_max3_f32 v174, v136, v137, v138
    v_max3_f32 v174, v174, v139, v140
    v_max3_f32 v174, v174, v141, v142
    v_max_f32 v174, v174, v143
    v_mov_b32 v173, v172
    v_mov_b32 v175, v174
    s_nop 0
    v_permlane32_swap_b32 v172, v173
    v_permlane32_swap_b32 v174, v175
    v_max_f32 v172, v172, v173
    v_max_f32 v174, v174, v175
    v_mov_b32 v173, v172
    v_mov_b32 v175, v174
    s_nop 0
    v_permlane16_swap_b32 v172, v173
    v_permlane16_swap_b32 v174, v175
    v_max_f32 v172, v172, v173
    v_max_f32 v174, v174, v175
    v_add_f32 v172, 1120665600, v172
    v_max_f32 v172, 0, v172
    v_sub_f32 v173, 0, v172
    v_exp_f32 v173, v173
    v_add_f32 v174, 1120665600, v174
    v_max_f32 v174, 0, v174
    v_sub_f32 v175, 0, v174
    v_exp_f32 v175, v175
    v_sub_f32 v128, v128, v172
    v_sub_f32 v144, v144, v172
    v_sub_f32 v129, v129, v172
    v_sub_f32 v145, v145, v172
    v_sub_f32 v130, v130, v172
    v_sub_f32 v146, v146, v172
    v_sub_f32 v131, v131, v172
    v_sub_f32 v147, v147, v172
    v_sub_f32 v132, v132, v172
    v_sub_f32 v148, v148, v172
    v_sub_f32 v133, v133, v172
    v_sub_f32 v149, v149, v172
    v_sub_f32 v134, v134, v172
    v_sub_f32 v150, v150, v172
    v_sub_f32 v135, v135, v172
    v_sub_f32 v151, v151, v172
    v_sub_f32 v136, v136, v174
    v_sub_f32 v152, v152, v174
    v_sub_f32 v137, v137, v174
    v_sub_f32 v153, v153, v174
    v_sub_f32 v138, v138, v174
    v_sub_f32 v154, v154, v174
    v_sub_f32 v139, v139, v174
    v_sub_f32 v155, v155, v174
    v_sub_f32 v140, v140, v174
    v_sub_f32 v156, v156, v174
    v_sub_f32 v141, v141, v174
    v_sub_f32 v157, v157, v174
    v_sub_f32 v142, v142, v174
    v_sub_f32 v158, v158, v174
    v_sub_f32 v143, v143, v174
    v_sub_f32 v159, v159, v174
    v_sub_f32 v160, v160, v172
    v_sub_f32 v161, v161, v172
    v_sub_f32 v162, v162, v172
    v_sub_f32 v163, v163, v172
    v_sub_f32 v164, v164, v174
    v_sub_f32 v165, v165, v174
    v_sub_f32 v166, v166, v174
    v_sub_f32 v167, v167, v174
    v_mul_f32 v64, v64, v173
    v_mul_f32 v65, v65, v173
    v_mul_f32 v66, v66, v173
    v_mul_f32 v67, v67, v173
    v_mul_f32 v68, v68, v173
    v_mul_f32 v69, v69, v173
    v_mul_f32 v70, v70, v173
    v_mul_f32 v71, v71, v173
    v_mul_f32 v72, v72, v175
    v_mul_f32 v73, v73, v175
    v_mul_f32 v74, v74, v175
    v_mul_f32 v75, v75, v175
    v_mul_f32 v76, v76, v175
    v_mul_f32 v77, v77, v175
    v_mul_f32 v78, v78, v175
    v_mul_f32 v79, v79, v175
    v_mul_f32 v80, v80, v173
    v_mul_f32 v81, v81, v173
    v_mul_f32 v82, v82, v173
    v_mul_f32 v83, v83, v173
    v_mul_f32 v84, v84, v173
    v_mul_f32 v85, v85, v173
    v_mul_f32 v86, v86, v173
    v_mul_f32 v87, v87, v173
    v_mul_f32 v88, v88, v175
    v_mul_f32 v89, v89, v175
    v_mul_f32 v90, v90, v175
    v_mul_f32 v91, v91, v175
    v_mul_f32 v92, v92, v175
    v_mul_f32 v93, v93, v175
    v_mul_f32 v94, v94, v175
    v_mul_f32 v95, v95, v175
    v_mul_f32 v96, v96, v173
    v_mul_f32 v97, v97, v173
    v_mul_f32 v98, v98, v173
    v_mul_f32 v99, v99, v173
    v_mul_f32 v100, v100, v173
    v_mul_f32 v101, v101, v173
    v_mul_f32 v102, v102, v173
    v_mul_f32 v103, v103, v173
    v_mul_f32 v104, v104, v175
    v_mul_f32 v105, v105, v175
    v_mul_f32 v106, v106, v175
    v_mul_f32 v107, v107, v175
    v_mul_f32 v108, v108, v175
    v_mul_f32 v109, v109, v175
    v_mul_f32 v110, v110, v175
    v_mul_f32 v111, v111, v175
    v_mul_f32 v112, v112, v173
    v_mul_f32 v113, v113, v173
    v_mul_f32 v114, v114, v173
    v_mul_f32 v115, v115, v173
    v_mul_f32 v116, v116, v173
    v_mul_f32 v117, v117, v173
    v_mul_f32 v118, v118, v173
    v_mul_f32 v119, v119, v173
    v_mul_f32 v120, v120, v175
    v_mul_f32 v121, v121, v175
    v_mul_f32 v122, v122, v175
    v_mul_f32 v123, v123, v175
    v_mul_f32 v124, v124, v175
    v_mul_f32 v125, v125, v175
    v_mul_f32 v126, v126, v175
    v_mul_f32 v127, v127, v175
    v_mul_f32 v170, v170, v173
    v_mul_f32 v171, v171, v175
    v_exp_f32 v12, v128
    v_exp_f32 v13, v129
    s_nop 0
    v_exp_f32 v1, v130
    v_cvt_pk_bf16_f32 v176, v12, v13
    s_nop 0
    v_exp_f32 v21, v131
    v_exp_f32 v22, v132
    s_nop 0
    v_exp_f32 v23, v133
    v_cvt_pk_bf16_f32 v177, v1, v21
    s_nop 0
    v_exp_f32 v12, v134
    v_exp_f32 v13, v135
    v_cvt_pk_bf16_f32 v178, v22, v23
    s_nop 0
    v_exp_f32 v1, v136
    v_cvt_pk_bf16_f32 v179, v12, v13
    s_nop 0
    v_exp_f32 v21, v137
    v_exp_f32 v22, v138
    s_nop 0
    v_exp_f32 v23, v139
    v_cvt_pk_bf16_f32 v180, v1, v21
    v_mfma_f32_16x16x32_bf16 v[4:7], v[28:31], v[176:179], 0
    s_nop 0
    v_exp_f32 v12, v140
    v_exp_f32 v13, v141
    v_cvt_pk_bf16_f32 v181, v22, v23
    s_nop 0
    v_exp_f32 v1, v142
    v_cvt_pk_bf16_f32 v182, v12, v13
    s_nop 0
    v_exp_f32 v21, v143
    s_nop 0
    v_cvt_pk_bf16_f32 v183, v1, v21
    s_nop 0
    s_nop 0
    v_mfma_f32_16x16x32_bf16 v[8:11], v[28:31], v[180:183], 0
    s_nop 0
    v_add_f32 v168, v170, v4
    s_nop 0
    s_nop 4
    v_add_f32 v169, v171, v8
    s_nop 0
    s_nop 0
    s_nop 1
    s_cmp_eq_u32 s71, 0
    s_cbranch_scc1 ret_77
    s_cmp_eq_u32 s71, 1
    s_cbranch_scc1 ret_78
    s_cmp_eq_u32 s71, 3
    s_cbranch_scc1 ret_80
    s_cmp_eq_u32 s71, 5
    s_cbranch_scc1 ret_82
    s_cmp_eq_u32 s71, 7
    s_cbranch_scc1 ret_85
    s_cmp_eq_u32 s71, 8
    s_cbranch_scc1 ret_86
    s_branch ret_88
rare1:
    s_nop 11
    v_max3_f32 v172, v144, v145, v146
    v_max3_f32 v172, v172, v147, v148
    v_max3_f32 v172, v172, v149, v150
    v_max_f32 v172, v172, v151
    v_max3_f32 v174, v152, v153, v154
    v_max3_f32 v174, v174, v155, v156
    v_max3_f32 v174, v174, v157, v158
    v_max_f32 v174, v174, v159
    v_mov_b32 v173, v172
    v_mov_b32 v175, v174
    s_nop 0
    v_permlane32_swap_b32 v172, v173
    v_permlane32_swap_b32 v174, v175
    v_max_f32 v172, v172, v173
    v_max_f32 v174, v174, v175
    v_mov_b32 v173, v172
    v_mov_b32 v175, v174
    s_nop 0
    v_permlane16_swap_b32 v172, v173
    v_permlane16_swap_b32 v174, v175
    v_max_f32 v172, v172, v173
    v_max_f32 v174, v174, v175
    v_add_f32 v172, 1120665600, v172
    v_max_f32 v172, 0, v172
    v_sub_f32 v173, 0, v172
    v_exp_f32 v173, v173
    v_add_f32 v174, 1120665600, v174
    v_max_f32 v174, 0, v174
    v_sub_f32 v175, 0, v174
    v_exp_f32 v175, v175
    v_sub_f32 v128, v128, v172
    v_sub_f32 v144, v144, v172
    v_sub_f32 v129, v129, v172
    v_sub_f32 v145, v145, v172
    v_sub_f32 v130, v130, v172
    v_sub_f32 v146, v146, v172
    v_sub_f32 v131, v131, v172
    v_sub_f32 v147, v147, v172
    v_sub_f32 v132, v132, v172
    v_sub_f32 v148, v148, v172
    v_sub_f32 v133, v133, v172
    v_sub_f32 v149, v149, v172
    v_sub_f32 v134, v134, v172
    v_sub_f32 v150, v150, v172
    v_sub_f32 v135, v135, v172
    v_sub_f32 v151, v151, v172
    v_sub_f32 v136, v136, v174
    v_sub_f32 v152, v152, v174
    v_sub_f32 v137, v137, v174
    v_sub_f32 v153, v153, v174
    v_sub_f32 v138, v138, v174
    v_sub_f32 v154, v154, v174
    v_sub_f32 v139, v139, v174
    v_sub_f32 v155, v155, v174
    v_sub_f32 v140, v140, v174
    v_sub_f32 v156, v156, v174
    v_sub_f32 v141, v141, v174
    v_sub_f32 v157, v157, v174
    v_sub_f32 v142, v142, v174
    v_sub_f32 v158, v158, v174
    v_sub_f32 v143, v143, v174
    v_sub_f32 v159, v159, v174
    v_sub_f32 v160, v160, v172
    v_sub_f32 v161, v161, v172
    v_sub_f32 v162, v162, v172
    v_sub_f32 v163, v163, v172
    v_sub_f32 v164, v164, v174
    v_sub_f32 v165, v165, v174
    v_sub_f32 v166, v166, v174
    v_sub_f32 v167, v167, v174
    v_mul_f32 v64, v64, v173
    v_mul_f32 v65, v65, v173
    v_mul_f32 v66, v66, v173
    v_mul_f32 v67, v67, v173
    v_mul_f32 v68, v68, v173
    v_mul_f32 v69, v69, v173
    v_mul_f32 v70, v70, v173
    v_mul_f32 v71, v71, v173
    v_mul_f32 v72, v72, v175
    v_mul_f32 v73, v73, v175
    v_mul_f32 v74, v74, v175
    v_mul_f32 v75, v75, v175
    v_mul_f32 v76, v76, v175
    v_mul_f32 v77, v77, v175
    v_mul_f32 v78, v78, v175
    v_mul_f32 v79, v79, v175
    v_mul_f32 v80, v80, v173
    v_mul_f32 v81, v81, v173
    v_mul_f32 v82, v82, v173
    v_mul_f32 v83, v83, v173
    v_mul_f32 v84, v84, v173
    v_mul_f32 v85, v85, v173
    v_mul_f32 v86, v86, v173
    v_mul_f32 v87, v87, v173
    v_mul_f32 v88, v88, v175
    v_mul_f32 v89, v89, v175
    v_mul_f32 v90, v90, v175
    v_mul_f32 v91, v91, v175
    v_mul_f32 v92, v92, v175
    v_mul_f32 v93, v93, v175
    v_mul_f32 v94, v94, v175
    v_mul_f32 v95, v95, v175
    v_mul_f32 v96, v96, v173
    v_mul_f32 v97, v97, v173
    v_mul_f32 v98, v98, v173
    v_mul_f32 v99, v99, v173
    v_mul_f32 v100, v100, v173
    v_mul_f32 v101, v101, v173
    v_mul_f32 v102, v102, v173
    v_mul_f32 v103, v103, v173
    v_mul_f32 v104, v104, v175
    v_mul_f32 v105, v105, v175
    v_mul_f32 v106, v106, v175
    v_mul_f32 v107, v107, v175
    v_mul_f32 v108, v108, v175
    v_mul_f32 v109, v109, v175
    v_mul_f32 v110, v110, v175
    v_mul_f32 v111, v111, v175
    v_mul_f32 v112, v112, v173
    v_mul_f32 v113, v113, v173
    v_mul_f32 v114, v114, v173
    v_mul_f32 v115, v115, v173
    v_mul_f32 v116, v116, v173
    v_mul_f32 v117, v117, v173
    v_mul_f32 v118, v118, v173
    v_mul_f32 v119, v119, v173
    v_mul_f32 v120, v120, v175
    v_mul_f32 v121, v121, v175
    v_mul_f32 v122, v122, v175
    v_mul_f32 v123, v123, v175
    v_mul_f32 v124, v124, v175
    v_mul_f32 v125, v125, v175
    v_mul_f32 v126, v126, v175
    v_mul_f32 v127, v127, v175
    v_mul_f32 v168, v168, v173
    v_mul_f32 v169, v169, v175
    v_exp_f32 v12, v144
    v_exp_f32 v13, v145
    s_nop 0
    v_exp_f32 v1, v146
    v_cvt_pk_bf16_f32 v184, v12, v13
    s_nop 0
    v_exp_f32 v21, v147
    v_exp_f32 v22, v148
    s_nop 0
    v_exp_f32 v23, v149
    v_cvt_pk_bf16_f32 v185, v1, v21
    s_nop 0
    v_exp_f32 v12, v150
    v_exp_f32 v13, v151
    v_cvt_pk_bf16_f32 v186, v22, v23
    s_nop 0
    v_exp_f32 v1, v152
    v_cvt_pk_bf16_f32 v187, v12, v13
    s_nop 0
    v_exp_f32 v21, v153
    v_exp_f32 v22, v154
    s_nop 0
    v_exp_f32 v23, v155
    v_cvt_pk_bf16_f32 v188, v1, v21
    v_mfma_f32_16x16x32_bf16 v[4:7], v[28:31], v[184:187], 0
    s_nop 0
    v_exp_f32 v12, v156
    v_exp_f32 v13, v157
    v_cvt_pk_bf16_f32 v189, v22, v23
    s_nop 0
    v_exp_f32 v1, v158
    v_cvt_pk_bf16_f32 v190, v12, v13
    s_nop 0
    v_exp_f32 v21, v159
    s_nop 0
    v_cvt_pk_bf16_f32 v191, v1, v21
    s_nop 0
    s_nop 0
    v_mfma_f32_16x16x32_bf16 v[8:11], v[28:31], v[188:191], 0
    s_nop 0
    v_add_f32 v170, v168, v4
    s_nop 0
    s_nop 4
    v_add_f32 v171, v169, v8
    s_nop 0
    s_nop 0
    s_nop 1
    s_cmp_eq_u32 s71, 2
    s_cbranch_scc1 ret_79
    s_cmp_eq_u32 s71, 4
    s_cbranch_scc1 ret_81
    s_cmp_eq_u32 s71, 6
    s_cbranch_scc1 ret_83
    s_branch ret_92
code_end:
.section .rodata,"a"
.p2align 6
.amdhsa_kernel concat_heads__linear_kernel_hedgehog__compressed_kv_cla__prompt_kernel
  .amdhsa_next_free_vgpr 256
  .amdhsa_next_free_sgpr 102
  .amdhsa_accum_offset 256
  .amdhsa_group_segment_fixed_size 0
  .amdhsa_kernarg_size 104
  .amdhsa_user_sgpr_count 2
  .amdhsa_user_sgpr_kernarg_segment_ptr 1
  .amdhsa_system_sgpr_workgroup_id_x 1
  .amdhsa_float_denorm_mode_32 0
.end_amdhsa_kernel
```
